```python
import torch

def _softmax(x, axis=-1):
    return torch.softmax(x, dim=axis)
def _gelu(x):
    return torch.nn.functional.gelu(x, approximate="tanh")
def _silu(x):
    return torch.nn.functional.silu(x)
def _sigmoid(x):
    return torch.sigmoid(x)
def _layernorm(x, axis=-1, eps=1e-5):
    m = x.mean(dim=axis, keepdim=True)
    v = x.var(dim=axis, keepdim=True, unbiased=False)
    return (x - m) / torch.sqrt(v + eps)
def _scatter_add(tgt, idx, src, axis=0):
    return tgt.clone().index_add_(axis, idx, src)
def _segment_sum(src, seg, n):
    out = torch.zeros((n,) + src.shape[1:], dtype=src.dtype)
    return out.index_add_(0, seg, src)
def _pad(x, pw):
    flat = tuple(v for pair in reversed(pw) for v in pair)
    return torch.nn.functional.pad(x, flat)

kernel_name = 'sequential_preLN__sliding_local_dilated__geglu_ffn__prompt'

def setup_inputs():

    _w = (lambda a: (lambda t: t.to(torch.bfloat16) if t.is_floating_point() else t)(torch.as_tensor(a)))
    def _A_setup():
        B, S, D = 1, 2048, 576
        return {
            "x": _w((lambda *s: torch.randn(*s, dtype=torch.bfloat16) * 0.05)(B, S, D)),
            "wqkv": _w((lambda *s: torch.randn(*s, dtype=torch.bfloat16) * 0.05)(D, 3 * D)),
            "wo": _w((lambda *s: torch.randn(*s, dtype=torch.bfloat16) * 0.05)(D, D)),
        }
    _A_in = _A_setup()

    def _B_setup():
        B, S, D, F = 1, 2048, 576, 4608
        return {
            "x": _w((lambda *s: torch.randn(*s, dtype=torch.bfloat16) * 0.05)(B, S, D)),
            "w_gate": _w((lambda *s: torch.randn(*s, dtype=torch.bfloat16) * 0.05)(D, F)),
            "w_up": _w((lambda *s: torch.randn(*s, dtype=torch.bfloat16) * 0.05)(D, F)),
            "w_down": _w((lambda *s: torch.randn(*s, dtype=torch.bfloat16) * 0.05)(F, D)),
        }
    _B_in = _B_setup()

    return {
        "A_x": _A_in["x"],
        "A_wqkv": _A_in["wqkv"],
        "A_wo": _A_in["wo"],
        "B_x": _B_in["x"],
        "B_w_gate": _B_in["w_gate"],
        "B_w_up": _B_in["w_up"],
        "B_w_down": _B_in["w_down"],
    }

def reference(A_x, A_wqkv, A_wo, B_x, B_w_gate, B_w_up, B_w_down):
    def _A_ref(x, wqkv, wo):
        B, S, D = x.shape
        H = 32; Dh = D // H
        W, dil = 8, 2
        qkv = (lambda x, *d: x.permute(*d))((x @ wqkv).reshape(B, S, 3, H, Dh), 2, 0, 3, 1, 4)
        q, k, v = qkv[0], qkv[1], qkv[2]
        scale = Dh ** -0.5
        pos = torch.arange(S)
        off = torch.arange(W) * dil
        idx = pos[:, None] - off[None, :]
        mask = idx >= 0
        idx_c = torch.where(mask, idx, 0).reshape(-1)
        kg = k[:, :, idx_c, :].reshape(B, H, S, W, Dh)
        vg = v[:, :, idx_c, :].reshape(B, H, S, W, Dh)
        logits = torch.einsum("bhsd,bhswd->bhsw", q, kg) * scale
        logits = torch.where(mask[None, None, :, :], logits, -1e9)
        attn = _softmax(logits, axis=-1)
        o = torch.einsum("bhsw,bhswd->bhsd", attn, vg)
        return (lambda x, *d: x.permute(*d))(o, 0, 2, 1, 3).reshape(B, S, D) @ wo

    def _B_ref(x, w_gate, w_up, w_down):
        return (_gelu(x @ w_gate) * (x @ w_up)) @ w_down

    x = A_x
    h = x + _A_ref(_layernorm(x, axis=-1), A_wqkv, A_wo)
    h2 = h + _B_ref(_layernorm(h, axis=-1), B_w_gate, B_w_up, B_w_down)
    return h2
```

```asm
; @launch kernel=k1_kernel grid=(256,1,1) block=(512,1,1) lds=157696
; @launch kernel=k2_kernel grid=(192,1,1) block=(256,1,1) lds=143360
; @launch kernel=k3_kernel grid=(256,1,1) block=(512,1,1) lds=111360
; @launch kernel=k4_kernel grid=(256,1,1) block=(512,1,1) lds=110592
; @launch kernel=k5_kernel grid=(576,1,1) block=(256,1,1) lds=0
.amdgcn_target "amdgcn-amd-amdhsa--gfx950"
.text
.globl k1_kernel
.p2align 8
.type k1_kernel,@function
k1_kernel:
    s_cmp_ge_u32 s2, 256
    s_cbranch_scc1 L_k1_kernel_done
    s_load_dwordx4 s[4:7], s[0:1], 0
    s_load_dwordx2 s[8:9], s[0:1], 72
    s_load_dwordx4 s[48:51], s[0:1], 32
    s_load_dwordx2 s[52:53], s[0:1], 48
    s_load_dwordx2 s[92:93], s[0:1], 16
    v_lshrrev_b32 v1, 6, v0
    v_mov_b32 v3, v0
    v_and_b32 v0, 63, v0
    v_readfirstlane_b32 s28, v1
    s_lshr_b32 s36, s2, 3
    s_and_b32 s30, s36, 3
    s_and_b32 s37, s2, 1
    s_lshl_b32 s37, s37, 2
    s_add_u32 s30, s30, s37
    s_lshr_b32 s29, s36, 2
    s_bfe_u32 s37, s2, 0x20001
    s_lshl_b32 s37, s37, 3
    s_add_u32 s29, s29, s37
    v_min_u32 v164, 59, v0
    v_mul_u32_u24 v160, 10923, v164
    v_lshrrev_b32 v160, 16, v160
    v_mul_u32_u24 v161, 6, v160
    v_sub_u32 v161, v164, v161
    s_mul_i32 s36, s28, 10
    v_add_u32 v162, s36, v160
    s_lshl_b32 s37, s29, 6
    s_sub_u32 s37, s37, 16
    v_add_u32 v163, s37, v162
    s_movk_i32 s38, 1152
    v_mul_lo_u32 v163, v163, s38
    v_lshl_add_u32 v163, v161, 4, v163
    s_waitcnt lgkmcnt(0)
    s_mov_b32 s16, s4
    s_mov_b32 s17, s5
    s_and_b32 s17, s17, 0xffff
    s_mov_b32 s18, 2359296
    s_mov_b32 s19, 0x00020000
    buffer_load_dwordx4 v[100:103], v163, s[16:19], 0 offen offset:0
    buffer_load_dwordx4 v[104:107], v163, s[16:19], 0 offen offset:96
    buffer_load_dwordx4 v[108:111], v163, s[16:19], 0 offen offset:192
    buffer_load_dwordx4 v[112:115], v163, s[16:19], 0 offen offset:288
    buffer_load_dwordx4 v[116:119], v163, s[16:19], 0 offen offset:384
    buffer_load_dwordx4 v[120:123], v163, s[16:19], 0 offen offset:480
    buffer_load_dwordx4 v[124:127], v163, s[16:19], 0 offen offset:576
    buffer_load_dwordx4 v[128:131], v163, s[16:19], 0 offen offset:672
    buffer_load_dwordx4 v[132:135], v163, s[16:19], 0 offen offset:768
    buffer_load_dwordx4 v[136:139], v163, s[16:19], 0 offen offset:864
    buffer_load_dwordx4 v[140:143], v163, s[16:19], 0 offen offset:960
    buffer_load_dwordx4 v[144:147], v163, s[16:19], 0 offen offset:1056
    s_mov_b32 s12, s6
    s_mov_b32 s13, s7
    s_and_b32 s13, s13, 0xffff
    s_mov_b32 s14, 1990656
    s_mov_b32 s15, 0x00020000
    s_mov_b32 s20, s8
    s_mov_b32 s21, s9
    s_and_b32 s21, s21, 0xffff
    s_mov_b32 s22, 2359296
    s_mov_b32 s23, 0x00020000
    s_lshl_b32 s36, s28, 7
    s_mul_i32 s37, s30, 144
    s_mov_b32 s38, 0x40000000
    v_add_u32 v164, s36, v0
    v_mul_u32_u24 v165, 2185, v164
    v_lshrrev_b32 v165, 16, v165
    v_mul_u32_u24 v166, 30, v165
    v_sub_u32 v166, v164, v166
    v_mul_u32_u24 v167, 7282, v166
    v_lshrrev_b32 v167, 16, v167
    v_mul_u32_u24 v168, 9, v167
    v_sub_u32 v168, v166, v168
    v_mul_u32_u24 v167, 1152, v167
    v_lshl_add_u32 v167, v168, 4, v167
    v_and_b32 v168, 4, v165
    v_lshlrev_b32 v168, 1, v168
    v_and_b32 v169, 8, v165
    v_lshrrev_b32 v169, 1, v169
    v_and_b32 v170, 0x13, v165
    v_or3_b32 v168, v168, v169, v170
    v_mul_u32_u24 v168, 3456, v168
    v_add3_u32 v167, v167, v168, s37
    v_cmp_gt_u32 vcc, 27, v166
    v_cmp_gt_u32 s[40:41], 32, v165
    s_and_b64 vcc, vcc, s[40:41]
    v_mov_b32 v168, s38
    s_nop 1
    v_cndmask_b32 v150, v168, v167, vcc
    v_add_u32 v164, s36, v0
    v_add_u32 v164, 64, v164
    v_mul_u32_u24 v165, 2185, v164
    v_lshrrev_b32 v165, 16, v165
    v_mul_u32_u24 v166, 30, v165
    v_sub_u32 v166, v164, v166
    v_mul_u32_u24 v167, 7282, v166
    v_lshrrev_b32 v167, 16, v167
    v_mul_u32_u24 v168, 9, v167
    v_sub_u32 v168, v166, v168
    v_mul_u32_u24 v167, 1152, v167
    v_lshl_add_u32 v167, v168, 4, v167
    v_and_b32 v168, 4, v165
    v_lshlrev_b32 v168, 1, v168
    v_and_b32 v169, 8, v165
    v_lshrrev_b32 v169, 1, v169
    v_and_b32 v170, 0x13, v165
    v_or3_b32 v168, v168, v169, v170
    v_mul_u32_u24 v168, 3456, v168
    v_add3_u32 v167, v167, v168, s37
    v_cmp_gt_u32 vcc, 27, v166
    v_cmp_gt_u32 s[40:41], 32, v165
    s_and_b64 vcc, vcc, s[40:41]
    v_mov_b32 v168, s38
    s_nop 1
    v_cndmask_b32 v151, v168, v167, vcc
    s_lshl_b32 s32, s28, 11
    s_add_u32 s32, s32, 92160
    s_mov_b32 s31, 0
    s_add_u32 m0, s32, 0
    s_nop 0
    buffer_load_dwordx4 v150, s[12:15], s31 offen lds
    s_add_u32 m0, s32, 1024
    s_nop 0
    buffer_load_dwordx4 v151, s[12:15], s31 offen lds
    s_mov_b32 s31, 110592
    s_add_u32 m0, s32, 16384
    s_nop 0
    buffer_load_dwordx4 v150, s[12:15], s31 offen lds
    s_add_u32 m0, s32, 17408
    s_nop 0
    buffer_load_dwordx4 v151, s[12:15], s31 offen lds
    s_mov_b32 s44, 0x3f803f80
    v_add_u32 v168, 3, v161
    v_subrev_u32 v171, 6, v168
    v_min_u32 v168, v168, v171
    v_mad_u32_u24 v168, v160, 6, v168
    v_lshlrev_b32 v168, 2, v168
    v_add_u32 v169, 1, v161
    v_subrev_u32 v171, 6, v169
    v_min_u32 v169, v169, v171
    v_mad_u32_u24 v169, v160, 6, v169
    v_lshlrev_b32 v169, 2, v169
    v_add_u32 v170, 2, v161
    v_subrev_u32 v171, 6, v170
    v_min_u32 v170, v170, v171
    v_mad_u32_u24 v170, v160, 6, v170
    v_lshlrev_b32 v170, 2, v170
    v_lshrrev_b32 v171, 4, v162
    v_mul_u32_u24 v171, 18432, v171
    v_and_b32 v172, 15, v162
    v_lshl_add_u32 v171, v172, 4, v171
    v_lshl_add_u32 v157, v161, 8, v171
    v_lshrrev_b32 v171, 5, v0
    v_lshlrev_b32 v171, 4, v171
    v_bfe_u32 v172, v0, 2, 3
    v_add_u32 v171, v171, v172
    v_mul_u32_u24 v171, 480, v171
    v_and_b32 v172, 3, v0
    v_lshl_add_u32 v152, v172, 3, v171
    s_lshl_b32 s36, s28, 6
    s_add_u32 s36, s36, 92160
    v_add_u32 v152, s36, v152
    v_lshlrev_b32 v153, 4, v0
    v_add_u32 v154, 65536, v153
    v_mov_b32 v164, 0
    v_mov_b32 v165, 0
    v_mov_b32 v166, 0
    v_mov_b32 v167, 0
    s_waitcnt vmcnt(15)
    v_dot2_f32_bf16 v164, v100, s44, v164
    v_dot2_f32_bf16 v165, v100, v100, v165
    v_dot2_f32_bf16 v166, v101, s44, v166
    v_dot2_f32_bf16 v167, v101, v101, v167
    v_dot2_f32_bf16 v164, v102, s44, v164
    v_dot2_f32_bf16 v165, v102, v102, v165
    v_dot2_f32_bf16 v166, v103, s44, v166
    v_dot2_f32_bf16 v167, v103, v103, v167
    s_waitcnt vmcnt(14)
    v_dot2_f32_bf16 v164, v104, s44, v164
    v_dot2_f32_bf16 v165, v104, v104, v165
    v_dot2_f32_bf16 v166, v105, s44, v166
    v_dot2_f32_bf16 v167, v105, v105, v167
    v_dot2_f32_bf16 v164, v106, s44, v164
    v_dot2_f32_bf16 v165, v106, v106, v165
    v_dot2_f32_bf16 v166, v107, s44, v166
    v_dot2_f32_bf16 v167, v107, v107, v167
    s_waitcnt vmcnt(13)
    v_dot2_f32_bf16 v164, v108, s44, v164
    v_dot2_f32_bf16 v165, v108, v108, v165
    v_dot2_f32_bf16 v166, v109, s44, v166
    v_dot2_f32_bf16 v167, v109, v109, v167
    v_dot2_f32_bf16 v164, v110, s44, v164
    v_dot2_f32_bf16 v165, v110, v110, v165
    v_dot2_f32_bf16 v166, v111, s44, v166
    v_dot2_f32_bf16 v167, v111, v111, v167
    s_waitcnt vmcnt(12)
    v_dot2_f32_bf16 v164, v112, s44, v164
    v_dot2_f32_bf16 v165, v112, v112, v165
    v_dot2_f32_bf16 v166, v113, s44, v166
    v_dot2_f32_bf16 v167, v113, v113, v167
    v_dot2_f32_bf16 v164, v114, s44, v164
    v_dot2_f32_bf16 v165, v114, v114, v165
    v_dot2_f32_bf16 v166, v115, s44, v166
    v_dot2_f32_bf16 v167, v115, v115, v167
    s_waitcnt vmcnt(11)
    v_dot2_f32_bf16 v164, v116, s44, v164
    v_dot2_f32_bf16 v165, v116, v116, v165
    v_dot2_f32_bf16 v166, v117, s44, v166
    v_dot2_f32_bf16 v167, v117, v117, v167
    v_dot2_f32_bf16 v164, v118, s44, v164
    v_dot2_f32_bf16 v165, v118, v118, v165
    v_dot2_f32_bf16 v166, v119, s44, v166
    v_dot2_f32_bf16 v167, v119, v119, v167
    s_waitcnt vmcnt(10)
    v_dot2_f32_bf16 v164, v120, s44, v164
    v_dot2_f32_bf16 v165, v120, v120, v165
    v_dot2_f32_bf16 v166, v121, s44, v166
    v_dot2_f32_bf16 v167, v121, v121, v167
    v_dot2_f32_bf16 v164, v122, s44, v164
    v_dot2_f32_bf16 v165, v122, v122, v165
    v_dot2_f32_bf16 v166, v123, s44, v166
    v_dot2_f32_bf16 v167, v123, v123, v167
    s_waitcnt vmcnt(9)
    v_dot2_f32_bf16 v164, v124, s44, v164
    v_dot2_f32_bf16 v165, v124, v124, v165
    v_dot2_f32_bf16 v166, v125, s44, v166
    v_dot2_f32_bf16 v167, v125, v125, v167
    v_dot2_f32_bf16 v164, v126, s44, v164
    v_dot2_f32_bf16 v165, v126, v126, v165
    v_dot2_f32_bf16 v166, v127, s44, v166
    v_dot2_f32_bf16 v167, v127, v127, v167
    s_waitcnt vmcnt(8)
    v_dot2_f32_bf16 v164, v128, s44, v164
    v_dot2_f32_bf16 v165, v128, v128, v165
    v_dot2_f32_bf16 v166, v129, s44, v166
    v_dot2_f32_bf16 v167, v129, v129, v167
    v_dot2_f32_bf16 v164, v130, s44, v164
    v_dot2_f32_bf16 v165, v130, v130, v165
    v_dot2_f32_bf16 v166, v131, s44, v166
    v_dot2_f32_bf16 v167, v131, v131, v167
    s_waitcnt vmcnt(7)
    v_dot2_f32_bf16 v164, v132, s44, v164
    v_dot2_f32_bf16 v165, v132, v132, v165
    v_dot2_f32_bf16 v166, v133, s44, v166
    v_dot2_f32_bf16 v167, v133, v133, v167
    v_dot2_f32_bf16 v164, v134, s44, v164
    v_dot2_f32_bf16 v165, v134, v134, v165
    v_dot2_f32_bf16 v166, v135, s44, v166
    v_dot2_f32_bf16 v167, v135, v135, v167
    s_waitcnt vmcnt(6)
    v_dot2_f32_bf16 v164, v136, s44, v164
    v_dot2_f32_bf16 v165, v136, v136, v165
    v_dot2_f32_bf16 v166, v137, s44, v166
    v_dot2_f32_bf16 v167, v137, v137, v167
    v_dot2_f32_bf16 v164, v138, s44, v164
    v_dot2_f32_bf16 v165, v138, v138, v165
    v_dot2_f32_bf16 v166, v139, s44, v166
    v_dot2_f32_bf16 v167, v139, v139, v167
    s_waitcnt vmcnt(5)
    v_dot2_f32_bf16 v164, v140, s44, v164
    v_dot2_f32_bf16 v165, v140, v140, v165
    v_dot2_f32_bf16 v166, v141, s44, v166
    v_dot2_f32_bf16 v167, v141, v141, v167
    v_dot2_f32_bf16 v164, v142, s44, v164
    v_dot2_f32_bf16 v165, v142, v142, v165
    v_dot2_f32_bf16 v166, v143, s44, v166
    v_dot2_f32_bf16 v167, v143, v143, v167
    s_waitcnt vmcnt(4)
    v_dot2_f32_bf16 v164, v144, s44, v164
    v_dot2_f32_bf16 v165, v144, v144, v165
    v_dot2_f32_bf16 v166, v145, s44, v166
    v_dot2_f32_bf16 v167, v145, v145, v167
    v_dot2_f32_bf16 v164, v146, s44, v164
    v_dot2_f32_bf16 v165, v146, v146, v165
    v_dot2_f32_bf16 v166, v147, s44, v166
    v_dot2_f32_bf16 v167, v147, v147, v167
    s_mov_b32 s31, 221184
    s_add_u32 m0, s32, 32768
    s_nop 0
    buffer_load_dwordx4 v150, s[12:15], s31 offen lds
    s_add_u32 m0, s32, 33792
    s_nop 0
    buffer_load_dwordx4 v151, s[12:15], s31 offen lds
    s_mov_b32 s31, 331776
    s_add_u32 m0, s32, 49152
    s_nop 0
    buffer_load_dwordx4 v150, s[12:15], s31 offen lds
    s_add_u32 m0, s32, 50176
    s_nop 0
    buffer_load_dwordx4 v151, s[12:15], s31 offen lds
    s_lshl_b32 s36, s2, 3
    s_add_u32 s36, s36, s28
    s_cmp_ge_u32 s36, 2025
    s_cbranch_scc1 L_k1_kernel_nopf
    s_cmp_ge_u32 s36, 648
    s_cselect_b32 s54, s50, s48
    s_cselect_b32 s55, s51, s49
    s_cselect_b32 s37, 648, 0
    s_cmp_ge_u32 s36, 1296
    s_cselect_b32 s54, s52, s54
    s_cselect_b32 s55, s53, s55
    s_cselect_b32 s37, 1296, s37
    s_cmp_ge_u32 s36, 1944
    s_cselect_b32 s54, s92, s54
    s_cselect_b32 s55, s93, s55
    s_cselect_b32 s37, 1944, s37
    s_sub_u32 s36, s36, s37
    s_lshl_b32 s36, s36, 13
    s_mov_b32 s56, s54
    s_mov_b32 s57, s55
    s_and_b32 s57, s57, 0xffff
    s_mov_b32 s58, 5308416
    s_mov_b32 s59, 0x00020000
    v_lshlrev_b32 v180, 7, v0
    buffer_load_dword v181, v180, s[56:59], s36 offen
L_k1_kernel_nopf:
    v_add_f32 v164, v164, v166
    v_add_f32 v165, v165, v167
    ds_bpermute_b32 v166, v168, v164
    ds_bpermute_b32 v167, v168, v165
    s_waitcnt lgkmcnt(0)
    v_add_f32 v164, v164, v166
    v_add_f32 v165, v165, v167
    ds_bpermute_b32 v166, v169, v164
    ds_bpermute_b32 v167, v169, v165
    ds_bpermute_b32 v171, v170, v164
    ds_bpermute_b32 v172, v170, v165
    s_waitcnt lgkmcnt(0)
    v_add_f32 v164, v164, v166
    v_add_f32 v165, v165, v167
    v_add_f32 v164, v164, v171
    v_add_f32 v165, v165, v172
    v_mul_f32 v164, 987991609, v164
    v_mul_f32 v165, 987991609, v165
    v_fma_f32 v165, -v164, v164, v165
    v_max_f32 v165, 0, v165
    v_cvt_pk_bf16_f32 v155, v164, v164
    v_lshlrev_b32 v155, 16, v155
    v_cvt_pk_bf16_f32 v165, v165, v165
    v_lshlrev_b32 v165, 16, v165
    v_add_f32 v165, 925353388, v165
    v_cvt_pk_bf16_f32 v165, v165, v165
    v_lshlrev_b32 v165, 16, v165
    v_sqrt_f32 v165, v165
    s_nop 0
    v_cvt_pk_bf16_f32 v165, v165, v165
    v_lshlrev_b32 v165, 16, v165
    v_rcp_f32 v156, v165
    s_nop 0
    v_lshlrev_b32 v172, 16, v100
    v_and_b32 v173, 0xffff0000, v100
    v_lshlrev_b32 v174, 16, v101
    v_and_b32 v175, 0xffff0000, v101
    v_lshlrev_b32 v176, 16, v102
    v_and_b32 v177, 0xffff0000, v102
    v_lshlrev_b32 v178, 16, v103
    v_and_b32 v179, 0xffff0000, v103
    v_sub_f32 v172, v172, v155
    v_sub_f32 v173, v173, v155
    v_sub_f32 v174, v174, v155
    v_sub_f32 v175, v175, v155
    v_sub_f32 v176, v176, v155
    v_sub_f32 v177, v177, v155
    v_sub_f32 v178, v178, v155
    v_sub_f32 v179, v179, v155
    v_cvt_pk_bf16_f32 v172, v172, v173
    v_cvt_pk_bf16_f32 v174, v174, v175
    v_cvt_pk_bf16_f32 v176, v176, v177
    v_cvt_pk_bf16_f32 v178, v178, v179
    v_and_b32 v173, 0xffff0000, v172
    v_lshlrev_b32 v172, 16, v172
    v_and_b32 v175, 0xffff0000, v174
    v_lshlrev_b32 v174, 16, v174
    v_and_b32 v177, 0xffff0000, v176
    v_lshlrev_b32 v176, 16, v176
    v_and_b32 v179, 0xffff0000, v178
    v_lshlrev_b32 v178, 16, v178
    v_mul_f32 v172, v172, v156
    v_mul_f32 v173, v173, v156
    v_mul_f32 v174, v174, v156
    v_mul_f32 v175, v175, v156
    v_mul_f32 v176, v176, v156
    v_mul_f32 v177, v177, v156
    v_mul_f32 v178, v178, v156
    v_mul_f32 v179, v179, v156
    v_cvt_pk_bf16_f32 v100, v172, v173
    v_cvt_pk_bf16_f32 v101, v174, v175
    v_cvt_pk_bf16_f32 v102, v176, v177
    v_cvt_pk_bf16_f32 v103, v178, v179
    ds_write_b128 v157, v[100:103] offset:0
    v_lshlrev_b32 v172, 16, v104
    v_and_b32 v173, 0xffff0000, v104
    v_lshlrev_b32 v174, 16, v105
    v_and_b32 v175, 0xffff0000, v105
    v_lshlrev_b32 v176, 16, v106
    v_and_b32 v177, 0xffff0000, v106
    v_lshlrev_b32 v178, 16, v107
    v_and_b32 v179, 0xffff0000, v107
    v_sub_f32 v172, v172, v155
    v_sub_f32 v173, v173, v155
    v_sub_f32 v174, v174, v155
    v_sub_f32 v175, v175, v155
    v_sub_f32 v176, v176, v155
    v_sub_f32 v177, v177, v155
    v_sub_f32 v178, v178, v155
    v_sub_f32 v179, v179, v155
    v_cvt_pk_bf16_f32 v172, v172, v173
    v_cvt_pk_bf16_f32 v174, v174, v175
    v_cvt_pk_bf16_f32 v176, v176, v177
    v_cvt_pk_bf16_f32 v178, v178, v179
    v_and_b32 v173, 0xffff0000, v172
    v_lshlrev_b32 v172, 16, v172
    v_and_b32 v175, 0xffff0000, v174
    v_lshlrev_b32 v174, 16, v174
    v_and_b32 v177, 0xffff0000, v176
    v_lshlrev_b32 v176, 16, v176
    v_and_b32 v179, 0xffff0000, v178
    v_lshlrev_b32 v178, 16, v178
    v_mul_f32 v172, v172, v156
    v_mul_f32 v173, v173, v156
    v_mul_f32 v174, v174, v156
    v_mul_f32 v175, v175, v156
    v_mul_f32 v176, v176, v156
    v_mul_f32 v177, v177, v156
    v_mul_f32 v178, v178, v156
    v_mul_f32 v179, v179, v156
    v_cvt_pk_bf16_f32 v104, v172, v173
    v_cvt_pk_bf16_f32 v105, v174, v175
    v_cvt_pk_bf16_f32 v106, v176, v177
    v_cvt_pk_bf16_f32 v107, v178, v179
    ds_write_b128 v157, v[104:107] offset:1536
    v_lshlrev_b32 v172, 16, v108
    v_and_b32 v173, 0xffff0000, v108
    v_lshlrev_b32 v174, 16, v109
    v_and_b32 v175, 0xffff0000, v109
    v_lshlrev_b32 v176, 16, v110
    v_and_b32 v177, 0xffff0000, v110
    v_lshlrev_b32 v178, 16, v111
    v_and_b32 v179, 0xffff0000, v111
    v_sub_f32 v172, v172, v155
    v_sub_f32 v173, v173, v155
    v_sub_f32 v174, v174, v155
    v_sub_f32 v175, v175, v155
    v_sub_f32 v176, v176, v155
    v_sub_f32 v177, v177, v155
    v_sub_f32 v178, v178, v155
    v_sub_f32 v179, v179, v155
    v_cvt_pk_bf16_f32 v172, v172, v173
    v_cvt_pk_bf16_f32 v174, v174, v175
    v_cvt_pk_bf16_f32 v176, v176, v177
    v_cvt_pk_bf16_f32 v178, v178, v179
    v_and_b32 v173, 0xffff0000, v172
    v_lshlrev_b32 v172, 16, v172
    v_and_b32 v175, 0xffff0000, v174
    v_lshlrev_b32 v174, 16, v174
    v_and_b32 v177, 0xffff0000, v176
    v_lshlrev_b32 v176, 16, v176
    v_and_b32 v179, 0xffff0000, v178
    v_lshlrev_b32 v178, 16, v178
    v_mul_f32 v172, v172, v156
    v_mul_f32 v173, v173, v156
    v_mul_f32 v174, v174, v156
    v_mul_f32 v175, v175, v156
    v_mul_f32 v176, v176, v156
    v_mul_f32 v177, v177, v156
    v_mul_f32 v178, v178, v156
    v_mul_f32 v179, v179, v156
    v_cvt_pk_bf16_f32 v108, v172, v173
    v_cvt_pk_bf16_f32 v109, v174, v175
    v_cvt_pk_bf16_f32 v110, v176, v177
    v_cvt_pk_bf16_f32 v111, v178, v179
    ds_write_b128 v157, v[108:111] offset:3072
    v_lshlrev_b32 v172, 16, v112
    v_and_b32 v173, 0xffff0000, v112
    v_lshlrev_b32 v174, 16, v113
    v_and_b32 v175, 0xffff0000, v113
    v_lshlrev_b32 v176, 16, v114
    v_and_b32 v177, 0xffff0000, v114
    v_lshlrev_b32 v178, 16, v115
    v_and_b32 v179, 0xffff0000, v115
    v_sub_f32 v172, v172, v155
    v_sub_f32 v173, v173, v155
    v_sub_f32 v174, v174, v155
    v_sub_f32 v175, v175, v155
    v_sub_f32 v176, v176, v155
    v_sub_f32 v177, v177, v155
    v_sub_f32 v178, v178, v155
    v_sub_f32 v179, v179, v155
    v_cvt_pk_bf16_f32 v172, v172, v173
    v_cvt_pk_bf16_f32 v174, v174, v175
    v_cvt_pk_bf16_f32 v176, v176, v177
    v_cvt_pk_bf16_f32 v178, v178, v179
    v_and_b32 v173, 0xffff0000, v172
    v_lshlrev_b32 v172, 16, v172
    v_and_b32 v175, 0xffff0000, v174
    v_lshlrev_b32 v174, 16, v174
    v_and_b32 v177, 0xffff0000, v176
    v_lshlrev_b32 v176, 16, v176
    v_and_b32 v179, 0xffff0000, v178
    v_lshlrev_b32 v178, 16, v178
    v_mul_f32 v172, v172, v156
    v_mul_f32 v173, v173, v156
    v_mul_f32 v174, v174, v156
    v_mul_f32 v175, v175, v156
    v_mul_f32 v176, v176, v156
    v_mul_f32 v177, v177, v156
    v_mul_f32 v178, v178, v156
    v_mul_f32 v179, v179, v156
    v_cvt_pk_bf16_f32 v112, v172, v173
    v_cvt_pk_bf16_f32 v113, v174, v175
    v_cvt_pk_bf16_f32 v114, v176, v177
    v_cvt_pk_bf16_f32 v115, v178, v179
    ds_write_b128 v157, v[112:115] offset:4608
    v_lshlrev_b32 v172, 16, v116
    v_and_b32 v173, 0xffff0000, v116
    v_lshlrev_b32 v174, 16, v117
    v_and_b32 v175, 0xffff0000, v117
    v_lshlrev_b32 v176, 16, v118
    v_and_b32 v177, 0xffff0000, v118
    v_lshlrev_b32 v178, 16, v119
    v_and_b32 v179, 0xffff0000, v119
    v_sub_f32 v172, v172, v155
    v_sub_f32 v173, v173, v155
    v_sub_f32 v174, v174, v155
    v_sub_f32 v175, v175, v155
    v_sub_f32 v176, v176, v155
    v_sub_f32 v177, v177, v155
    v_sub_f32 v178, v178, v155
    v_sub_f32 v179, v179, v155
    v_cvt_pk_bf16_f32 v172, v172, v173
    v_cvt_pk_bf16_f32 v174, v174, v175
    v_cvt_pk_bf16_f32 v176, v176, v177
    v_cvt_pk_bf16_f32 v178, v178, v179
    v_and_b32 v173, 0xffff0000, v172
    v_lshlrev_b32 v172, 16, v172
    v_and_b32 v175, 0xffff0000, v174
    v_lshlrev_b32 v174, 16, v174
    v_and_b32 v177, 0xffff0000, v176
    v_lshlrev_b32 v176, 16, v176
    v_and_b32 v179, 0xffff0000, v178
    v_lshlrev_b32 v178, 16, v178
    v_mul_f32 v172, v172, v156
    v_mul_f32 v173, v173, v156
    v_mul_f32 v174, v174, v156
    v_mul_f32 v175, v175, v156
    v_mul_f32 v176, v176, v156
    v_mul_f32 v177, v177, v156
    v_mul_f32 v178, v178, v156
    v_mul_f32 v179, v179, v156
    v_cvt_pk_bf16_f32 v116, v172, v173
    v_cvt_pk_bf16_f32 v117, v174, v175
    v_cvt_pk_bf16_f32 v118, v176, v177
    v_cvt_pk_bf16_f32 v119, v178, v179
    ds_write_b128 v157, v[116:119] offset:6144
    v_lshlrev_b32 v172, 16, v120
    v_and_b32 v173, 0xffff0000, v120
    v_lshlrev_b32 v174, 16, v121
    v_and_b32 v175, 0xffff0000, v121
    v_lshlrev_b32 v176, 16, v122
    v_and_b32 v177, 0xffff0000, v122
    v_lshlrev_b32 v178, 16, v123
    v_and_b32 v179, 0xffff0000, v123
    v_sub_f32 v172, v172, v155
    v_sub_f32 v173, v173, v155
    v_sub_f32 v174, v174, v155
    v_sub_f32 v175, v175, v155
    v_sub_f32 v176, v176, v155
    v_sub_f32 v177, v177, v155
    v_sub_f32 v178, v178, v155
    v_sub_f32 v179, v179, v155
    v_cvt_pk_bf16_f32 v172, v172, v173
    v_cvt_pk_bf16_f32 v174, v174, v175
    v_cvt_pk_bf16_f32 v176, v176, v177
    v_cvt_pk_bf16_f32 v178, v178, v179
    v_and_b32 v173, 0xffff0000, v172
    v_lshlrev_b32 v172, 16, v172
    v_and_b32 v175, 0xffff0000, v174
    v_lshlrev_b32 v174, 16, v174
    v_and_b32 v177, 0xffff0000, v176
    v_lshlrev_b32 v176, 16, v176
    v_and_b32 v179, 0xffff0000, v178
    v_lshlrev_b32 v178, 16, v178
    v_mul_f32 v172, v172, v156
    v_mul_f32 v173, v173, v156
    v_mul_f32 v174, v174, v156
    v_mul_f32 v175, v175, v156
    v_mul_f32 v176, v176, v156
    v_mul_f32 v177, v177, v156
    v_mul_f32 v178, v178, v156
    v_mul_f32 v179, v179, v156
    v_cvt_pk_bf16_f32 v120, v172, v173
    v_cvt_pk_bf16_f32 v121, v174, v175
    v_cvt_pk_bf16_f32 v122, v176, v177
    v_cvt_pk_bf16_f32 v123, v178, v179
    ds_write_b128 v157, v[120:123] offset:7680
    v_lshlrev_b32 v172, 16, v124
    v_and_b32 v173, 0xffff0000, v124
    v_lshlrev_b32 v174, 16, v125
    v_and_b32 v175, 0xffff0000, v125
    v_lshlrev_b32 v176, 16, v126
    v_and_b32 v177, 0xffff0000, v126
    v_lshlrev_b32 v178, 16, v127
    v_and_b32 v179, 0xffff0000, v127
    v_sub_f32 v172, v172, v155
    v_sub_f32 v173, v173, v155
    v_sub_f32 v174, v174, v155
    v_sub_f32 v175, v175, v155
    v_sub_f32 v176, v176, v155
    v_sub_f32 v177, v177, v155
    v_sub_f32 v178, v178, v155
    v_sub_f32 v179, v179, v155
    v_cvt_pk_bf16_f32 v172, v172, v173
    v_cvt_pk_bf16_f32 v174, v174, v175
    v_cvt_pk_bf16_f32 v176, v176, v177
    v_cvt_pk_bf16_f32 v178, v178, v179
    v_and_b32 v173, 0xffff0000, v172
    v_lshlrev_b32 v172, 16, v172
    v_and_b32 v175, 0xffff0000, v174
    v_lshlrev_b32 v174, 16, v174
    v_and_b32 v177, 0xffff0000, v176
    v_lshlrev_b32 v176, 16, v176
    v_and_b32 v179, 0xffff0000, v178
    v_lshlrev_b32 v178, 16, v178
    v_mul_f32 v172, v172, v156
    v_mul_f32 v173, v173, v156
    v_mul_f32 v174, v174, v156
    v_mul_f32 v175, v175, v156
    v_mul_f32 v176, v176, v156
    v_mul_f32 v177, v177, v156
    v_mul_f32 v178, v178, v156
    v_mul_f32 v179, v179, v156
    v_cvt_pk_bf16_f32 v124, v172, v173
    v_cvt_pk_bf16_f32 v125, v174, v175
    v_cvt_pk_bf16_f32 v126, v176, v177
    v_cvt_pk_bf16_f32 v127, v178, v179
    ds_write_b128 v157, v[124:127] offset:9216
    v_lshlrev_b32 v172, 16, v128
    v_and_b32 v173, 0xffff0000, v128
    v_lshlrev_b32 v174, 16, v129
    v_and_b32 v175, 0xffff0000, v129
    v_lshlrev_b32 v176, 16, v130
    v_and_b32 v177, 0xffff0000, v130
    v_lshlrev_b32 v178, 16, v131
    v_and_b32 v179, 0xffff0000, v131
    v_sub_f32 v172, v172, v155
    v_sub_f32 v173, v173, v155
    v_sub_f32 v174, v174, v155
    v_sub_f32 v175, v175, v155
    v_sub_f32 v176, v176, v155
    v_sub_f32 v177, v177, v155
    v_sub_f32 v178, v178, v155
    v_sub_f32 v179, v179, v155
    v_cvt_pk_bf16_f32 v172, v172, v173
    v_cvt_pk_bf16_f32 v174, v174, v175
    v_cvt_pk_bf16_f32 v176, v176, v177
    v_cvt_pk_bf16_f32 v178, v178, v179
    v_and_b32 v173, 0xffff0000, v172
    v_lshlrev_b32 v172, 16, v172
    v_and_b32 v175, 0xffff0000, v174
    v_lshlrev_b32 v174, 16, v174
    v_and_b32 v177, 0xffff0000, v176
    v_lshlrev_b32 v176, 16, v176
    v_and_b32 v179, 0xffff0000, v178
    v_lshlrev_b32 v178, 16, v178
    v_mul_f32 v172, v172, v156
    v_mul_f32 v173, v173, v156
    v_mul_f32 v174, v174, v156
    v_mul_f32 v175, v175, v156
    v_mul_f32 v176, v176, v156
    v_mul_f32 v177, v177, v156
    v_mul_f32 v178, v178, v156
    v_mul_f32 v179, v179, v156
    v_cvt_pk_bf16_f32 v128, v172, v173
    v_cvt_pk_bf16_f32 v129, v174, v175
    v_cvt_pk_bf16_f32 v130, v176, v177
    v_cvt_pk_bf16_f32 v131, v178, v179
    ds_write_b128 v157, v[128:131] offset:10752
    v_lshlrev_b32 v172, 16, v132
    v_and_b32 v173, 0xffff0000, v132
    v_lshlrev_b32 v174, 16, v133
    v_and_b32 v175, 0xffff0000, v133
    v_lshlrev_b32 v176, 16, v134
    v_and_b32 v177, 0xffff0000, v134
    v_lshlrev_b32 v178, 16, v135
    v_and_b32 v179, 0xffff0000, v135
    v_sub_f32 v172, v172, v155
    v_sub_f32 v173, v173, v155
    v_sub_f32 v174, v174, v155
    v_sub_f32 v175, v175, v155
    v_sub_f32 v176, v176, v155
    v_sub_f32 v177, v177, v155
    v_sub_f32 v178, v178, v155
    v_sub_f32 v179, v179, v155
    v_cvt_pk_bf16_f32 v172, v172, v173
    v_cvt_pk_bf16_f32 v174, v174, v175
    v_cvt_pk_bf16_f32 v176, v176, v177
    v_cvt_pk_bf16_f32 v178, v178, v179
    v_and_b32 v173, 0xffff0000, v172
    v_lshlrev_b32 v172, 16, v172
    v_and_b32 v175, 0xffff0000, v174
    v_lshlrev_b32 v174, 16, v174
    v_and_b32 v177, 0xffff0000, v176
    v_lshlrev_b32 v176, 16, v176
    v_and_b32 v179, 0xffff0000, v178
    v_lshlrev_b32 v178, 16, v178
    v_mul_f32 v172, v172, v156
    v_mul_f32 v173, v173, v156
    v_mul_f32 v174, v174, v156
    v_mul_f32 v175, v175, v156
    v_mul_f32 v176, v176, v156
    v_mul_f32 v177, v177, v156
    v_mul_f32 v178, v178, v156
    v_mul_f32 v179, v179, v156
    v_cvt_pk_bf16_f32 v132, v172, v173
    v_cvt_pk_bf16_f32 v133, v174, v175
    v_cvt_pk_bf16_f32 v134, v176, v177
    v_cvt_pk_bf16_f32 v135, v178, v179
    ds_write_b128 v157, v[132:135] offset:12288
    v_lshlrev_b32 v172, 16, v136
    v_and_b32 v173, 0xffff0000, v136
    v_lshlrev_b32 v174, 16, v137
    v_and_b32 v175, 0xffff0000, v137
    v_lshlrev_b32 v176, 16, v138
    v_and_b32 v177, 0xffff0000, v138
    v_lshlrev_b32 v178, 16, v139
    v_and_b32 v179, 0xffff0000, v139
    v_sub_f32 v172, v172, v155
    v_sub_f32 v173, v173, v155
    v_sub_f32 v174, v174, v155
    v_sub_f32 v175, v175, v155
    v_sub_f32 v176, v176, v155
    v_sub_f32 v177, v177, v155
    v_sub_f32 v178, v178, v155
    v_sub_f32 v179, v179, v155
    v_cvt_pk_bf16_f32 v172, v172, v173
    v_cvt_pk_bf16_f32 v174, v174, v175
    v_cvt_pk_bf16_f32 v176, v176, v177
    v_cvt_pk_bf16_f32 v178, v178, v179
    v_and_b32 v173, 0xffff0000, v172
    v_lshlrev_b32 v172, 16, v172
    v_and_b32 v175, 0xffff0000, v174
    v_lshlrev_b32 v174, 16, v174
    v_and_b32 v177, 0xffff0000, v176
    v_lshlrev_b32 v176, 16, v176
    v_and_b32 v179, 0xffff0000, v178
    v_lshlrev_b32 v178, 16, v178
    v_mul_f32 v172, v172, v156
    v_mul_f32 v173, v173, v156
    v_mul_f32 v174, v174, v156
    v_mul_f32 v175, v175, v156
    v_mul_f32 v176, v176, v156
    v_mul_f32 v177, v177, v156
    v_mul_f32 v178, v178, v156
    v_mul_f32 v179, v179, v156
    v_cvt_pk_bf16_f32 v136, v172, v173
    v_cvt_pk_bf16_f32 v137, v174, v175
    v_cvt_pk_bf16_f32 v138, v176, v177
    v_cvt_pk_bf16_f32 v139, v178, v179
    ds_write_b128 v157, v[136:139] offset:13824
    v_lshlrev_b32 v172, 16, v140
    v_and_b32 v173, 0xffff0000, v140
    v_lshlrev_b32 v174, 16, v141
    v_and_b32 v175, 0xffff0000, v141
    v_lshlrev_b32 v176, 16, v142
    v_and_b32 v177, 0xffff0000, v142
    v_lshlrev_b32 v178, 16, v143
    v_and_b32 v179, 0xffff0000, v143
    v_sub_f32 v172, v172, v155
    v_sub_f32 v173, v173, v155
    v_sub_f32 v174, v174, v155
    v_sub_f32 v175, v175, v155
    v_sub_f32 v176, v176, v155
    v_sub_f32 v177, v177, v155
    v_sub_f32 v178, v178, v155
    v_sub_f32 v179, v179, v155
    v_cvt_pk_bf16_f32 v172, v172, v173
    v_cvt_pk_bf16_f32 v174, v174, v175
    v_cvt_pk_bf16_f32 v176, v176, v177
    v_cvt_pk_bf16_f32 v178, v178, v179
    v_and_b32 v173, 0xffff0000, v172
    v_lshlrev_b32 v172, 16, v172
    v_and_b32 v175, 0xffff0000, v174
    v_lshlrev_b32 v174, 16, v174
    v_and_b32 v177, 0xffff0000, v176
    v_lshlrev_b32 v176, 16, v176
    v_and_b32 v179, 0xffff0000, v178
    v_lshlrev_b32 v178, 16, v178
    v_mul_f32 v172, v172, v156
    v_mul_f32 v173, v173, v156
    v_mul_f32 v174, v174, v156
    v_mul_f32 v175, v175, v156
    v_mul_f32 v176, v176, v156
    v_mul_f32 v177, v177, v156
    v_mul_f32 v178, v178, v156
    v_mul_f32 v179, v179, v156
    v_cvt_pk_bf16_f32 v140, v172, v173
    v_cvt_pk_bf16_f32 v141, v174, v175
    v_cvt_pk_bf16_f32 v142, v176, v177
    v_cvt_pk_bf16_f32 v143, v178, v179
    ds_write_b128 v157, v[140:143] offset:15360
    v_lshlrev_b32 v172, 16, v144
    v_and_b32 v173, 0xffff0000, v144
    v_lshlrev_b32 v174, 16, v145
    v_and_b32 v175, 0xffff0000, v145
    v_lshlrev_b32 v176, 16, v146
    v_and_b32 v177, 0xffff0000, v146
    v_lshlrev_b32 v178, 16, v147
    v_and_b32 v179, 0xffff0000, v147
    v_sub_f32 v172, v172, v155
    v_sub_f32 v173, v173, v155
    v_sub_f32 v174, v174, v155
    v_sub_f32 v175, v175, v155
    v_sub_f32 v176, v176, v155
    v_sub_f32 v177, v177, v155
    v_sub_f32 v178, v178, v155
    v_sub_f32 v179, v179, v155
    v_cvt_pk_bf16_f32 v172, v172, v173
    v_cvt_pk_bf16_f32 v174, v174, v175
    v_cvt_pk_bf16_f32 v176, v176, v177
    v_cvt_pk_bf16_f32 v178, v178, v179
    v_and_b32 v173, 0xffff0000, v172
    v_lshlrev_b32 v172, 16, v172
    v_and_b32 v175, 0xffff0000, v174
    v_lshlrev_b32 v174, 16, v174
    v_and_b32 v177, 0xffff0000, v176
    v_lshlrev_b32 v176, 16, v176
    v_and_b32 v179, 0xffff0000, v178
    v_lshlrev_b32 v178, 16, v178
    v_mul_f32 v172, v172, v156
    v_mul_f32 v173, v173, v156
    v_mul_f32 v174, v174, v156
    v_mul_f32 v175, v175, v156
    v_mul_f32 v176, v176, v156
    v_mul_f32 v177, v177, v156
    v_mul_f32 v178, v178, v156
    v_mul_f32 v179, v179, v156
    v_cvt_pk_bf16_f32 v144, v172, v173
    v_cvt_pk_bf16_f32 v145, v174, v175
    v_cvt_pk_bf16_f32 v146, v176, v177
    v_cvt_pk_bf16_f32 v147, v178, v179
    ds_write_b128 v157, v[144:147] offset:16896
    s_waitcnt vmcnt(6)
    s_waitcnt lgkmcnt(0)
    s_barrier
    ds_read_b128 v[44:47], v153 offset:0
    ds_read_b128 v[48:51], v153 offset:18432
    ds_read_b128 v[52:55], v153 offset:36864
    ds_read_b128 v[56:59], v153 offset:55296
    ds_read_b128 v[60:63], v154 offset:8192
    ds_read_b64_tr_b16 v[84:85], v152 offset:0
    ds_read_b64_tr_b16 v[86:87], v152 offset:3840
    ds_read_b64_tr_b16 v[88:89], v152 offset:32
    ds_read_b64_tr_b16 v[90:91], v152 offset:3872
    ds_read_b128 v[64:67], v153 offset:1024
    ds_read_b128 v[68:71], v153 offset:19456
    ds_read_b128 v[72:75], v153 offset:37888
    ds_read_b128 v[76:79], v153 offset:56320
    ds_read_b128 v[80:83], v154 offset:9216
    s_waitcnt lgkmcnt(7)
    v_mfma_f32_16x16x32_bf16 v[4:7], v[84:87], v[44:47], 0
    v_mfma_f32_16x16x32_bf16 v[12:15], v[84:87], v[48:51], 0
    v_mfma_f32_16x16x32_bf16 v[20:23], v[84:87], v[52:55], 0
    v_mfma_f32_16x16x32_bf16 v[28:31], v[84:87], v[56:59], 0
    v_mfma_f32_16x16x32_bf16 v[36:39], v[84:87], v[60:63], 0
    s_waitcnt lgkmcnt(5)
    v_mfma_f32_16x16x32_bf16 v[8:11], v[88:91], v[44:47], 0
    v_mfma_f32_16x16x32_bf16 v[16:19], v[88:91], v[48:51], 0
    v_mfma_f32_16x16x32_bf16 v[24:27], v[88:91], v[52:55], 0
    v_mfma_f32_16x16x32_bf16 v[32:35], v[88:91], v[56:59], 0
    v_mfma_f32_16x16x32_bf16 v[40:43], v[88:91], v[60:63], 0
    s_waitcnt vmcnt(4)
    s_barrier
    ds_read_b64_tr_b16 v[92:93], v152 offset:16384
    ds_read_b64_tr_b16 v[94:95], v152 offset:20224
    ds_read_b64_tr_b16 v[96:97], v152 offset:16416
    ds_read_b64_tr_b16 v[98:99], v152 offset:20256
    s_mov_b32 s31, 442368
    s_add_u32 m0, s32, 0
    s_nop 0
    buffer_load_dwordx4 v150, s[12:15], s31 offen lds
    s_add_u32 m0, s32, 1024
    s_nop 0
    buffer_load_dwordx4 v151, s[12:15], s31 offen lds
    ds_read_b128 v[44:47], v153 offset:2048
    ds_read_b128 v[48:51], v153 offset:20480
    ds_read_b128 v[52:55], v153 offset:38912
    ds_read_b128 v[56:59], v153 offset:57344
    ds_read_b128 v[60:63], v154 offset:10240
    s_waitcnt lgkmcnt(7)
    v_mfma_f32_16x16x32_bf16 v[4:7], v[92:95], v[64:67], v[4:7]
    v_mfma_f32_16x16x32_bf16 v[12:15], v[92:95], v[68:71], v[12:15]
    v_mfma_f32_16x16x32_bf16 v[20:23], v[92:95], v[72:75], v[20:23]
    v_mfma_f32_16x16x32_bf16 v[28:31], v[92:95], v[76:79], v[28:31]
    v_mfma_f32_16x16x32_bf16 v[36:39], v[92:95], v[80:83], v[36:39]
    s_waitcnt lgkmcnt(5)
    v_mfma_f32_16x16x32_bf16 v[8:11], v[96:99], v[64:67], v[8:11]
    v_mfma_f32_16x16x32_bf16 v[16:19], v[96:99], v[68:71], v[16:19]
    v_mfma_f32_16x16x32_bf16 v[24:27], v[96:99], v[72:75], v[24:27]
    v_mfma_f32_16x16x32_bf16 v[32:35], v[96:99], v[76:79], v[32:35]
    v_mfma_f32_16x16x32_bf16 v[40:43], v[96:99], v[80:83], v[40:43]
    s_waitcnt vmcnt(4)
    s_barrier
    ds_read_b64_tr_b16 v[84:85], v152 offset:32768
    ds_read_b64_tr_b16 v[86:87], v152 offset:36608
    ds_read_b64_tr_b16 v[88:89], v152 offset:32800
    ds_read_b64_tr_b16 v[90:91], v152 offset:36640
    s_mov_b32 s31, 552960
    s_add_u32 m0, s32, 16384
    s_nop 0
    buffer_load_dwordx4 v150, s[12:15], s31 offen lds
    s_add_u32 m0, s32, 17408
    s_nop 0
    buffer_load_dwordx4 v151, s[12:15], s31 offen lds
    ds_read_b128 v[64:67], v153 offset:3072
    ds_read_b128 v[68:71], v153 offset:21504
    ds_read_b128 v[72:75], v153 offset:39936
    ds_read_b128 v[76:79], v153 offset:58368
    ds_read_b128 v[80:83], v154 offset:11264
    s_waitcnt lgkmcnt(7)
    v_mfma_f32_16x16x32_bf16 v[4:7], v[84:87], v[44:47], v[4:7]
    v_mfma_f32_16x16x32_bf16 v[12:15], v[84:87], v[48:51], v[12:15]
    v_mfma_f32_16x16x32_bf16 v[20:23], v[84:87], v[52:55], v[20:23]
    v_mfma_f32_16x16x32_bf16 v[28:31], v[84:87], v[56:59], v[28:31]
    v_mfma_f32_16x16x32_bf16 v[36:39], v[84:87], v[60:63], v[36:39]
    s_waitcnt lgkmcnt(5)
    v_mfma_f32_16x16x32_bf16 v[8:11], v[88:91], v[44:47], v[8:11]
    v_mfma_f32_16x16x32_bf16 v[16:19], v[88:91], v[48:51], v[16:19]
    v_mfma_f32_16x16x32_bf16 v[24:27], v[88:91], v[52:55], v[24:27]
    v_mfma_f32_16x16x32_bf16 v[32:35], v[88:91], v[56:59], v[32:35]
    v_mfma_f32_16x16x32_bf16 v[40:43], v[88:91], v[60:63], v[40:43]
    s_waitcnt vmcnt(4)
    s_barrier
    ds_read_b64_tr_b16 v[92:93], v152 offset:49152
    ds_read_b64_tr_b16 v[94:95], v152 offset:52992
    ds_read_b64_tr_b16 v[96:97], v152 offset:49184
    ds_read_b64_tr_b16 v[98:99], v152 offset:53024
    s_mov_b32 s31, 663552
    s_add_u32 m0, s32, 32768
    s_nop 0
    buffer_load_dwordx4 v150, s[12:15], s31 offen lds
    s_add_u32 m0, s32, 33792
    s_nop 0
    buffer_load_dwordx4 v151, s[12:15], s31 offen lds
    ds_read_b128 v[44:47], v153 offset:4096
    ds_read_b128 v[48:51], v153 offset:22528
    ds_read_b128 v[52:55], v153 offset:40960
    ds_read_b128 v[56:59], v153 offset:59392
    ds_read_b128 v[60:63], v154 offset:12288
    s_waitcnt lgkmcnt(7)
    v_mfma_f32_16x16x32_bf16 v[4:7], v[92:95], v[64:67], v[4:7]
    v_mfma_f32_16x16x32_bf16 v[12:15], v[92:95], v[68:71], v[12:15]
    v_mfma_f32_16x16x32_bf16 v[20:23], v[92:95], v[72:75], v[20:23]
    v_mfma_f32_16x16x32_bf16 v[28:31], v[92:95], v[76:79], v[28:31]
    v_mfma_f32_16x16x32_bf16 v[36:39], v[92:95], v[80:83], v[36:39]
    s_waitcnt lgkmcnt(5)
    v_mfma_f32_16x16x32_bf16 v[8:11], v[96:99], v[64:67], v[8:11]
    v_mfma_f32_16x16x32_bf16 v[16:19], v[96:99], v[68:71], v[16:19]
    v_mfma_f32_16x16x32_bf16 v[24:27], v[96:99], v[72:75], v[24:27]
    v_mfma_f32_16x16x32_bf16 v[32:35], v[96:99], v[76:79], v[32:35]
    v_mfma_f32_16x16x32_bf16 v[40:43], v[96:99], v[80:83], v[40:43]
    s_waitcnt vmcnt(4)
    s_barrier
    ds_read_b64_tr_b16 v[84:85], v152 offset:0
    ds_read_b64_tr_b16 v[86:87], v152 offset:3840
    ds_read_b64_tr_b16 v[88:89], v152 offset:32
    ds_read_b64_tr_b16 v[90:91], v152 offset:3872
    s_mov_b32 s31, 774144
    s_add_u32 m0, s32, 49152
    s_nop 0
    buffer_load_dwordx4 v150, s[12:15], s31 offen lds
    s_add_u32 m0, s32, 50176
    s_nop 0
    buffer_load_dwordx4 v151, s[12:15], s31 offen lds
    ds_read_b128 v[64:67], v153 offset:5120
    ds_read_b128 v[68:71], v153 offset:23552
    ds_read_b128 v[72:75], v153 offset:41984
    ds_read_b128 v[76:79], v153 offset:60416
    ds_read_b128 v[80:83], v154 offset:13312
    s_waitcnt lgkmcnt(7)
    v_mfma_f32_16x16x32_bf16 v[4:7], v[84:87], v[44:47], v[4:7]
    v_mfma_f32_16x16x32_bf16 v[12:15], v[84:87], v[48:51], v[12:15]
    v_mfma_f32_16x16x32_bf16 v[20:23], v[84:87], v[52:55], v[20:23]
    v_mfma_f32_16x16x32_bf16 v[28:31], v[84:87], v[56:59], v[28:31]
    v_mfma_f32_16x16x32_bf16 v[36:39], v[84:87], v[60:63], v[36:39]
    s_waitcnt lgkmcnt(5)
    v_mfma_f32_16x16x32_bf16 v[8:11], v[88:91], v[44:47], v[8:11]
    v_mfma_f32_16x16x32_bf16 v[16:19], v[88:91], v[48:51], v[16:19]
    v_mfma_f32_16x16x32_bf16 v[24:27], v[88:91], v[52:55], v[24:27]
    v_mfma_f32_16x16x32_bf16 v[32:35], v[88:91], v[56:59], v[32:35]
    v_mfma_f32_16x16x32_bf16 v[40:43], v[88:91], v[60:63], v[40:43]
    s_waitcnt vmcnt(4)
    s_barrier
    ds_read_b64_tr_b16 v[92:93], v152 offset:16384
    ds_read_b64_tr_b16 v[94:95], v152 offset:20224
    ds_read_b64_tr_b16 v[96:97], v152 offset:16416
    ds_read_b64_tr_b16 v[98:99], v152 offset:20256
    s_mov_b32 s31, 884736
    s_add_u32 m0, s32, 0
    s_nop 0
    buffer_load_dwordx4 v150, s[12:15], s31 offen lds
    s_add_u32 m0, s32, 1024
    s_nop 0
    buffer_load_dwordx4 v151, s[12:15], s31 offen lds
    ds_read_b128 v[44:47], v153 offset:6144
    ds_read_b128 v[48:51], v153 offset:24576
    ds_read_b128 v[52:55], v153 offset:43008
    ds_read_b128 v[56:59], v153 offset:61440
    ds_read_b128 v[60:63], v154 offset:14336
    s_waitcnt lgkmcnt(7)
    v_mfma_f32_16x16x32_bf16 v[4:7], v[92:95], v[64:67], v[4:7]
    v_mfma_f32_16x16x32_bf16 v[12:15], v[92:95], v[68:71], v[12:15]
    v_mfma_f32_16x16x32_bf16 v[20:23], v[92:95], v[72:75], v[20:23]
    v_mfma_f32_16x16x32_bf16 v[28:31], v[92:95], v[76:79], v[28:31]
    v_mfma_f32_16x16x32_bf16 v[36:39], v[92:95], v[80:83], v[36:39]
    s_waitcnt lgkmcnt(5)
    v_mfma_f32_16x16x32_bf16 v[8:11], v[96:99], v[64:67], v[8:11]
    v_mfma_f32_16x16x32_bf16 v[16:19], v[96:99], v[68:71], v[16:19]
    v_mfma_f32_16x16x32_bf16 v[24:27], v[96:99], v[72:75], v[24:27]
    v_mfma_f32_16x16x32_bf16 v[32:35], v[96:99], v[76:79], v[32:35]
    v_mfma_f32_16x16x32_bf16 v[40:43], v[96:99], v[80:83], v[40:43]
    s_waitcnt vmcnt(4)
    s_barrier
    ds_read_b64_tr_b16 v[84:85], v152 offset:32768
    ds_read_b64_tr_b16 v[86:87], v152 offset:36608
    ds_read_b64_tr_b16 v[88:89], v152 offset:32800
    ds_read_b64_tr_b16 v[90:91], v152 offset:36640
    s_mov_b32 s31, 995328
    s_add_u32 m0, s32, 16384
    s_nop 0
    buffer_load_dwordx4 v150, s[12:15], s31 offen lds
    s_add_u32 m0, s32, 17408
    s_nop 0
    buffer_load_dwordx4 v151, s[12:15], s31 offen lds
    ds_read_b128 v[64:67], v153 offset:7168
    ds_read_b128 v[68:71], v153 offset:25600
    ds_read_b128 v[72:75], v153 offset:44032
    ds_read_b128 v[76:79], v153 offset:62464
    ds_read_b128 v[80:83], v154 offset:15360
    s_waitcnt lgkmcnt(7)
    v_mfma_f32_16x16x32_bf16 v[4:7], v[84:87], v[44:47], v[4:7]
    v_mfma_f32_16x16x32_bf16 v[12:15], v[84:87], v[48:51], v[12:15]
    v_mfma_f32_16x16x32_bf16 v[20:23], v[84:87], v[52:55], v[20:23]
    v_mfma_f32_16x16x32_bf16 v[28:31], v[84:87], v[56:59], v[28:31]
    v_mfma_f32_16x16x32_bf16 v[36:39], v[84:87], v[60:63], v[36:39]
    s_waitcnt lgkmcnt(5)
    v_mfma_f32_16x16x32_bf16 v[8:11], v[88:91], v[44:47], v[8:11]
    v_mfma_f32_16x16x32_bf16 v[16:19], v[88:91], v[48:51], v[16:19]
    v_mfma_f32_16x16x32_bf16 v[24:27], v[88:91], v[52:55], v[24:27]
    v_mfma_f32_16x16x32_bf16 v[32:35], v[88:91], v[56:59], v[32:35]
    v_mfma_f32_16x16x32_bf16 v[40:43], v[88:91], v[60:63], v[40:43]
    s_waitcnt vmcnt(4)
    s_barrier
    ds_read_b64_tr_b16 v[92:93], v152 offset:49152
    ds_read_b64_tr_b16 v[94:95], v152 offset:52992
    ds_read_b64_tr_b16 v[96:97], v152 offset:49184
    ds_read_b64_tr_b16 v[98:99], v152 offset:53024
    s_mov_b32 s31, 1105920
    s_add_u32 m0, s32, 32768
    s_nop 0
    buffer_load_dwordx4 v150, s[12:15], s31 offen lds
    s_add_u32 m0, s32, 33792
    s_nop 0
    buffer_load_dwordx4 v151, s[12:15], s31 offen lds
    ds_read_b128 v[44:47], v153 offset:8192
    ds_read_b128 v[48:51], v153 offset:26624
    ds_read_b128 v[52:55], v153 offset:45056
    ds_read_b128 v[56:59], v153 offset:63488
    ds_read_b128 v[60:63], v154 offset:16384
    s_waitcnt lgkmcnt(7)
    v_mfma_f32_16x16x32_bf16 v[4:7], v[92:95], v[64:67], v[4:7]
    v_mfma_f32_16x16x32_bf16 v[12:15], v[92:95], v[68:71], v[12:15]
    v_mfma_f32_16x16x32_bf16 v[20:23], v[92:95], v[72:75], v[20:23]
    v_mfma_f32_16x16x32_bf16 v[28:31], v[92:95], v[76:79], v[28:31]
    v_mfma_f32_16x16x32_bf16 v[36:39], v[92:95], v[80:83], v[36:39]
    s_waitcnt lgkmcnt(5)
    v_mfma_f32_16x16x32_bf16 v[8:11], v[96:99], v[64:67], v[8:11]
    v_mfma_f32_16x16x32_bf16 v[16:19], v[96:99], v[68:71], v[16:19]
    v_mfma_f32_16x16x32_bf16 v[24:27], v[96:99], v[72:75], v[24:27]
    v_mfma_f32_16x16x32_bf16 v[32:35], v[96:99], v[76:79], v[32:35]
    v_mfma_f32_16x16x32_bf16 v[40:43], v[96:99], v[80:83], v[40:43]
    s_waitcnt vmcnt(4)
    s_barrier
    ds_read_b64_tr_b16 v[84:85], v152 offset:0
    ds_read_b64_tr_b16 v[86:87], v152 offset:3840
    ds_read_b64_tr_b16 v[88:89], v152 offset:32
    ds_read_b64_tr_b16 v[90:91], v152 offset:3872
    s_mov_b32 s31, 1216512
    s_add_u32 m0, s32, 49152
    s_nop 0
    buffer_load_dwordx4 v150, s[12:15], s31 offen lds
    s_add_u32 m0, s32, 50176
    s_nop 0
    buffer_load_dwordx4 v151, s[12:15], s31 offen lds
    ds_read_b128 v[64:67], v153 offset:9216
    ds_read_b128 v[68:71], v153 offset:27648
    ds_read_b128 v[72:75], v153 offset:46080
    ds_read_b128 v[76:79], v153 offset:64512
    ds_read_b128 v[80:83], v154 offset:17408
    s_waitcnt lgkmcnt(7)
    v_mfma_f32_16x16x32_bf16 v[4:7], v[84:87], v[44:47], v[4:7]
    v_mfma_f32_16x16x32_bf16 v[12:15], v[84:87], v[48:51], v[12:15]
    v_mfma_f32_16x16x32_bf16 v[20:23], v[84:87], v[52:55], v[20:23]
    v_mfma_f32_16x16x32_bf16 v[28:31], v[84:87], v[56:59], v[28:31]
    v_mfma_f32_16x16x32_bf16 v[36:39], v[84:87], v[60:63], v[36:39]
    s_waitcnt lgkmcnt(5)
    v_mfma_f32_16x16x32_bf16 v[8:11], v[88:91], v[44:47], v[8:11]
    v_mfma_f32_16x16x32_bf16 v[16:19], v[88:91], v[48:51], v[16:19]
    v_mfma_f32_16x16x32_bf16 v[24:27], v[88:91], v[52:55], v[24:27]
    v_mfma_f32_16x16x32_bf16 v[32:35], v[88:91], v[56:59], v[32:35]
    v_mfma_f32_16x16x32_bf16 v[40:43], v[88:91], v[60:63], v[40:43]
    s_waitcnt vmcnt(4)
    s_barrier
    ds_read_b64_tr_b16 v[92:93], v152 offset:16384
    ds_read_b64_tr_b16 v[94:95], v152 offset:20224
    ds_read_b64_tr_b16 v[96:97], v152 offset:16416
    ds_read_b64_tr_b16 v[98:99], v152 offset:20256
    s_mov_b32 s31, 1327104
    s_add_u32 m0, s32, 0
    s_nop 0
    buffer_load_dwordx4 v150, s[12:15], s31 offen lds
    s_add_u32 m0, s32, 1024
    s_nop 0
    buffer_load_dwordx4 v151, s[12:15], s31 offen lds
    ds_read_b128 v[44:47], v153 offset:10240
    ds_read_b128 v[48:51], v153 offset:28672
    ds_read_b128 v[52:55], v153 offset:47104
    ds_read_b128 v[56:59], v154 offset:0
    ds_read_b128 v[60:63], v154 offset:18432
    s_waitcnt lgkmcnt(7)
    v_mfma_f32_16x16x32_bf16 v[4:7], v[92:95], v[64:67], v[4:7]
    v_mfma_f32_16x16x32_bf16 v[12:15], v[92:95], v[68:71], v[12:15]
    v_mfma_f32_16x16x32_bf16 v[20:23], v[92:95], v[72:75], v[20:23]
    v_mfma_f32_16x16x32_bf16 v[28:31], v[92:95], v[76:79], v[28:31]
    v_mfma_f32_16x16x32_bf16 v[36:39], v[92:95], v[80:83], v[36:39]
    s_waitcnt lgkmcnt(5)
    v_mfma_f32_16x16x32_bf16 v[8:11], v[96:99], v[64:67], v[8:11]
    v_mfma_f32_16x16x32_bf16 v[16:19], v[96:99], v[68:71], v[16:19]
    v_mfma_f32_16x16x32_bf16 v[24:27], v[96:99], v[72:75], v[24:27]
    v_mfma_f32_16x16x32_bf16 v[32:35], v[96:99], v[76:79], v[32:35]
    v_mfma_f32_16x16x32_bf16 v[40:43], v[96:99], v[80:83], v[40:43]
    s_waitcnt vmcnt(4)
    s_barrier
    ds_read_b64_tr_b16 v[84:85], v152 offset:32768
    ds_read_b64_tr_b16 v[86:87], v152 offset:36608
    ds_read_b64_tr_b16 v[88:89], v152 offset:32800
    ds_read_b64_tr_b16 v[90:91], v152 offset:36640
    s_mov_b32 s31, 1437696
    s_add_u32 m0, s32, 16384
    s_nop 0
    buffer_load_dwordx4 v150, s[12:15], s31 offen lds
    s_add_u32 m0, s32, 17408
    s_nop 0
    buffer_load_dwordx4 v151, s[12:15], s31 offen lds
    ds_read_b128 v[64:67], v153 offset:11264
    ds_read_b128 v[68:71], v153 offset:29696
    ds_read_b128 v[72:75], v153 offset:48128
    ds_read_b128 v[76:79], v154 offset:1024
    ds_read_b128 v[80:83], v154 offset:19456
    s_waitcnt lgkmcnt(7)
    v_mfma_f32_16x16x32_bf16 v[4:7], v[84:87], v[44:47], v[4:7]
    v_mfma_f32_16x16x32_bf16 v[12:15], v[84:87], v[48:51], v[12:15]
    v_mfma_f32_16x16x32_bf16 v[20:23], v[84:87], v[52:55], v[20:23]
    v_mfma_f32_16x16x32_bf16 v[28:31], v[84:87], v[56:59], v[28:31]
    v_mfma_f32_16x16x32_bf16 v[36:39], v[84:87], v[60:63], v[36:39]
    s_waitcnt lgkmcnt(5)
    v_mfma_f32_16x16x32_bf16 v[8:11], v[88:91], v[44:47], v[8:11]
    v_mfma_f32_16x16x32_bf16 v[16:19], v[88:91], v[48:51], v[16:19]
    v_mfma_f32_16x16x32_bf16 v[24:27], v[88:91], v[52:55], v[24:27]
    v_mfma_f32_16x16x32_bf16 v[32:35], v[88:91], v[56:59], v[32:35]
    v_mfma_f32_16x16x32_bf16 v[40:43], v[88:91], v[60:63], v[40:43]
    s_waitcnt vmcnt(4)
    s_barrier
    ds_read_b64_tr_b16 v[92:93], v152 offset:49152
    ds_read_b64_tr_b16 v[94:95], v152 offset:52992
    ds_read_b64_tr_b16 v[96:97], v152 offset:49184
    ds_read_b64_tr_b16 v[98:99], v152 offset:53024
    s_mov_b32 s31, 1548288
    s_add_u32 m0, s32, 32768
    s_nop 0
    buffer_load_dwordx4 v150, s[12:15], s31 offen lds
    s_add_u32 m0, s32, 33792
    s_nop 0
    buffer_load_dwordx4 v151, s[12:15], s31 offen lds
    ds_read_b128 v[44:47], v153 offset:12288
    ds_read_b128 v[48:51], v153 offset:30720
    ds_read_b128 v[52:55], v153 offset:49152
    ds_read_b128 v[56:59], v154 offset:2048
    ds_read_b128 v[60:63], v154 offset:20480
    s_waitcnt lgkmcnt(7)
    v_mfma_f32_16x16x32_bf16 v[4:7], v[92:95], v[64:67], v[4:7]
    v_mfma_f32_16x16x32_bf16 v[12:15], v[92:95], v[68:71], v[12:15]
    v_mfma_f32_16x16x32_bf16 v[20:23], v[92:95], v[72:75], v[20:23]
    v_mfma_f32_16x16x32_bf16 v[28:31], v[92:95], v[76:79], v[28:31]
    v_mfma_f32_16x16x32_bf16 v[36:39], v[92:95], v[80:83], v[36:39]
    s_waitcnt lgkmcnt(5)
    v_mfma_f32_16x16x32_bf16 v[8:11], v[96:99], v[64:67], v[8:11]
    v_mfma_f32_16x16x32_bf16 v[16:19], v[96:99], v[68:71], v[16:19]
    v_mfma_f32_16x16x32_bf16 v[24:27], v[96:99], v[72:75], v[24:27]
    v_mfma_f32_16x16x32_bf16 v[32:35], v[96:99], v[76:79], v[32:35]
    v_mfma_f32_16x16x32_bf16 v[40:43], v[96:99], v[80:83], v[40:43]
    s_waitcnt vmcnt(4)
    s_barrier
    ds_read_b64_tr_b16 v[84:85], v152 offset:0
    ds_read_b64_tr_b16 v[86:87], v152 offset:3840
    ds_read_b64_tr_b16 v[88:89], v152 offset:32
    ds_read_b64_tr_b16 v[90:91], v152 offset:3872
    s_mov_b32 s31, 1658880
    s_add_u32 m0, s32, 49152
    s_nop 0
    buffer_load_dwordx4 v150, s[12:15], s31 offen lds
    s_add_u32 m0, s32, 50176
    s_nop 0
    buffer_load_dwordx4 v151, s[12:15], s31 offen lds
    ds_read_b128 v[64:67], v153 offset:13312
    ds_read_b128 v[68:71], v153 offset:31744
    ds_read_b128 v[72:75], v153 offset:50176
    ds_read_b128 v[76:79], v154 offset:3072
    ds_read_b128 v[80:83], v154 offset:21504
    s_waitcnt lgkmcnt(7)
    v_mfma_f32_16x16x32_bf16 v[4:7], v[84:87], v[44:47], v[4:7]
    v_mfma_f32_16x16x32_bf16 v[12:15], v[84:87], v[48:51], v[12:15]
    v_mfma_f32_16x16x32_bf16 v[20:23], v[84:87], v[52:55], v[20:23]
    v_mfma_f32_16x16x32_bf16 v[28:31], v[84:87], v[56:59], v[28:31]
    v_mfma_f32_16x16x32_bf16 v[36:39], v[84:87], v[60:63], v[36:39]
    s_waitcnt lgkmcnt(5)
    v_mfma_f32_16x16x32_bf16 v[8:11], v[88:91], v[44:47], v[8:11]
    v_mfma_f32_16x16x32_bf16 v[16:19], v[88:91], v[48:51], v[16:19]
    v_mfma_f32_16x16x32_bf16 v[24:27], v[88:91], v[52:55], v[24:27]
    v_mfma_f32_16x16x32_bf16 v[32:35], v[88:91], v[56:59], v[32:35]
    v_mfma_f32_16x16x32_bf16 v[40:43], v[88:91], v[60:63], v[40:43]
    s_waitcnt vmcnt(4)
    s_barrier
    ds_read_b64_tr_b16 v[92:93], v152 offset:16384
    ds_read_b64_tr_b16 v[94:95], v152 offset:20224
    ds_read_b64_tr_b16 v[96:97], v152 offset:16416
    ds_read_b64_tr_b16 v[98:99], v152 offset:20256
    s_mov_b32 s31, 1769472
    s_add_u32 m0, s32, 0
    s_nop 0
    buffer_load_dwordx4 v150, s[12:15], s31 offen lds
    s_add_u32 m0, s32, 1024
    s_nop 0
    buffer_load_dwordx4 v151, s[12:15], s31 offen lds
    ds_read_b128 v[44:47], v153 offset:14336
    ds_read_b128 v[48:51], v153 offset:32768
    ds_read_b128 v[52:55], v153 offset:51200
    ds_read_b128 v[56:59], v154 offset:4096
    ds_read_b128 v[60:63], v154 offset:22528
    s_waitcnt lgkmcnt(7)
    v_mfma_f32_16x16x32_bf16 v[4:7], v[92:95], v[64:67], v[4:7]
    v_mfma_f32_16x16x32_bf16 v[12:15], v[92:95], v[68:71], v[12:15]
    v_mfma_f32_16x16x32_bf16 v[20:23], v[92:95], v[72:75], v[20:23]
    v_mfma_f32_16x16x32_bf16 v[28:31], v[92:95], v[76:79], v[28:31]
    v_mfma_f32_16x16x32_bf16 v[36:39], v[92:95], v[80:83], v[36:39]
    s_waitcnt lgkmcnt(5)
    v_mfma_f32_16x16x32_bf16 v[8:11], v[96:99], v[64:67], v[8:11]
    v_mfma_f32_16x16x32_bf16 v[16:19], v[96:99], v[68:71], v[16:19]
    v_mfma_f32_16x16x32_bf16 v[24:27], v[96:99], v[72:75], v[24:27]
    v_mfma_f32_16x16x32_bf16 v[32:35], v[96:99], v[76:79], v[32:35]
    v_mfma_f32_16x16x32_bf16 v[40:43], v[96:99], v[80:83], v[40:43]
    s_waitcnt vmcnt(4)
    s_barrier
    ds_read_b64_tr_b16 v[84:85], v152 offset:32768
    ds_read_b64_tr_b16 v[86:87], v152 offset:36608
    ds_read_b64_tr_b16 v[88:89], v152 offset:32800
    ds_read_b64_tr_b16 v[90:91], v152 offset:36640
    s_mov_b32 s31, 1880064
    s_add_u32 m0, s32, 16384
    s_nop 0
    buffer_load_dwordx4 v150, s[12:15], s31 offen lds
    s_add_u32 m0, s32, 17408
    s_nop 0
    buffer_load_dwordx4 v151, s[12:15], s31 offen lds
    ds_read_b128 v[64:67], v153 offset:15360
    ds_read_b128 v[68:71], v153 offset:33792
    ds_read_b128 v[72:75], v153 offset:52224
    ds_read_b128 v[76:79], v154 offset:5120
    ds_read_b128 v[80:83], v154 offset:23552
    s_waitcnt lgkmcnt(7)
    v_mfma_f32_16x16x32_bf16 v[4:7], v[84:87], v[44:47], v[4:7]
    v_mfma_f32_16x16x32_bf16 v[12:15], v[84:87], v[48:51], v[12:15]
    v_mfma_f32_16x16x32_bf16 v[20:23], v[84:87], v[52:55], v[20:23]
    v_mfma_f32_16x16x32_bf16 v[28:31], v[84:87], v[56:59], v[28:31]
    v_mfma_f32_16x16x32_bf16 v[36:39], v[84:87], v[60:63], v[36:39]
    s_waitcnt lgkmcnt(5)
    v_mfma_f32_16x16x32_bf16 v[8:11], v[88:91], v[44:47], v[8:11]
    v_mfma_f32_16x16x32_bf16 v[16:19], v[88:91], v[48:51], v[16:19]
    v_mfma_f32_16x16x32_bf16 v[24:27], v[88:91], v[52:55], v[24:27]
    v_mfma_f32_16x16x32_bf16 v[32:35], v[88:91], v[56:59], v[32:35]
    v_mfma_f32_16x16x32_bf16 v[40:43], v[88:91], v[60:63], v[40:43]
    s_waitcnt vmcnt(4)
    s_barrier
    ds_read_b64_tr_b16 v[92:93], v152 offset:49152
    ds_read_b64_tr_b16 v[94:95], v152 offset:52992
    ds_read_b64_tr_b16 v[96:97], v152 offset:49184
    ds_read_b64_tr_b16 v[98:99], v152 offset:53024
    ds_read_b128 v[44:47], v153 offset:16384
    ds_read_b128 v[48:51], v153 offset:34816
    ds_read_b128 v[52:55], v153 offset:53248
    ds_read_b128 v[56:59], v154 offset:6144
    ds_read_b128 v[60:63], v154 offset:24576
    s_waitcnt lgkmcnt(7)
    v_mfma_f32_16x16x32_bf16 v[4:7], v[92:95], v[64:67], v[4:7]
    v_mfma_f32_16x16x32_bf16 v[12:15], v[92:95], v[68:71], v[12:15]
    v_mfma_f32_16x16x32_bf16 v[20:23], v[92:95], v[72:75], v[20:23]
    v_mfma_f32_16x16x32_bf16 v[28:31], v[92:95], v[76:79], v[28:31]
    v_mfma_f32_16x16x32_bf16 v[36:39], v[92:95], v[80:83], v[36:39]
    s_waitcnt lgkmcnt(5)
    v_mfma_f32_16x16x32_bf16 v[8:11], v[96:99], v[64:67], v[8:11]
    v_mfma_f32_16x16x32_bf16 v[16:19], v[96:99], v[68:71], v[16:19]
    v_mfma_f32_16x16x32_bf16 v[24:27], v[96:99], v[72:75], v[24:27]
    v_mfma_f32_16x16x32_bf16 v[32:35], v[96:99], v[76:79], v[32:35]
    v_mfma_f32_16x16x32_bf16 v[40:43], v[96:99], v[80:83], v[40:43]
    s_waitcnt vmcnt(2)
    s_barrier
    ds_read_b64_tr_b16 v[84:85], v152 offset:0
    ds_read_b64_tr_b16 v[86:87], v152 offset:3840
    ds_read_b64_tr_b16 v[88:89], v152 offset:32
    ds_read_b64_tr_b16 v[90:91], v152 offset:3872
    ds_read_b128 v[64:67], v153 offset:17408
    ds_read_b128 v[68:71], v153 offset:35840
    ds_read_b128 v[72:75], v153 offset:54272
    ds_read_b128 v[76:79], v154 offset:7168
    ds_read_b128 v[80:83], v154 offset:25600
    s_waitcnt lgkmcnt(7)
    v_mfma_f32_16x16x32_bf16 v[4:7], v[84:87], v[44:47], v[4:7]
    v_mfma_f32_16x16x32_bf16 v[12:15], v[84:87], v[48:51], v[12:15]
    v_mfma_f32_16x16x32_bf16 v[20:23], v[84:87], v[52:55], v[20:23]
    v_mfma_f32_16x16x32_bf16 v[28:31], v[84:87], v[56:59], v[28:31]
    v_mfma_f32_16x16x32_bf16 v[36:39], v[84:87], v[60:63], v[36:39]
    s_waitcnt lgkmcnt(5)
    v_mfma_f32_16x16x32_bf16 v[8:11], v[88:91], v[44:47], v[8:11]
    v_mfma_f32_16x16x32_bf16 v[16:19], v[88:91], v[48:51], v[16:19]
    v_mfma_f32_16x16x32_bf16 v[24:27], v[88:91], v[52:55], v[24:27]
    v_mfma_f32_16x16x32_bf16 v[32:35], v[88:91], v[56:59], v[32:35]
    v_mfma_f32_16x16x32_bf16 v[40:43], v[88:91], v[60:63], v[40:43]
    s_waitcnt vmcnt(0)
    s_barrier
    ds_read_b64_tr_b16 v[92:93], v152 offset:16384
    ds_read_b64_tr_b16 v[94:95], v152 offset:20224
    ds_read_b64_tr_b16 v[96:97], v152 offset:16416
    ds_read_b64_tr_b16 v[98:99], v152 offset:20256
    s_waitcnt lgkmcnt(2)
    v_mfma_f32_16x16x32_bf16 v[4:7], v[92:95], v[64:67], v[4:7]
    v_mfma_f32_16x16x32_bf16 v[12:15], v[92:95], v[68:71], v[12:15]
    v_mfma_f32_16x16x32_bf16 v[20:23], v[92:95], v[72:75], v[20:23]
    v_mfma_f32_16x16x32_bf16 v[28:31], v[92:95], v[76:79], v[28:31]
    v_mfma_f32_16x16x32_bf16 v[36:39], v[92:95], v[80:83], v[36:39]
    s_waitcnt lgkmcnt(0)
    v_mfma_f32_16x16x32_bf16 v[8:11], v[96:99], v[64:67], v[8:11]
    v_mfma_f32_16x16x32_bf16 v[16:19], v[96:99], v[68:71], v[16:19]
    v_mfma_f32_16x16x32_bf16 v[24:27], v[96:99], v[72:75], v[24:27]
    v_mfma_f32_16x16x32_bf16 v[32:35], v[96:99], v[76:79], v[32:35]
    v_mfma_f32_16x16x32_bf16 v[40:43], v[96:99], v[80:83], v[40:43]
    s_barrier
    v_lshrrev_b32 v160, 4, v0
    v_lshlrev_b32 v160, 2, v160
    s_lshl_b32 s36, s28, 5
    v_add_u32 v160, s36, v160
    v_and_b32 v161, 15, v0
    v_mul_u32_u24 v161, 624, v161
    v_add_u32 v162, 0, v160
    v_mul_u32_u24 v163, 3641, v162
    v_lshrrev_b32 v163, 16, v163
    v_mul_u32_u24 v164, 18, v163
    v_sub_u32 v164, v162, v164
    v_lshl_add_u32 v164, v164, 1, v161
    v_mad_u32_u24 v164, v163, 48, v164
    v_add_u32 v162, 2, v160
    v_mul_u32_u24 v163, 3641, v162
    v_lshrrev_b32 v163, 16, v163
    v_mul_u32_u24 v165, 18, v163
    v_sub_u32 v165, v162, v165
    v_lshl_add_u32 v165, v165, 1, v161
    v_mad_u32_u24 v165, v163, 48, v165
    v_add_u32 v162, 16, v160
    v_mul_u32_u24 v163, 3641, v162
    v_lshrrev_b32 v163, 16, v163
    v_mul_u32_u24 v166, 18, v163
    v_sub_u32 v166, v162, v166
    v_lshl_add_u32 v166, v166, 1, v161
    v_mad_u32_u24 v166, v163, 48, v166
    v_add_u32 v162, 18, v160
    v_mul_u32_u24 v163, 3641, v162
    v_lshrrev_b32 v163, 16, v163
    v_mul_u32_u24 v167, 18, v163
    v_sub_u32 v167, v162, v167
    v_lshl_add_u32 v167, v167, 1, v161
    v_mad_u32_u24 v167, v163, 48, v167
    s_cmp_ge_u32 s28, 7
    s_cbranch_scc1 L_k1_kernel_skipq
    v_cvt_pk_bf16_f32 v168, v4, v5
    v_cvt_pk_bf16_f32 v169, v6, v7
    ds_write_b32 v164, v168 offset:0
    ds_write_b32 v165, v169 offset:0
    v_cvt_pk_bf16_f32 v170, v8, v9
    v_cvt_pk_bf16_f32 v171, v10, v11
    ds_write_b32 v166, v170 offset:0
    ds_write_b32 v167, v171 offset:0
    v_cvt_pk_bf16_f32 v168, v12, v13
    v_cvt_pk_bf16_f32 v169, v14, v15
    ds_write_b32 v164, v168 offset:9984
    ds_write_b32 v165, v169 offset:9984
    v_cvt_pk_bf16_f32 v170, v16, v17
    v_cvt_pk_bf16_f32 v171, v18, v19
    ds_write_b32 v166, v170 offset:9984
    ds_write_b32 v167, v171 offset:9984
    v_cvt_pk_bf16_f32 v168, v20, v21
    v_cvt_pk_bf16_f32 v169, v22, v23
    ds_write_b32 v164, v168 offset:19968
    ds_write_b32 v165, v169 offset:19968
    v_cvt_pk_bf16_f32 v170, v24, v25
    v_cvt_pk_bf16_f32 v171, v26, v27
    ds_write_b32 v166, v170 offset:19968
    ds_write_b32 v167, v171 offset:19968
    v_cvt_pk_bf16_f32 v168, v28, v29
    v_cvt_pk_bf16_f32 v169, v30, v31
    ds_write_b32 v164, v168 offset:29952
    ds_write_b32 v165, v169 offset:29952
    v_cvt_pk_bf16_f32 v170, v32, v33
    v_cvt_pk_bf16_f32 v171, v34, v35
    ds_write_b32 v166, v170 offset:29952
    ds_write_b32 v167, v171 offset:29952
    v_cvt_pk_bf16_f32 v168, v36, v37
    v_cvt_pk_bf16_f32 v169, v38, v39
    ds_write_b32 v164, v168 offset:39936
    ds_write_b32 v165, v169 offset:39936
    v_cvt_pk_bf16_f32 v170, v40, v41
    v_cvt_pk_bf16_f32 v171, v42, v43
    ds_write_b32 v166, v170 offset:39936
    ds_write_b32 v167, v171 offset:39936
L_k1_kernel_skipq:
    v_lshrrev_b32 v162, 3, v3
    v_bfe_u32 v163, v3, 1, 2
    v_and_b32 v172, 1, v3
    v_add_u32 v173, 2, v162
    v_mul_u32_u24 v173, 624, v173
    v_mad_u32_u24 v173, v163, 48, v173
    v_xor_b32 v174, 1, v172
    s_movk_i32 s36, 4992
    v_mad_u32_u24 v160, v174, s36, v173
    v_mad_u32_u24 v161, v172, s36, v173
    s_waitcnt lgkmcnt(0)
    s_barrier
    ds_read_b128 v[4:7], v173 offset:8736
    ds_read_b128 v[8:11], v173 offset:8752
    ds_read_b128 v[12:15], v173 offset:8768
    ds_read_b128 v[16:19], v160 offset:3936
    ds_read_b128 v[20:23], v160 offset:3952
    ds_read_b128 v[24:27], v160 offset:3968
    ds_read_b128 v[28:31], v160 offset:2688
    ds_read_b128 v[32:35], v160 offset:2704
    ds_read_b128 v[36:39], v160 offset:2720
    ds_read_b128 v[40:43], v160 offset:1440
    ds_read_b128 v[44:47], v160 offset:1456
    ds_read_b128 v[48:51], v160 offset:1472
    ds_read_b128 v[52:55], v160 offset:192
    ds_read_b128 v[56:59], v160 offset:208
    ds_read_b128 v[60:63], v160 offset:224
    v_lshl_add_u32 v160, v172, 4, v160
    v_lshl_add_u32 v161, v172, 4, v161
    s_lshl_b32 s36, s29, 6
    v_add_u32 v162, s36, v162
    v_lshlrev_b32 v174, 3, v172
    v_sub_u32 v174, v162, v174
    s_mov_b32 s37, 1047616495
    s_mov_b32 s38, 3463342888
    v_cvt_pk_bf16_f32 v175, s38, s38
    v_lshlrev_b32 v175, 16, v175
    v_mov_b32 v64, 0
    v_mov_b32 v65, 0
    v_mov_b32 v66, 0
    v_mov_b32 v67, 0
    s_waitcnt lgkmcnt(0)
    ds_read_b128 v[72:75], v160 offset:4128
    ds_read_b32 v76, v160 offset:4144
    ds_read_b128 v[80:83], v160 offset:2880
    ds_read_b32 v84, v160 offset:2896
    ds_read_b128 v[88:91], v160 offset:1632
    ds_read_b32 v92, v160 offset:1648
    ds_read_b128 v[96:99], v160 offset:384
    ds_read_b32 v100, v160 offset:400
    ds_read_b128 v[104:107], v161 offset:4128
    ds_read_b32 v108, v161 offset:4144
    ds_read_b128 v[112:115], v161 offset:2880
    ds_read_b32 v116, v161 offset:2896
    ds_read_b128 v[120:123], v161 offset:1632
    ds_read_b32 v124, v161 offset:1648
    ds_read_b128 v[128:131], v161 offset:384
    ds_read_b32 v132, v161 offset:400
    v_dot2_f32_bf16 v64, v4, v16, v64
    v_dot2_f32_bf16 v65, v4, v28, v65
    v_dot2_f32_bf16 v66, v4, v40, v66
    v_dot2_f32_bf16 v67, v4, v52, v67
    v_dot2_f32_bf16 v64, v5, v17, v64
    v_dot2_f32_bf16 v65, v5, v29, v65
    v_dot2_f32_bf16 v66, v5, v41, v66
    v_dot2_f32_bf16 v67, v5, v53, v67
    v_dot2_f32_bf16 v64, v6, v18, v64
    v_dot2_f32_bf16 v65, v6, v30, v65
    v_dot2_f32_bf16 v66, v6, v42, v66
    v_dot2_f32_bf16 v67, v6, v54, v67
    v_dot2_f32_bf16 v64, v7, v19, v64
    v_dot2_f32_bf16 v65, v7, v31, v65
    v_dot2_f32_bf16 v66, v7, v43, v66
    v_dot2_f32_bf16 v67, v7, v55, v67
    v_dot2_f32_bf16 v64, v8, v20, v64
    v_dot2_f32_bf16 v65, v8, v32, v65
    v_dot2_f32_bf16 v66, v8, v44, v66
    v_dot2_f32_bf16 v67, v8, v56, v67
    v_dot2_f32_bf16 v64, v9, v21, v64
    v_dot2_f32_bf16 v65, v9, v33, v65
    v_dot2_f32_bf16 v66, v9, v45, v66
    v_dot2_f32_bf16 v67, v9, v57, v67
    v_dot2_f32_bf16 v64, v10, v22, v64
    v_dot2_f32_bf16 v65, v10, v34, v65
    v_dot2_f32_bf16 v66, v10, v46, v66
    v_dot2_f32_bf16 v67, v10, v58, v67
    v_dot2_f32_bf16 v64, v11, v23, v64
    v_dot2_f32_bf16 v65, v11, v35, v65
    v_dot2_f32_bf16 v66, v11, v47, v66
    v_dot2_f32_bf16 v67, v11, v59, v67
    v_dot2_f32_bf16 v64, v12, v24, v64
    v_dot2_f32_bf16 v65, v12, v36, v65
    v_dot2_f32_bf16 v66, v12, v48, v66
    v_dot2_f32_bf16 v67, v12, v60, v67
    s_nop 2
    v_cvt_pk_bf16_f32 v64, v64, v65
    v_cvt_pk_bf16_f32 v66, v66, v67
    v_and_b32 v65, 0xffff0000, v64
    v_lshlrev_b32 v64, 16, v64
    v_and_b32 v67, 0xffff0000, v66
    v_lshlrev_b32 v66, 16, v66
    v_mul_f32 v64, s37, v64
    v_mul_f32 v65, s37, v65
    v_mul_f32 v66, s37, v66
    v_mul_f32 v67, s37, v67
    v_cvt_pk_bf16_f32 v64, v64, v65
    v_cvt_pk_bf16_f32 v66, v66, v67
    v_and_b32 v65, 0xffff0000, v64
    v_lshlrev_b32 v64, 16, v64
    v_and_b32 v67, 0xffff0000, v66
    v_lshlrev_b32 v66, 16, v66
    v_cmp_le_i32 vcc, 0, v174
    s_nop 1
    v_cndmask_b32 v64, v175, v64, vcc
    v_cmp_le_i32 vcc, 2, v174
    s_nop 1
    v_cndmask_b32 v65, v175, v65, vcc
    v_cmp_le_i32 vcc, 4, v174
    s_nop 1
    v_cndmask_b32 v66, v175, v66, vcc
    v_cmp_le_i32 vcc, 6, v174
    s_nop 1
    v_cndmask_b32 v67, v175, v67, vcc
    s_nop 1
    v_mov_b32_dpp v68, v64 quad_perm:[1,0,3,2] row_mask:0xf bank_mask:0xf
    v_mov_b32_dpp v69, v65 quad_perm:[1,0,3,2] row_mask:0xf bank_mask:0xf
    v_mov_b32_dpp v70, v66 quad_perm:[1,0,3,2] row_mask:0xf bank_mask:0xf
    v_mov_b32_dpp v71, v67 quad_perm:[1,0,3,2] row_mask:0xf bank_mask:0xf
    v_max3_f32 v173, v64, v65, v66
    v_max3_f32 v173, v173, v67, v68
    v_max3_f32 v173, v173, v69, v70
    v_max_f32 v173, v173, v71
    s_mov_b32 s39, 1069066811
    v_sub_f32 v64, v64, v173
    v_sub_f32 v65, v65, v173
    v_sub_f32 v66, v66, v173
    v_sub_f32 v67, v67, v173
    v_sub_f32 v68, v68, v173
    v_sub_f32 v69, v69, v173
    v_sub_f32 v70, v70, v173
    v_sub_f32 v71, v71, v173
    v_mul_f32 v64, s39, v64
    v_mul_f32 v65, s39, v65
    v_mul_f32 v66, s39, v66
    v_mul_f32 v67, s39, v67
    v_mul_f32 v68, s39, v68
    v_mul_f32 v69, s39, v69
    v_mul_f32 v70, s39, v70
    v_mul_f32 v71, s39, v71
    v_exp_f32 v64, v64
    v_exp_f32 v65, v65
    v_exp_f32 v66, v66
    v_exp_f32 v67, v67
    v_exp_f32 v68, v68
    v_exp_f32 v69, v69
    v_exp_f32 v70, v70
    v_exp_f32 v71, v71
    s_nop 0
    v_add_f32 v174, v64, v68
    v_add_f32 v173, v65, v69
    v_add_f32 v175, v66, v70
    v_add_f32 v176, v67, v71
    v_add_f32 v174, v174, v173
    v_add_f32 v175, v175, v176
    v_add_f32 v174, v174, v175
    v_rcp_f32 v174, v174
    s_nop 0
    v_mul_f32 v64, v64, v174
    v_mul_f32 v65, v65, v174
    v_mul_f32 v66, v66, v174
    v_mul_f32 v67, v67, v174
    v_mul_f32 v68, v68, v174
    v_mul_f32 v69, v69, v174
    v_mul_f32 v70, v70, v174
    v_mul_f32 v71, v71, v174
    v_cvt_pk_bf16_f32 v64, v64, v65
    v_cvt_pk_bf16_f32 v65, v66, v67
    v_cvt_pk_bf16_f32 v66, v68, v69
    v_cvt_pk_bf16_f32 v67, v70, v71
    s_mov_b32 s40, 0x05040100
    s_mov_b32 s41, 0x07060302
    s_waitcnt lgkmcnt(0)
    v_perm_b32 v173, v80, v72, s40
    v_perm_b32 v174, v80, v72, s41
    v_dot2_f32_bf16 v136, v173, v64, 0
    v_dot2_f32_bf16 v137, v174, v64, 0
    v_perm_b32 v175, v81, v73, s40
    v_perm_b32 v176, v81, v73, s41
    v_dot2_f32_bf16 v138, v175, v64, 0
    v_dot2_f32_bf16 v139, v176, v64, 0
    v_perm_b32 v173, v82, v74, s40
    v_perm_b32 v174, v82, v74, s41
    v_dot2_f32_bf16 v140, v173, v64, 0
    v_dot2_f32_bf16 v141, v174, v64, 0
    v_perm_b32 v175, v83, v75, s40
    v_perm_b32 v176, v83, v75, s41
    v_dot2_f32_bf16 v142, v175, v64, 0
    v_dot2_f32_bf16 v143, v176, v64, 0
    v_perm_b32 v173, v84, v76, s40
    v_perm_b32 v174, v84, v76, s41
    v_dot2_f32_bf16 v144, v173, v64, 0
    v_dot2_f32_bf16 v145, v174, v64, 0
    v_perm_b32 v173, v96, v88, s40
    v_perm_b32 v174, v96, v88, s41
    v_dot2_f32_bf16 v136, v173, v65, v136
    v_dot2_f32_bf16 v137, v174, v65, v137
    v_perm_b32 v175, v97, v89, s40
    v_perm_b32 v176, v97, v89, s41
    v_dot2_f32_bf16 v138, v175, v65, v138
    v_dot2_f32_bf16 v139, v176, v65, v139
    v_perm_b32 v173, v98, v90, s40
    v_perm_b32 v174, v98, v90, s41
    v_dot2_f32_bf16 v140, v173, v65, v140
    v_dot2_f32_bf16 v141, v174, v65, v141
    v_perm_b32 v175, v99, v91, s40
    v_perm_b32 v176, v99, v91, s41
    v_dot2_f32_bf16 v142, v175, v65, v142
    v_dot2_f32_bf16 v143, v176, v65, v143
    v_perm_b32 v173, v100, v92, s40
    v_perm_b32 v174, v100, v92, s41
    v_dot2_f32_bf16 v144, v173, v65, v144
    v_dot2_f32_bf16 v145, v174, v65, v145
    v_perm_b32 v173, v112, v104, s40
    v_perm_b32 v174, v112, v104, s41
    v_dot2_f32_bf16 v136, v173, v66, v136
    v_dot2_f32_bf16 v137, v174, v66, v137
    v_perm_b32 v175, v113, v105, s40
    v_perm_b32 v176, v113, v105, s41
    v_dot2_f32_bf16 v138, v175, v66, v138
    v_dot2_f32_bf16 v139, v176, v66, v139
    v_perm_b32 v173, v114, v106, s40
    v_perm_b32 v174, v114, v106, s41
    v_dot2_f32_bf16 v140, v173, v66, v140
    v_dot2_f32_bf16 v141, v174, v66, v141
    v_perm_b32 v175, v115, v107, s40
    v_perm_b32 v176, v115, v107, s41
    v_dot2_f32_bf16 v142, v175, v66, v142
    v_dot2_f32_bf16 v143, v176, v66, v143
    v_perm_b32 v173, v116, v108, s40
    v_perm_b32 v174, v116, v108, s41
    v_dot2_f32_bf16 v144, v173, v66, v144
    v_dot2_f32_bf16 v145, v174, v66, v145
    v_perm_b32 v173, v128, v120, s40
    v_perm_b32 v174, v128, v120, s41
    v_dot2_f32_bf16 v136, v173, v67, v136
    v_dot2_f32_bf16 v137, v174, v67, v137
    v_perm_b32 v175, v129, v121, s40
    v_perm_b32 v176, v129, v121, s41
    v_dot2_f32_bf16 v138, v175, v67, v138
    v_dot2_f32_bf16 v139, v176, v67, v139
    v_perm_b32 v173, v130, v122, s40
    v_perm_b32 v174, v130, v122, s41
    v_dot2_f32_bf16 v140, v173, v67, v140
    v_dot2_f32_bf16 v141, v174, v67, v141
    v_perm_b32 v175, v131, v123, s40
    v_perm_b32 v176, v131, v123, s41
    v_dot2_f32_bf16 v142, v175, v67, v142
    v_dot2_f32_bf16 v143, v176, v67, v143
    v_perm_b32 v173, v132, v124, s40
    v_perm_b32 v174, v132, v124, s41
    v_dot2_f32_bf16 v144, v173, v67, v144
    v_dot2_f32_bf16 v145, v174, v67, v145
    s_nop 2
    v_cvt_pk_bf16_f32 v4, v136, v137
    v_cvt_pk_bf16_f32 v5, v138, v139
    v_cvt_pk_bf16_f32 v6, v140, v141
    v_cvt_pk_bf16_f32 v7, v142, v143
    v_cvt_pk_bf16_f32 v8, v144, v145
    v_lshrrev_b32 v173, 3, v3
    v_mul_u32_u24 v173, 160, v173
    v_mad_u32_u24 v173, v163, 36, v173
    v_lshl_add_u32 v173, v172, 4, v173
    v_add_u32 v173, 65536, v173
    ds_write2_b32 v173, v4, v5 offset0:0 offset1:1
    ds_write2_b32 v173, v6, v7 offset0:2 offset1:3
    ds_write_b32 v173, v8 offset:16
    s_lshl_b32 s36, s28, 2
    v_lshrrev_b32 v174, 4, v0
    v_add_u32 v174, s36, v174
    s_mul_i32 s37, s30, 9
    s_lshl_b32 s38, s29, 2
    s_mul_i32 s38, s38, 18432
    v_mul_u32_u24 v175, 7282, v174
    v_lshrrev_b32 v175, 16, v175
    v_mul_u32_u24 v176, 9, v175
    v_sub_u32 v176, v174, v176
    v_and_b32 v177, 15, v0
    v_lshl_add_u32 v164, v175, 4, v177
    v_mul_u32_u24 v164, 160, v164
    v_lshl_add_u32 v164, v176, 4, v164
    v_add_u32 v164, 65536, v164
    v_add_u32 v176, s37, v176
    v_mul_u32_u24 v165, 18432, v175
    v_lshl_add_u32 v165, v176, 8, v165
    v_lshl_add_u32 v165, v177, 4, v165
    v_add_u32 v174, 32, v174
    v_mul_u32_u24 v175, 7282, v174
    v_lshrrev_b32 v175, 16, v175
    v_mul_u32_u24 v176, 9, v175
    v_sub_u32 v176, v174, v176
    v_and_b32 v177, 15, v0
    v_lshl_add_u32 v166, v175, 4, v177
    v_mul_u32_u24 v166, 160, v166
    v_lshl_add_u32 v166, v176, 4, v166
    v_add_u32 v166, 65536, v166
    v_add_u32 v176, s37, v176
    v_mul_u32_u24 v167, 18432, v175
    v_lshl_add_u32 v167, v176, 8, v167
    v_lshl_add_u32 v167, v177, 4, v167
    s_waitcnt lgkmcnt(0)
    s_barrier
    ds_read_b128 v[4:7], v164
    ds_read_b128 v[8:11], v166
    s_waitcnt lgkmcnt(1)
    buffer_store_dwordx4 v[4:7], v165, s[20:23], s38 offen
    s_cmp_lg_u32 s28, 0
    s_cbranch_scc1 L_k1_kernel_nost2
    s_waitcnt lgkmcnt(0)
    buffer_store_dwordx4 v[8:11], v167, s[20:23], s38 offen
L_k1_kernel_nost2:
L_k1_kernel_done:
    s_endpgm

.globl k2_kernel
.p2align 8
.type k2_kernel,@function
k2_kernel:
    s_cmp_ge_u32 s2, 192
    s_cbranch_scc1 L_k2_kernel_done
    s_load_dwordx2 s[4:5], s[0:1], 0
    s_load_dwordx2 s[6:7], s[0:1], 16
    s_load_dwordx2 s[8:9], s[0:1], 72
    v_lshrrev_b32 v1, 6, v0
    v_and_b32 v0, 63, v0
    s_nop 0
    v_readfirstlane_b32 s32, v1
    s_lshr_b32 s37, s2, 3
    s_mul_i32 s33, s37, 10923
    s_lshr_b32 s33, s33, 16
    s_mul_i32 s36, s33, 6
    s_sub_u32 s34, s37, s36
    s_and_b32 s36, s2, 7
    s_lshl_b32 s36, s36, 2
    s_add_u32 s33, s33, s36
    s_waitcnt lgkmcnt(0)
    s_mov_b32 s12, s6
    s_mov_b32 s13, s7
    s_and_b32 s13, s13, 0xffff
    s_mov_b32 s14, 663552
    s_mov_b32 s15, 0x00020000
    s_mov_b32 s16, s8
    s_mov_b32 s17, s9
    s_and_b32 s17, s17, 0xffff
    s_mov_b32 s18, 2359296
    s_mov_b32 s19, 0x00020000
    s_mov_b32 s20, s4
    s_mov_b32 s21, s5
    s_and_b32 s21, s21, 0xffff
    s_mov_b32 s22, 2359296
    s_mov_b32 s23, 0x00020000
    s_add_u32 s24, s8, 2359296
    s_addc_u32 s25, s9, 0
    s_and_b32 s25, s25, 0xffff
    s_mov_b32 s26, 2359296
    s_mov_b32 s27, 0x00020000
    s_add_u32 s28, s8, 4718592
    s_addc_u32 s29, s9, 0
    s_and_b32 s29, s29, 0xffff
    s_mov_b32 s30, 98304
    s_mov_b32 s31, 0x00020000
    s_mul_i32 s36, s34, 192
    s_mov_b32 s37, 0x40000000
    v_add_u32 v170, 0, v0
    v_mul_u32_u24 v171, 4682, v170
    v_lshrrev_b32 v171, 16, v171
    v_mul_u32_u24 v172, 14, v171
    v_sub_u32 v172, v170, v172
    v_and_b32 v173, 4, v171
    v_lshlrev_b32 v173, 1, v173
    v_and_b32 v174, 8, v171
    v_lshrrev_b32 v174, 1, v174
    v_and_b32 v171, 0x13, v171
    v_or3_b32 v171, v171, v173, v174
    v_mul_u32_u24 v171, 1152, v171
    v_lshl_add_u32 v171, v172, 4, v171
    v_add_u32 v171, s36, v171
    v_cmp_gt_u32 vcc, 12, v172
    v_mov_b32 v173, s37
    s_nop 0
    v_cndmask_b32 v160, v173, v171, vcc
    v_add_u32 v170, 64, v0
    v_mul_u32_u24 v171, 4682, v170
    v_lshrrev_b32 v171, 16, v171
    v_mul_u32_u24 v172, 14, v171
    v_sub_u32 v172, v170, v172
    v_and_b32 v173, 4, v171
    v_lshlrev_b32 v173, 1, v173
    v_and_b32 v174, 8, v171
    v_lshrrev_b32 v174, 1, v174
    v_and_b32 v171, 0x13, v171
    v_or3_b32 v171, v171, v173, v174
    v_mul_u32_u24 v171, 1152, v171
    v_lshl_add_u32 v171, v172, 4, v171
    v_add_u32 v171, s36, v171
    v_cmp_gt_u32 vcc, 12, v172
    v_mov_b32 v173, s37
    s_nop 0
    v_cndmask_b32 v161, v173, v171, vcc
    v_add_u32 v170, 128, v0
    v_mul_u32_u24 v171, 4682, v170
    v_lshrrev_b32 v171, 16, v171
    v_mul_u32_u24 v172, 14, v171
    v_sub_u32 v172, v170, v172
    v_and_b32 v173, 4, v171
    v_lshlrev_b32 v173, 1, v173
    v_and_b32 v174, 8, v171
    v_lshrrev_b32 v174, 1, v174
    v_and_b32 v171, 0x13, v171
    v_or3_b32 v171, v171, v173, v174
    v_mul_u32_u24 v171, 1152, v171
    v_lshl_add_u32 v171, v172, 4, v171
    v_add_u32 v171, s36, v171
    v_cmp_gt_u32 vcc, 12, v172
    v_mov_b32 v173, s37
    s_nop 0
    v_cndmask_b32 v162, v173, v171, vcc
    v_add_u32 v170, 192, v0
    v_mul_u32_u24 v171, 4682, v170
    v_lshrrev_b32 v171, 16, v171
    v_mul_u32_u24 v172, 14, v171
    v_sub_u32 v172, v170, v172
    v_and_b32 v173, 4, v171
    v_lshlrev_b32 v173, 1, v173
    v_and_b32 v174, 8, v171
    v_lshrrev_b32 v174, 1, v174
    v_and_b32 v171, 0x13, v171
    v_or3_b32 v171, v171, v173, v174
    v_mul_u32_u24 v171, 1152, v171
    v_lshl_add_u32 v171, v172, 4, v171
    v_add_u32 v171, s36, v171
    v_cmp_gt_u32 vcc, 12, v172
    v_mov_b32 v173, s37
    s_nop 0
    v_cndmask_b32 v163, v173, v171, vcc
    v_add_u32 v170, 256, v0
    v_mul_u32_u24 v171, 4682, v170
    v_lshrrev_b32 v171, 16, v171
    v_mul_u32_u24 v172, 14, v171
    v_sub_u32 v172, v170, v172
    v_and_b32 v173, 4, v171
    v_lshlrev_b32 v173, 1, v173
    v_and_b32 v174, 8, v171
    v_lshrrev_b32 v174, 1, v174
    v_and_b32 v171, 0x13, v171
    v_or3_b32 v171, v171, v173, v174
    v_mul_u32_u24 v171, 1152, v171
    v_lshl_add_u32 v171, v172, 4, v171
    v_add_u32 v171, s36, v171
    v_cmp_gt_u32 vcc, 12, v172
    v_mov_b32 v173, s37
    s_nop 0
    v_cndmask_b32 v164, v173, v171, vcc
    v_add_u32 v170, 320, v0
    v_mul_u32_u24 v171, 4682, v170
    v_lshrrev_b32 v171, 16, v171
    v_mul_u32_u24 v172, 14, v171
    v_sub_u32 v172, v170, v172
    v_and_b32 v173, 4, v171
    v_lshlrev_b32 v173, 1, v173
    v_and_b32 v174, 8, v171
    v_lshrrev_b32 v174, 1, v174
    v_and_b32 v171, 0x13, v171
    v_or3_b32 v171, v171, v173, v174
    v_mul_u32_u24 v171, 1152, v171
    v_lshl_add_u32 v171, v172, 4, v171
    v_add_u32 v171, s36, v171
    v_cmp_gt_u32 vcc, 12, v172
    v_mov_b32 v173, s37
    s_nop 0
    v_cndmask_b32 v165, v173, v171, vcc
    v_add_u32 v170, 384, v0
    v_mul_u32_u24 v171, 4682, v170
    v_lshrrev_b32 v171, 16, v171
    v_mul_u32_u24 v172, 14, v171
    v_sub_u32 v172, v170, v172
    v_and_b32 v173, 4, v171
    v_lshlrev_b32 v173, 1, v173
    v_and_b32 v174, 8, v171
    v_lshrrev_b32 v174, 1, v174
    v_and_b32 v171, 0x13, v171
    v_or3_b32 v171, v171, v173, v174
    v_mul_u32_u24 v171, 1152, v171
    v_lshl_add_u32 v171, v172, 4, v171
    v_add_u32 v171, s36, v171
    v_cmp_gt_u32 vcc, 12, v172
    v_mov_b32 v173, s37
    s_nop 0
    v_cndmask_b32 v166, v173, v171, vcc
    s_lshl_b32 s36, s33, 6
    s_lshl_b32 s37, s32, 4
    s_add_u32 s36, s36, s37
    v_and_b32 v170, 15, v0
    v_add_u32 v170, s36, v170
    v_mul_u32_u24 v171, 1152, v170
    v_lshrrev_b32 v172, 4, v0
    s_lshr_b32 s40, s36, 4
    s_mul_i32 s40, s40, 18432
    v_lshlrev_b32 v173, 4, v0
    v_add_u32 v173, s40, v173
    v_lshl_add_u32 v174, v172, 3, v171
    s_movk_i32 s41, 4096
    s_movk_i32 s42, 8192
    s_movk_i32 s43, 12288
    s_movk_i32 s44, 16384
    s_mul_i32 s37, s34, 192
    s_mul_i32 s38, s32, 36864
    s_mul_i32 s39, s32, 7168
    s_add_u32 m0, s39, 0
    s_nop 0
    buffer_load_dwordx4 v160, s[12:15], s38 offen lds
    s_add_u32 m0, s39, 1024
    s_nop 0
    buffer_load_dwordx4 v161, s[12:15], s38 offen lds
    s_add_u32 m0, s39, 2048
    s_nop 0
    buffer_load_dwordx4 v162, s[12:15], s38 offen lds
    s_add_u32 m0, s39, 3072
    s_nop 0
    buffer_load_dwordx4 v163, s[12:15], s38 offen lds
    s_add_u32 m0, s39, 4096
    s_nop 0
    buffer_load_dwordx4 v164, s[12:15], s38 offen lds
    s_add_u32 m0, s39, 5120
    s_nop 0
    buffer_load_dwordx4 v165, s[12:15], s38 offen lds
    s_add_u32 m0, s39, 6144
    s_nop 0
    buffer_load_dwordx4 v166, s[12:15], s38 offen lds
    s_add_u32 s38, s38, 147456
    buffer_load_dwordx4 v[28:31], v173, s[16:19], 0 offen offset:0
    buffer_load_dwordx4 v[32:35], v173, s[16:19], 0 offen offset:1024
    buffer_load_dwordx4 v[36:39], v173, s[16:19], 0 offen offset:2048
    buffer_load_dwordx4 v[40:43], v173, s[16:19], 0 offen offset:3072
    s_add_u32 m0, s39, 28672
    s_nop 0
    buffer_load_dwordx4 v160, s[12:15], s38 offen lds
    s_add_u32 m0, s39, 29696
    s_nop 0
    buffer_load_dwordx4 v161, s[12:15], s38 offen lds
    s_add_u32 m0, s39, 30720
    s_nop 0
    buffer_load_dwordx4 v162, s[12:15], s38 offen lds
    s_add_u32 m0, s39, 31744
    s_nop 0
    buffer_load_dwordx4 v163, s[12:15], s38 offen lds
    s_add_u32 m0, s39, 32768
    s_nop 0
    buffer_load_dwordx4 v164, s[12:15], s38 offen lds
    s_add_u32 m0, s39, 33792
    s_nop 0
    buffer_load_dwordx4 v165, s[12:15], s38 offen lds
    s_add_u32 m0, s39, 34816
    s_nop 0
    buffer_load_dwordx4 v166, s[12:15], s38 offen lds
    s_add_u32 s38, s38, 147456
    buffer_load_dwordx4 v[44:47], v173, s[16:19], s41 offen offset:0
    buffer_load_dwordx4 v[48:51], v173, s[16:19], s41 offen offset:1024
    buffer_load_dwordx4 v[52:55], v173, s[16:19], s41 offen offset:2048
    buffer_load_dwordx4 v[56:59], v173, s[16:19], s41 offen offset:3072
    v_lshrrev_b32 v175, 5, v0
    v_lshlrev_b32 v175, 4, v175
    v_bfe_u32 v176, v0, 2, 3
    v_add_u32 v175, v175, v176
    v_mul_u32_u24 v175, 224, v175
    v_and_b32 v176, 3, v0
    v_lshl_add_u32 v167, v176, 3, v175
    v_add_u32 v168, 64512, v167
    s_waitcnt vmcnt(11)
    s_barrier
    ds_read_b64_tr_b16 v[112:113], v167 offset:0
    ds_read_b64_tr_b16 v[114:115], v167 offset:1792
    ds_read_b64_tr_b16 v[116:117], v167 offset:32
    ds_read_b64_tr_b16 v[118:119], v167 offset:1824
    ds_read_b64_tr_b16 v[120:121], v167 offset:64
    ds_read_b64_tr_b16 v[122:123], v167 offset:1856
    ds_read_b64_tr_b16 v[124:125], v167 offset:96
    ds_read_b64_tr_b16 v[126:127], v167 offset:1888
    ds_read_b64_tr_b16 v[128:129], v167 offset:128
    ds_read_b64_tr_b16 v[130:131], v167 offset:1920
    ds_read_b64_tr_b16 v[132:133], v167 offset:160
    ds_read_b64_tr_b16 v[134:135], v167 offset:1952
    ds_read_b64_tr_b16 v[136:137], v167 offset:7168
    ds_read_b64_tr_b16 v[138:139], v167 offset:8960
    ds_read_b64_tr_b16 v[140:141], v167 offset:7200
    ds_read_b64_tr_b16 v[142:143], v167 offset:8992
    ds_read_b64_tr_b16 v[144:145], v167 offset:7232
    ds_read_b64_tr_b16 v[146:147], v167 offset:9024
    ds_read_b64_tr_b16 v[148:149], v167 offset:7264
    ds_read_b64_tr_b16 v[150:151], v167 offset:9056
    ds_read_b64_tr_b16 v[152:153], v167 offset:7296
    ds_read_b64_tr_b16 v[154:155], v167 offset:9088
    ds_read_b64_tr_b16 v[156:157], v167 offset:7328
    ds_read_b64_tr_b16 v[158:159], v167 offset:9120
    s_waitcnt lgkmcnt(12)
    v_mfma_f32_16x16x32_bf16 v[4:7], v[112:115], v[28:31], 0
    s_add_u32 m0, s39, 57344
    s_nop 0
    buffer_load_dwordx4 v160, s[12:15], s38 offen lds
    v_mfma_f32_16x16x32_bf16 v[8:11], v[116:119], v[28:31], 0
    s_add_u32 m0, s39, 58368
    s_nop 0
    buffer_load_dwordx4 v161, s[12:15], s38 offen lds
    v_mfma_f32_16x16x32_bf16 v[12:15], v[120:123], v[28:31], 0
    s_add_u32 m0, s39, 59392
    s_nop 0
    buffer_load_dwordx4 v162, s[12:15], s38 offen lds
    v_mfma_f32_16x16x32_bf16 v[16:19], v[124:127], v[28:31], 0
    s_add_u32 m0, s39, 60416
    s_nop 0
    buffer_load_dwordx4 v163, s[12:15], s38 offen lds
    v_mfma_f32_16x16x32_bf16 v[20:23], v[128:131], v[28:31], 0
    s_add_u32 m0, s39, 61440
    s_nop 0
    buffer_load_dwordx4 v164, s[12:15], s38 offen lds
    v_mfma_f32_16x16x32_bf16 v[24:27], v[132:135], v[28:31], 0
    s_add_u32 m0, s39, 62464
    s_nop 0
    buffer_load_dwordx4 v165, s[12:15], s38 offen lds
    ds_read_b64_tr_b16 v[112:113], v167 offset:14336
    ds_read_b64_tr_b16 v[114:115], v167 offset:16128
    ds_read_b64_tr_b16 v[116:117], v167 offset:14368
    ds_read_b64_tr_b16 v[118:119], v167 offset:16160
    ds_read_b64_tr_b16 v[120:121], v167 offset:14400
    ds_read_b64_tr_b16 v[122:123], v167 offset:16192
    ds_read_b64_tr_b16 v[124:125], v167 offset:14432
    ds_read_b64_tr_b16 v[126:127], v167 offset:16224
    ds_read_b64_tr_b16 v[128:129], v167 offset:14464
    ds_read_b64_tr_b16 v[130:131], v167 offset:16256
    ds_read_b64_tr_b16 v[132:133], v167 offset:14496
    ds_read_b64_tr_b16 v[134:135], v167 offset:16288
    s_waitcnt lgkmcnt(12)
    v_mfma_f32_16x16x32_bf16 v[4:7], v[136:139], v[32:35], v[4:7]
    s_add_u32 m0, s39, 63488
    s_nop 0
    buffer_load_dwordx4 v166, s[12:15], s38 offen lds
    s_add_u32 s38, s38, 147456
    v_mfma_f32_16x16x32_bf16 v[8:11], v[140:143], v[32:35], v[8:11]
    buffer_load_dwordx4 v[60:63], v173, s[16:19], s42 offen offset:0
    v_mfma_f32_16x16x32_bf16 v[12:15], v[144:147], v[32:35], v[12:15]
    buffer_load_dwordx4 v[64:67], v173, s[16:19], s42 offen offset:1024
    v_mfma_f32_16x16x32_bf16 v[16:19], v[148:151], v[32:35], v[16:19]
    buffer_load_dwordx4 v[68:71], v173, s[16:19], s42 offen offset:2048
    v_mfma_f32_16x16x32_bf16 v[20:23], v[152:155], v[32:35], v[20:23]
    buffer_load_dwordx4 v[72:75], v173, s[16:19], s42 offen offset:3072
    v_mfma_f32_16x16x32_bf16 v[24:27], v[156:159], v[32:35], v[24:27]
    ds_read_b64_tr_b16 v[136:137], v167 offset:21504
    ds_read_b64_tr_b16 v[138:139], v167 offset:23296
    ds_read_b64_tr_b16 v[140:141], v167 offset:21536
    ds_read_b64_tr_b16 v[142:143], v167 offset:23328
    ds_read_b64_tr_b16 v[144:145], v167 offset:21568
    ds_read_b64_tr_b16 v[146:147], v167 offset:23360
    ds_read_b64_tr_b16 v[148:149], v167 offset:21600
    ds_read_b64_tr_b16 v[150:151], v167 offset:23392
    ds_read_b64_tr_b16 v[152:153], v167 offset:21632
    ds_read_b64_tr_b16 v[154:155], v167 offset:23424
    ds_read_b64_tr_b16 v[156:157], v167 offset:21664
    ds_read_b64_tr_b16 v[158:159], v167 offset:23456
    s_waitcnt lgkmcnt(12)
    v_mfma_f32_16x16x32_bf16 v[4:7], v[112:115], v[36:39], v[4:7]
    v_mfma_f32_16x16x32_bf16 v[8:11], v[116:119], v[36:39], v[8:11]
    v_mfma_f32_16x16x32_bf16 v[12:15], v[120:123], v[36:39], v[12:15]
    v_mfma_f32_16x16x32_bf16 v[16:19], v[124:127], v[36:39], v[16:19]
    v_mfma_f32_16x16x32_bf16 v[20:23], v[128:131], v[36:39], v[20:23]
    v_mfma_f32_16x16x32_bf16 v[24:27], v[132:135], v[36:39], v[24:27]
    s_waitcnt lgkmcnt(0)
    v_mfma_f32_16x16x32_bf16 v[4:7], v[136:139], v[40:43], v[4:7]
    v_mfma_f32_16x16x32_bf16 v[8:11], v[140:143], v[40:43], v[8:11]
    v_mfma_f32_16x16x32_bf16 v[12:15], v[144:147], v[40:43], v[12:15]
    v_mfma_f32_16x16x32_bf16 v[16:19], v[148:151], v[40:43], v[16:19]
    v_mfma_f32_16x16x32_bf16 v[20:23], v[152:155], v[40:43], v[20:23]
    v_mfma_f32_16x16x32_bf16 v[24:27], v[156:159], v[40:43], v[24:27]
    s_waitcnt vmcnt(11)
    s_barrier
    ds_read_b64_tr_b16 v[112:113], v167 offset:28672
    ds_read_b64_tr_b16 v[114:115], v167 offset:30464
    ds_read_b64_tr_b16 v[116:117], v167 offset:28704
    ds_read_b64_tr_b16 v[118:119], v167 offset:30496
    ds_read_b64_tr_b16 v[120:121], v167 offset:28736
    ds_read_b64_tr_b16 v[122:123], v167 offset:30528
    ds_read_b64_tr_b16 v[124:125], v167 offset:28768
    ds_read_b64_tr_b16 v[126:127], v167 offset:30560
    ds_read_b64_tr_b16 v[128:129], v167 offset:28800
    ds_read_b64_tr_b16 v[130:131], v167 offset:30592
    ds_read_b64_tr_b16 v[132:133], v167 offset:28832
    ds_read_b64_tr_b16 v[134:135], v167 offset:30624
    ds_read_b64_tr_b16 v[136:137], v167 offset:35840
    ds_read_b64_tr_b16 v[138:139], v167 offset:37632
    ds_read_b64_tr_b16 v[140:141], v167 offset:35872
    ds_read_b64_tr_b16 v[142:143], v167 offset:37664
    ds_read_b64_tr_b16 v[144:145], v167 offset:35904
    ds_read_b64_tr_b16 v[146:147], v167 offset:37696
    ds_read_b64_tr_b16 v[148:149], v167 offset:35936
    ds_read_b64_tr_b16 v[150:151], v167 offset:37728
    ds_read_b64_tr_b16 v[152:153], v167 offset:35968
    ds_read_b64_tr_b16 v[154:155], v167 offset:37760
    ds_read_b64_tr_b16 v[156:157], v167 offset:36000
    ds_read_b64_tr_b16 v[158:159], v167 offset:37792
    s_waitcnt lgkmcnt(12)
    v_mfma_f32_16x16x32_bf16 v[4:7], v[112:115], v[44:47], v[4:7]
    s_add_u32 m0, s39, 86016
    s_nop 0
    buffer_load_dwordx4 v160, s[12:15], s38 offen lds
    v_mfma_f32_16x16x32_bf16 v[8:11], v[116:119], v[44:47], v[8:11]
    s_add_u32 m0, s39, 87040
    s_nop 0
    buffer_load_dwordx4 v161, s[12:15], s38 offen lds
    v_mfma_f32_16x16x32_bf16 v[12:15], v[120:123], v[44:47], v[12:15]
    s_add_u32 m0, s39, 88064
    s_nop 0
    buffer_load_dwordx4 v162, s[12:15], s38 offen lds
    v_mfma_f32_16x16x32_bf16 v[16:19], v[124:127], v[44:47], v[16:19]
    s_add_u32 m0, s39, 89088
    s_nop 0
    buffer_load_dwordx4 v163, s[12:15], s38 offen lds
    v_mfma_f32_16x16x32_bf16 v[20:23], v[128:131], v[44:47], v[20:23]
    s_add_u32 m0, s39, 90112
    s_nop 0
    buffer_load_dwordx4 v164, s[12:15], s38 offen lds
    v_mfma_f32_16x16x32_bf16 v[24:27], v[132:135], v[44:47], v[24:27]
    s_add_u32 m0, s39, 91136
    s_nop 0
    buffer_load_dwordx4 v165, s[12:15], s38 offen lds
    ds_read_b64_tr_b16 v[112:113], v167 offset:43008
    ds_read_b64_tr_b16 v[114:115], v167 offset:44800
    ds_read_b64_tr_b16 v[116:117], v167 offset:43040
    ds_read_b64_tr_b16 v[118:119], v167 offset:44832
    ds_read_b64_tr_b16 v[120:121], v167 offset:43072
    ds_read_b64_tr_b16 v[122:123], v167 offset:44864
    ds_read_b64_tr_b16 v[124:125], v167 offset:43104
    ds_read_b64_tr_b16 v[126:127], v167 offset:44896
    ds_read_b64_tr_b16 v[128:129], v167 offset:43136
    ds_read_b64_tr_b16 v[130:131], v167 offset:44928
    ds_read_b64_tr_b16 v[132:133], v167 offset:43168
    ds_read_b64_tr_b16 v[134:135], v167 offset:44960
    s_waitcnt lgkmcnt(12)
    v_mfma_f32_16x16x32_bf16 v[4:7], v[136:139], v[48:51], v[4:7]
    s_add_u32 m0, s39, 92160
    s_nop 0
    buffer_load_dwordx4 v166, s[12:15], s38 offen lds
    s_add_u32 s38, s38, 147456
    v_mfma_f32_16x16x32_bf16 v[8:11], v[140:143], v[48:51], v[8:11]
    buffer_load_dwordx4 v[76:79], v173, s[16:19], s43 offen offset:0
    v_mfma_f32_16x16x32_bf16 v[12:15], v[144:147], v[48:51], v[12:15]
    buffer_load_dwordx4 v[80:83], v173, s[16:19], s43 offen offset:1024
    v_mfma_f32_16x16x32_bf16 v[16:19], v[148:151], v[48:51], v[16:19]
    buffer_load_dwordx4 v[84:87], v173, s[16:19], s43 offen offset:2048
    v_mfma_f32_16x16x32_bf16 v[20:23], v[152:155], v[48:51], v[20:23]
    buffer_load_dwordx4 v[88:91], v173, s[16:19], s43 offen offset:3072
    v_mfma_f32_16x16x32_bf16 v[24:27], v[156:159], v[48:51], v[24:27]
    ds_read_b64_tr_b16 v[136:137], v167 offset:50176
    ds_read_b64_tr_b16 v[138:139], v167 offset:51968
    ds_read_b64_tr_b16 v[140:141], v167 offset:50208
    ds_read_b64_tr_b16 v[142:143], v167 offset:52000
    ds_read_b64_tr_b16 v[144:145], v167 offset:50240
    ds_read_b64_tr_b16 v[146:147], v167 offset:52032
    ds_read_b64_tr_b16 v[148:149], v167 offset:50272
    ds_read_b64_tr_b16 v[150:151], v167 offset:52064
    ds_read_b64_tr_b16 v[152:153], v167 offset:50304
    ds_read_b64_tr_b16 v[154:155], v167 offset:52096
    ds_read_b64_tr_b16 v[156:157], v167 offset:50336
    ds_read_b64_tr_b16 v[158:159], v167 offset:52128
    s_waitcnt lgkmcnt(12)
    v_mfma_f32_16x16x32_bf16 v[4:7], v[112:115], v[52:55], v[4:7]
    v_mfma_f32_16x16x32_bf16 v[8:11], v[116:119], v[52:55], v[8:11]
    v_mfma_f32_16x16x32_bf16 v[12:15], v[120:123], v[52:55], v[12:15]
    v_mfma_f32_16x16x32_bf16 v[16:19], v[124:127], v[52:55], v[16:19]
    v_mfma_f32_16x16x32_bf16 v[20:23], v[128:131], v[52:55], v[20:23]
    v_mfma_f32_16x16x32_bf16 v[24:27], v[132:135], v[52:55], v[24:27]
    s_waitcnt lgkmcnt(0)
    v_mfma_f32_16x16x32_bf16 v[4:7], v[136:139], v[56:59], v[4:7]
    v_mfma_f32_16x16x32_bf16 v[8:11], v[140:143], v[56:59], v[8:11]
    v_mfma_f32_16x16x32_bf16 v[12:15], v[144:147], v[56:59], v[12:15]
    v_mfma_f32_16x16x32_bf16 v[16:19], v[148:151], v[56:59], v[16:19]
    v_mfma_f32_16x16x32_bf16 v[20:23], v[152:155], v[56:59], v[20:23]
    v_mfma_f32_16x16x32_bf16 v[24:27], v[156:159], v[56:59], v[24:27]
    s_waitcnt vmcnt(11)
    s_barrier
    ds_read_b64_tr_b16 v[112:113], v167 offset:57344
    ds_read_b64_tr_b16 v[114:115], v167 offset:59136
    ds_read_b64_tr_b16 v[116:117], v167 offset:57376
    ds_read_b64_tr_b16 v[118:119], v167 offset:59168
    ds_read_b64_tr_b16 v[120:121], v167 offset:57408
    ds_read_b64_tr_b16 v[122:123], v167 offset:59200
    ds_read_b64_tr_b16 v[124:125], v167 offset:57440
    ds_read_b64_tr_b16 v[126:127], v167 offset:59232
    ds_read_b64_tr_b16 v[128:129], v167 offset:57472
    ds_read_b64_tr_b16 v[130:131], v167 offset:59264
    ds_read_b64_tr_b16 v[132:133], v167 offset:57504
    ds_read_b64_tr_b16 v[134:135], v167 offset:59296
    ds_read_b64_tr_b16 v[136:137], v168 offset:0
    ds_read_b64_tr_b16 v[138:139], v168 offset:1792
    ds_read_b64_tr_b16 v[140:141], v168 offset:32
    ds_read_b64_tr_b16 v[142:143], v168 offset:1824
    ds_read_b64_tr_b16 v[144:145], v168 offset:64
    ds_read_b64_tr_b16 v[146:147], v168 offset:1856
    ds_read_b64_tr_b16 v[148:149], v168 offset:96
    ds_read_b64_tr_b16 v[150:151], v168 offset:1888
    ds_read_b64_tr_b16 v[152:153], v168 offset:128
    ds_read_b64_tr_b16 v[154:155], v168 offset:1920
    ds_read_b64_tr_b16 v[156:157], v168 offset:160
    ds_read_b64_tr_b16 v[158:159], v168 offset:1952
    s_waitcnt lgkmcnt(12)
    v_mfma_f32_16x16x32_bf16 v[4:7], v[112:115], v[60:63], v[4:7]
    s_add_u32 m0, s39, 114688
    s_nop 0
    buffer_load_dwordx4 v160, s[12:15], s38 offen lds
    v_mfma_f32_16x16x32_bf16 v[8:11], v[116:119], v[60:63], v[8:11]
    s_add_u32 m0, s39, 115712
    s_nop 0
    buffer_load_dwordx4 v161, s[12:15], s38 offen lds
    v_mfma_f32_16x16x32_bf16 v[12:15], v[120:123], v[60:63], v[12:15]
    s_add_u32 m0, s39, 116736
    s_nop 0
    buffer_load_dwordx4 v162, s[12:15], s38 offen lds
    v_mfma_f32_16x16x32_bf16 v[16:19], v[124:127], v[60:63], v[16:19]
    s_add_u32 m0, s39, 117760
    s_nop 0
    buffer_load_dwordx4 v163, s[12:15], s38 offen lds
    v_mfma_f32_16x16x32_bf16 v[20:23], v[128:131], v[60:63], v[20:23]
    s_add_u32 m0, s39, 118784
    s_nop 0
    buffer_load_dwordx4 v164, s[12:15], s38 offen lds
    v_mfma_f32_16x16x32_bf16 v[24:27], v[132:135], v[60:63], v[24:27]
    s_add_u32 m0, s39, 119808
    s_nop 0
    buffer_load_dwordx4 v165, s[12:15], s38 offen lds
    ds_read_b64_tr_b16 v[112:113], v168 offset:7168
    ds_read_b64_tr_b16 v[114:115], v168 offset:8960
    ds_read_b64_tr_b16 v[116:117], v168 offset:7200
    ds_read_b64_tr_b16 v[118:119], v168 offset:8992
    ds_read_b64_tr_b16 v[120:121], v168 offset:7232
    ds_read_b64_tr_b16 v[122:123], v168 offset:9024
    ds_read_b64_tr_b16 v[124:125], v168 offset:7264
    ds_read_b64_tr_b16 v[126:127], v168 offset:9056
    ds_read_b64_tr_b16 v[128:129], v168 offset:7296
    ds_read_b64_tr_b16 v[130:131], v168 offset:9088
    ds_read_b64_tr_b16 v[132:133], v168 offset:7328
    ds_read_b64_tr_b16 v[134:135], v168 offset:9120
    s_waitcnt lgkmcnt(12)
    v_mfma_f32_16x16x32_bf16 v[4:7], v[136:139], v[64:67], v[4:7]
    s_add_u32 m0, s39, 120832
    s_nop 0
    buffer_load_dwordx4 v166, s[12:15], s38 offen lds
    s_add_u32 s38, s38, 147456
    v_mfma_f32_16x16x32_bf16 v[8:11], v[140:143], v[64:67], v[8:11]
    buffer_load_dwordx4 v[92:95], v173, s[16:19], s44 offen offset:0
    v_mfma_f32_16x16x32_bf16 v[12:15], v[144:147], v[64:67], v[12:15]
    buffer_load_dwordx4 v[96:99], v173, s[16:19], s44 offen offset:1024
    v_mfma_f32_16x16x32_bf16 v[16:19], v[148:151], v[64:67], v[16:19]
    buffer_load_dwordx2 v[100:101], v174, s[20:23], s37 offen offset:0
    v_mfma_f32_16x16x32_bf16 v[20:23], v[152:155], v[64:67], v[20:23]
    buffer_load_dwordx2 v[102:103], v174, s[20:23], s37 offen offset:32
    v_mfma_f32_16x16x32_bf16 v[24:27], v[156:159], v[64:67], v[24:27]
    buffer_load_dwordx2 v[104:105], v174, s[20:23], s37 offen offset:64
    ds_read_b64_tr_b16 v[136:137], v168 offset:14336
    ds_read_b64_tr_b16 v[138:139], v168 offset:16128
    ds_read_b64_tr_b16 v[140:141], v168 offset:14368
    ds_read_b64_tr_b16 v[142:143], v168 offset:16160
    ds_read_b64_tr_b16 v[144:145], v168 offset:14400
    ds_read_b64_tr_b16 v[146:147], v168 offset:16192
    ds_read_b64_tr_b16 v[148:149], v168 offset:14432
    ds_read_b64_tr_b16 v[150:151], v168 offset:16224
    ds_read_b64_tr_b16 v[152:153], v168 offset:14464
    ds_read_b64_tr_b16 v[154:155], v168 offset:16256
    ds_read_b64_tr_b16 v[156:157], v168 offset:14496
    ds_read_b64_tr_b16 v[158:159], v168 offset:16288
    s_waitcnt lgkmcnt(12)
    v_mfma_f32_16x16x32_bf16 v[4:7], v[112:115], v[68:71], v[4:7]
    buffer_load_dwordx2 v[106:107], v174, s[20:23], s37 offen offset:96
    v_mfma_f32_16x16x32_bf16 v[8:11], v[116:119], v[68:71], v[8:11]
    buffer_load_dwordx2 v[108:109], v174, s[20:23], s37 offen offset:128
    v_mfma_f32_16x16x32_bf16 v[12:15], v[120:123], v[68:71], v[12:15]
    buffer_load_dwordx2 v[110:111], v174, s[20:23], s37 offen offset:160
    v_mfma_f32_16x16x32_bf16 v[16:19], v[124:127], v[68:71], v[16:19]
    v_mfma_f32_16x16x32_bf16 v[20:23], v[128:131], v[68:71], v[20:23]
    v_mfma_f32_16x16x32_bf16 v[24:27], v[132:135], v[68:71], v[24:27]
    s_waitcnt lgkmcnt(0)
    v_mfma_f32_16x16x32_bf16 v[4:7], v[136:139], v[72:75], v[4:7]
    v_mfma_f32_16x16x32_bf16 v[8:11], v[140:143], v[72:75], v[8:11]
    v_mfma_f32_16x16x32_bf16 v[12:15], v[144:147], v[72:75], v[12:15]
    v_mfma_f32_16x16x32_bf16 v[16:19], v[148:151], v[72:75], v[16:19]
    v_mfma_f32_16x16x32_bf16 v[20:23], v[152:155], v[72:75], v[20:23]
    v_mfma_f32_16x16x32_bf16 v[24:27], v[156:159], v[72:75], v[24:27]
    s_waitcnt vmcnt(15)
    s_barrier
    ds_read_b64_tr_b16 v[112:113], v168 offset:21504
    ds_read_b64_tr_b16 v[114:115], v168 offset:23296
    ds_read_b64_tr_b16 v[116:117], v168 offset:21536
    ds_read_b64_tr_b16 v[118:119], v168 offset:23328
    ds_read_b64_tr_b16 v[120:121], v168 offset:21568
    ds_read_b64_tr_b16 v[122:123], v168 offset:23360
    ds_read_b64_tr_b16 v[124:125], v168 offset:21600
    ds_read_b64_tr_b16 v[126:127], v168 offset:23392
    ds_read_b64_tr_b16 v[128:129], v168 offset:21632
    ds_read_b64_tr_b16 v[130:131], v168 offset:23424
    ds_read_b64_tr_b16 v[132:133], v168 offset:21664
    ds_read_b64_tr_b16 v[134:135], v168 offset:23456
    ds_read_b64_tr_b16 v[136:137], v168 offset:28672
    ds_read_b64_tr_b16 v[138:139], v168 offset:30464
    ds_read_b64_tr_b16 v[140:141], v168 offset:28704
    ds_read_b64_tr_b16 v[142:143], v168 offset:30496
    ds_read_b64_tr_b16 v[144:145], v168 offset:28736
    ds_read_b64_tr_b16 v[146:147], v168 offset:30528
    ds_read_b64_tr_b16 v[148:149], v168 offset:28768
    ds_read_b64_tr_b16 v[150:151], v168 offset:30560
    ds_read_b64_tr_b16 v[152:153], v168 offset:28800
    ds_read_b64_tr_b16 v[154:155], v168 offset:30592
    ds_read_b64_tr_b16 v[156:157], v168 offset:28832
    ds_read_b64_tr_b16 v[158:159], v168 offset:30624
    s_waitcnt lgkmcnt(12)
    v_mfma_f32_16x16x32_bf16 v[4:7], v[112:115], v[76:79], v[4:7]
    v_mfma_f32_16x16x32_bf16 v[8:11], v[116:119], v[76:79], v[8:11]
    v_mfma_f32_16x16x32_bf16 v[12:15], v[120:123], v[76:79], v[12:15]
    v_mfma_f32_16x16x32_bf16 v[16:19], v[124:127], v[76:79], v[16:19]
    v_mfma_f32_16x16x32_bf16 v[20:23], v[128:131], v[76:79], v[20:23]
    v_mfma_f32_16x16x32_bf16 v[24:27], v[132:135], v[76:79], v[24:27]
    ds_read_b64_tr_b16 v[112:113], v168 offset:35840
    ds_read_b64_tr_b16 v[114:115], v168 offset:37632
    ds_read_b64_tr_b16 v[116:117], v168 offset:35872
    ds_read_b64_tr_b16 v[118:119], v168 offset:37664
    ds_read_b64_tr_b16 v[120:121], v168 offset:35904
    ds_read_b64_tr_b16 v[122:123], v168 offset:37696
    ds_read_b64_tr_b16 v[124:125], v168 offset:35936
    ds_read_b64_tr_b16 v[126:127], v168 offset:37728
    ds_read_b64_tr_b16 v[128:129], v168 offset:35968
    ds_read_b64_tr_b16 v[130:131], v168 offset:37760
    ds_read_b64_tr_b16 v[132:133], v168 offset:36000
    ds_read_b64_tr_b16 v[134:135], v168 offset:37792
    s_waitcnt lgkmcnt(12)
    v_mfma_f32_16x16x32_bf16 v[4:7], v[136:139], v[80:83], v[4:7]
    v_mfma_f32_16x16x32_bf16 v[8:11], v[140:143], v[80:83], v[8:11]
    v_mfma_f32_16x16x32_bf16 v[12:15], v[144:147], v[80:83], v[12:15]
    v_mfma_f32_16x16x32_bf16 v[16:19], v[148:151], v[80:83], v[16:19]
    v_mfma_f32_16x16x32_bf16 v[20:23], v[152:155], v[80:83], v[20:23]
    v_mfma_f32_16x16x32_bf16 v[24:27], v[156:159], v[80:83], v[24:27]
    ds_read_b64_tr_b16 v[136:137], v168 offset:43008
    ds_read_b64_tr_b16 v[138:139], v168 offset:44800
    ds_read_b64_tr_b16 v[140:141], v168 offset:43040
    ds_read_b64_tr_b16 v[142:143], v168 offset:44832
    ds_read_b64_tr_b16 v[144:145], v168 offset:43072
    ds_read_b64_tr_b16 v[146:147], v168 offset:44864
    ds_read_b64_tr_b16 v[148:149], v168 offset:43104
    ds_read_b64_tr_b16 v[150:151], v168 offset:44896
    ds_read_b64_tr_b16 v[152:153], v168 offset:43136
    ds_read_b64_tr_b16 v[154:155], v168 offset:44928
    ds_read_b64_tr_b16 v[156:157], v168 offset:43168
    ds_read_b64_tr_b16 v[158:159], v168 offset:44960
    s_waitcnt lgkmcnt(12)
    v_mfma_f32_16x16x32_bf16 v[4:7], v[112:115], v[84:87], v[4:7]
    v_mfma_f32_16x16x32_bf16 v[8:11], v[116:119], v[84:87], v[8:11]
    v_mfma_f32_16x16x32_bf16 v[12:15], v[120:123], v[84:87], v[12:15]
    v_mfma_f32_16x16x32_bf16 v[16:19], v[124:127], v[84:87], v[16:19]
    v_mfma_f32_16x16x32_bf16 v[20:23], v[128:131], v[84:87], v[20:23]
    v_mfma_f32_16x16x32_bf16 v[24:27], v[132:135], v[84:87], v[24:27]
    s_waitcnt lgkmcnt(0)
    v_mfma_f32_16x16x32_bf16 v[4:7], v[136:139], v[88:91], v[4:7]
    v_mfma_f32_16x16x32_bf16 v[8:11], v[140:143], v[88:91], v[8:11]
    v_mfma_f32_16x16x32_bf16 v[12:15], v[144:147], v[88:91], v[12:15]
    v_mfma_f32_16x16x32_bf16 v[16:19], v[148:151], v[88:91], v[16:19]
    v_mfma_f32_16x16x32_bf16 v[20:23], v[152:155], v[88:91], v[20:23]
    v_mfma_f32_16x16x32_bf16 v[24:27], v[156:159], v[88:91], v[24:27]
    s_waitcnt vmcnt(6)
    s_barrier
    ds_read_b64_tr_b16 v[112:113], v168 offset:50176
    ds_read_b64_tr_b16 v[114:115], v168 offset:51968
    ds_read_b64_tr_b16 v[116:117], v168 offset:50208
    ds_read_b64_tr_b16 v[118:119], v168 offset:52000
    ds_read_b64_tr_b16 v[120:121], v168 offset:50240
    ds_read_b64_tr_b16 v[122:123], v168 offset:52032
    ds_read_b64_tr_b16 v[124:125], v168 offset:50272
    ds_read_b64_tr_b16 v[126:127], v168 offset:52064
    ds_read_b64_tr_b16 v[128:129], v168 offset:50304
    ds_read_b64_tr_b16 v[130:131], v168 offset:52096
    ds_read_b64_tr_b16 v[132:133], v168 offset:50336
    ds_read_b64_tr_b16 v[134:135], v168 offset:52128
    ds_read_b64_tr_b16 v[136:137], v168 offset:57344
    ds_read_b64_tr_b16 v[138:139], v168 offset:59136
    ds_read_b64_tr_b16 v[140:141], v168 offset:57376
    ds_read_b64_tr_b16 v[142:143], v168 offset:59168
    ds_read_b64_tr_b16 v[144:145], v168 offset:57408
    ds_read_b64_tr_b16 v[146:147], v168 offset:59200
    ds_read_b64_tr_b16 v[148:149], v168 offset:57440
    ds_read_b64_tr_b16 v[150:151], v168 offset:59232
    ds_read_b64_tr_b16 v[152:153], v168 offset:57472
    ds_read_b64_tr_b16 v[154:155], v168 offset:59264
    ds_read_b64_tr_b16 v[156:157], v168 offset:57504
    ds_read_b64_tr_b16 v[158:159], v168 offset:59296
    s_waitcnt lgkmcnt(12)
    v_mfma_f32_16x16x32_bf16 v[4:7], v[112:115], v[92:95], v[4:7]
    v_mfma_f32_16x16x32_bf16 v[8:11], v[116:119], v[92:95], v[8:11]
    v_mfma_f32_16x16x32_bf16 v[12:15], v[120:123], v[92:95], v[12:15]
    v_mfma_f32_16x16x32_bf16 v[16:19], v[124:127], v[92:95], v[16:19]
    v_mfma_f32_16x16x32_bf16 v[20:23], v[128:131], v[92:95], v[20:23]
    v_mfma_f32_16x16x32_bf16 v[24:27], v[132:135], v[92:95], v[24:27]
    s_waitcnt lgkmcnt(0)
    v_mfma_f32_16x16x32_bf16 v[4:7], v[136:139], v[96:99], v[4:7]
    v_mfma_f32_16x16x32_bf16 v[8:11], v[140:143], v[96:99], v[8:11]
    v_mfma_f32_16x16x32_bf16 v[12:15], v[144:147], v[96:99], v[12:15]
    v_mfma_f32_16x16x32_bf16 v[16:19], v[148:151], v[96:99], v[16:19]
    v_mfma_f32_16x16x32_bf16 v[20:23], v[152:155], v[96:99], v[20:23]
    v_mfma_f32_16x16x32_bf16 v[24:27], v[156:159], v[96:99], v[24:27]
    s_waitcnt vmcnt(0)
    s_nop 7
    v_cvt_pk_bf16_f32 v170, v4, v5
    v_lshlrev_b32 v4, 16, v170
    v_and_b32 v5, 0xffff0000, v170
    v_lshlrev_b32 v171, 16, v100
    v_and_b32 v172, 0xffff0000, v100
    v_add_f32 v4, v4, v171
    v_add_f32 v5, v5, v172
    v_cvt_pk_bf16_f32 v112, v4, v5
    v_lshlrev_b32 v4, 16, v112
    v_and_b32 v5, 0xffff0000, v112
    v_cvt_pk_bf16_f32 v170, v6, v7
    v_lshlrev_b32 v6, 16, v170
    v_and_b32 v7, 0xffff0000, v170
    v_lshlrev_b32 v171, 16, v101
    v_and_b32 v172, 0xffff0000, v101
    v_add_f32 v6, v6, v171
    v_add_f32 v7, v7, v172
    v_cvt_pk_bf16_f32 v113, v6, v7
    v_lshlrev_b32 v6, 16, v113
    v_and_b32 v7, 0xffff0000, v113
    v_cvt_pk_bf16_f32 v170, v8, v9
    v_lshlrev_b32 v8, 16, v170
    v_and_b32 v9, 0xffff0000, v170
    v_lshlrev_b32 v171, 16, v102
    v_and_b32 v172, 0xffff0000, v102
    v_add_f32 v8, v8, v171
    v_add_f32 v9, v9, v172
    v_cvt_pk_bf16_f32 v114, v8, v9
    v_lshlrev_b32 v8, 16, v114
    v_and_b32 v9, 0xffff0000, v114
    v_cvt_pk_bf16_f32 v170, v10, v11
    v_lshlrev_b32 v10, 16, v170
    v_and_b32 v11, 0xffff0000, v170
    v_lshlrev_b32 v171, 16, v103
    v_and_b32 v172, 0xffff0000, v103
    v_add_f32 v10, v10, v171
    v_add_f32 v11, v11, v172
    v_cvt_pk_bf16_f32 v115, v10, v11
    v_lshlrev_b32 v10, 16, v115
    v_and_b32 v11, 0xffff0000, v115
    v_cvt_pk_bf16_f32 v170, v12, v13
    v_lshlrev_b32 v12, 16, v170
    v_and_b32 v13, 0xffff0000, v170
    v_lshlrev_b32 v171, 16, v104
    v_and_b32 v172, 0xffff0000, v104
    v_add_f32 v12, v12, v171
    v_add_f32 v13, v13, v172
    v_cvt_pk_bf16_f32 v116, v12, v13
    v_lshlrev_b32 v12, 16, v116
    v_and_b32 v13, 0xffff0000, v116
    v_cvt_pk_bf16_f32 v170, v14, v15
    v_lshlrev_b32 v14, 16, v170
    v_and_b32 v15, 0xffff0000, v170
    v_lshlrev_b32 v171, 16, v105
    v_and_b32 v172, 0xffff0000, v105
    v_add_f32 v14, v14, v171
    v_add_f32 v15, v15, v172
    v_cvt_pk_bf16_f32 v117, v14, v15
    v_lshlrev_b32 v14, 16, v117
    v_and_b32 v15, 0xffff0000, v117
    v_cvt_pk_bf16_f32 v170, v16, v17
    v_lshlrev_b32 v16, 16, v170
    v_and_b32 v17, 0xffff0000, v170
    v_lshlrev_b32 v171, 16, v106
    v_and_b32 v172, 0xffff0000, v106
    v_add_f32 v16, v16, v171
    v_add_f32 v17, v17, v172
    v_cvt_pk_bf16_f32 v118, v16, v17
    v_lshlrev_b32 v16, 16, v118
    v_and_b32 v17, 0xffff0000, v118
    v_cvt_pk_bf16_f32 v170, v18, v19
    v_lshlrev_b32 v18, 16, v170
    v_and_b32 v19, 0xffff0000, v170
    v_lshlrev_b32 v171, 16, v107
    v_and_b32 v172, 0xffff0000, v107
    v_add_f32 v18, v18, v171
    v_add_f32 v19, v19, v172
    v_cvt_pk_bf16_f32 v119, v18, v19
    v_lshlrev_b32 v18, 16, v119
    v_and_b32 v19, 0xffff0000, v119
    v_cvt_pk_bf16_f32 v170, v20, v21
    v_lshlrev_b32 v20, 16, v170
    v_and_b32 v21, 0xffff0000, v170
    v_lshlrev_b32 v171, 16, v108
    v_and_b32 v172, 0xffff0000, v108
    v_add_f32 v20, v20, v171
    v_add_f32 v21, v21, v172
    v_cvt_pk_bf16_f32 v120, v20, v21
    v_lshlrev_b32 v20, 16, v120
    v_and_b32 v21, 0xffff0000, v120
    v_cvt_pk_bf16_f32 v170, v22, v23
    v_lshlrev_b32 v22, 16, v170
    v_and_b32 v23, 0xffff0000, v170
    v_lshlrev_b32 v171, 16, v109
    v_and_b32 v172, 0xffff0000, v109
    v_add_f32 v22, v22, v171
    v_add_f32 v23, v23, v172
    v_cvt_pk_bf16_f32 v121, v22, v23
    v_lshlrev_b32 v22, 16, v121
    v_and_b32 v23, 0xffff0000, v121
    v_cvt_pk_bf16_f32 v170, v24, v25
    v_lshlrev_b32 v24, 16, v170
    v_and_b32 v25, 0xffff0000, v170
    v_lshlrev_b32 v171, 16, v110
    v_and_b32 v172, 0xffff0000, v110
    v_add_f32 v24, v24, v171
    v_add_f32 v25, v25, v172
    v_cvt_pk_bf16_f32 v122, v24, v25
    v_lshlrev_b32 v24, 16, v122
    v_and_b32 v25, 0xffff0000, v122
    v_cvt_pk_bf16_f32 v170, v26, v27
    v_lshlrev_b32 v26, 16, v170
    v_and_b32 v27, 0xffff0000, v170
    v_lshlrev_b32 v171, 16, v111
    v_and_b32 v172, 0xffff0000, v111
    v_add_f32 v26, v26, v171
    v_add_f32 v27, v27, v172
    v_cvt_pk_bf16_f32 v123, v26, v27
    v_lshlrev_b32 v26, 16, v123
    v_and_b32 v27, 0xffff0000, v123
    s_lshl_b32 s36, s33, 2
    s_add_u32 s36, s36, s32
    s_mul_i32 s37, s36, 18
    s_mul_i32 s38, s34, 3
    s_add_u32 s37, s37, s38
    s_lshl_b32 s37, s37, 10
    v_lshlrev_b32 v170, 4, v0
    buffer_store_dwordx4 v[112:115], v170, s[24:27], s37 offen offset:0
    buffer_store_dwordx4 v[116:119], v170, s[24:27], s37 offen offset:1024
    buffer_store_dwordx4 v[120:123], v170, s[24:27], s37 offen offset:2048
    v_add_f32 v174, v4, v5
    v_add_f32 v174, v174, v6
    v_add_f32 v174, v174, v7
    v_add_f32 v174, v174, v8
    v_add_f32 v174, v174, v9
    v_add_f32 v174, v174, v10
    v_add_f32 v174, v174, v11
    v_add_f32 v174, v174, v12
    v_add_f32 v174, v174, v13
    v_add_f32 v174, v174, v14
    v_add_f32 v174, v174, v15
    v_add_f32 v174, v174, v16
    v_add_f32 v174, v174, v17
    v_add_f32 v174, v174, v18
    v_add_f32 v174, v174, v19
    v_add_f32 v174, v174, v20
    v_add_f32 v174, v174, v21
    v_add_f32 v174, v174, v22
    v_add_f32 v174, v174, v23
    v_add_f32 v174, v174, v24
    v_add_f32 v174, v174, v25
    v_add_f32 v174, v174, v26
    v_add_f32 v174, v174, v27
    v_xor_b32 v176, 16, v0
    v_lshlrev_b32 v176, 2, v176
    ds_bpermute_b32 v177, v176, v174
    s_waitcnt lgkmcnt(0)
    v_add_f32 v174, v174, v177
    v_xor_b32 v176, 32, v0
    v_lshlrev_b32 v176, 2, v176
    ds_bpermute_b32 v177, v176, v174
    s_waitcnt lgkmcnt(0)
    v_add_f32 v174, v174, v177
    v_mul_f32 v174, 1009429163, v174
    v_mov_b32 v175, 0
    v_sub_f32 v171, v4, v174
    v_fmac_f32 v175, v171, v171
    v_sub_f32 v171, v5, v174
    v_fmac_f32 v175, v171, v171
    v_sub_f32 v171, v6, v174
    v_fmac_f32 v175, v171, v171
    v_sub_f32 v171, v7, v174
    v_fmac_f32 v175, v171, v171
    v_sub_f32 v171, v8, v174
    v_fmac_f32 v175, v171, v171
    v_sub_f32 v171, v9, v174
    v_fmac_f32 v175, v171, v171
    v_sub_f32 v171, v10, v174
    v_fmac_f32 v175, v171, v171
    v_sub_f32 v171, v11, v174
    v_fmac_f32 v175, v171, v171
    v_sub_f32 v171, v12, v174
    v_fmac_f32 v175, v171, v171
    v_sub_f32 v171, v13, v174
    v_fmac_f32 v175, v171, v171
    v_sub_f32 v171, v14, v174
    v_fmac_f32 v175, v171, v171
    v_sub_f32 v171, v15, v174
    v_fmac_f32 v175, v171, v171
    v_sub_f32 v171, v16, v174
    v_fmac_f32 v175, v171, v171
    v_sub_f32 v171, v17, v174
    v_fmac_f32 v175, v171, v171
    v_sub_f32 v171, v18, v174
    v_fmac_f32 v175, v171, v171
    v_sub_f32 v171, v19, v174
    v_fmac_f32 v175, v171, v171
    v_sub_f32 v171, v20, v174
    v_fmac_f32 v175, v171, v171
    v_sub_f32 v171, v21, v174
    v_fmac_f32 v175, v171, v171
    v_sub_f32 v171, v22, v174
    v_fmac_f32 v175, v171, v171
    v_sub_f32 v171, v23, v174
    v_fmac_f32 v175, v171, v171
    v_sub_f32 v171, v24, v174
    v_fmac_f32 v175, v171, v171
    v_sub_f32 v171, v25, v174
    v_fmac_f32 v175, v171, v171
    v_sub_f32 v171, v26, v174
    v_fmac_f32 v175, v171, v171
    v_sub_f32 v171, v27, v174
    v_fmac_f32 v175, v171, v171
    v_xor_b32 v176, 16, v0
    v_lshlrev_b32 v176, 2, v176
    ds_bpermute_b32 v177, v176, v175
    s_waitcnt lgkmcnt(0)
    v_add_f32 v175, v175, v177
    v_xor_b32 v176, 32, v0
    v_lshlrev_b32 v176, 2, v176
    ds_bpermute_b32 v177, v176, v175
    s_waitcnt lgkmcnt(0)
    v_add_f32 v175, v175, v177
    s_lshl_b32 s36, s36, 4
    v_add_u32 v170, s36, v0
    v_mul_u32_u24 v170, 48, v170
    s_lshl_b32 s37, s34, 3
    s_mov_b64 exec, 0xffff
    buffer_store_dwordx2 v[174:175], v170, s[28:31], s37 offen
L_k2_kernel_done:
    s_endpgm

.globl k3_kernel
.p2align 8
.type k3_kernel,@function
k3_kernel:
    s_cmp_ge_u32 s2, 256
    s_cbranch_scc1 L_k3_kernel_done
    s_load_dwordx4 s[4:7], s[0:1], 32
    s_load_dwordx2 s[8:9], s[0:1], 72
    v_lshrrev_b32 v1, 6, v0
    v_and_b32 v0, 63, v0
    s_nop 0
    v_readfirstlane_b32 s36, v1
    s_and_b32 s46, s2, 7
    s_lshr_b32 s47, s2, 3
    s_and_b32 s37, s47, 3
    s_lshl_b32 s46, s46, 2
    s_add_u32 s37, s37, s46
    s_lshr_b32 s38, s47, 2
    s_lshl_b32 s46, s36, 6
    s_sub_u32 s47, s46, 64
    s_cmp_eq_u32 s36, 0
    s_cselect_b32 s47, 512, s47
    s_cselect_b32 s49, 0, 128
    s_add_u32 s48, s46, 448
    s_lshl_b32 s42, s36, 10
    s_add_u32 s43, s42, 8192
    s_add_u32 s43, s43, s49
    s_add_u32 s44, s42, 16512
    v_add_u32 v229, s46, v0
    v_mul_u32_u24 v230, 3641, v229
    v_lshrrev_b32 v236, 16, v230
    v_mul_u32_u24 v231, 18, v236
    v_sub_u32 v231, v229, v231
    v_mul_u32_u24 v230, 9216, v236
    v_lshl_add_u32 v222, v231, 4, v230
    v_add_u32 v229, s47, v0
    v_mul_u32_u24 v230, 3641, v229
    v_lshrrev_b32 v237, 16, v230
    v_mul_u32_u24 v231, 18, v237
    v_sub_u32 v231, v229, v231
    v_mul_u32_u24 v230, 9216, v237
    v_lshl_add_u32 v223, v231, 4, v230
    v_add_u32 v229, s48, v0
    v_mul_u32_u24 v230, 3641, v229
    v_lshrrev_b32 v238, 16, v230
    v_mul_u32_u24 v231, 18, v238
    v_sub_u32 v231, v229, v231
    v_mul_u32_u24 v230, 9216, v238
    v_lshl_add_u32 v224, v231, 4, v230
    s_mul_i32 s46, s37, 288
    v_add_u32 v222, s46, v222
    v_add_u32 v223, s46, v223
    v_add_u32 v224, s46, v224
    s_lshl_b32 s46, s38, 4
    s_lshl_b32 s47, s36, 1
    s_add_u32 s46, s46, s47
    s_mul_i32 s47, s46, 18432
    v_bfe_u32 v228, v0, 4, 1
    v_mul_u32_u24 v228, 18432, v228
    v_lshrrev_b32 v229, 5, v0
    v_lshl_add_u32 v228, v229, 8, v228
    v_and_b32 v229, 15, v0
    v_lshl_add_u32 v228, v229, 4, v228
    v_add_u32 v225, s47, v228
    s_mul_i32 s58, s46, 144
    s_lshr_b32 s47, s37, 1
    s_mul_i32 s47, s47, 9
    s_add_u32 s58, s58, s47
    s_lshl_b32 s58, s58, 10
    s_lshl_b32 s46, s46, 4
    v_and_b32 v232, 31, v0
    v_add_u32 v232, s46, v232
    v_mul_u32_u24 v232, 48, v232
    v_bfe_u32 v228, v0, 4, 1
    v_mul_u32_u24 v228, 9344, v228
    v_lshrrev_b32 v229, 5, v0
    v_bfe_u32 v230, v0, 2, 2
    v_lshl_add_u32 v229, v229, 2, v230
    v_mul_u32_u24 v229, 288, v229
    v_add_u32 v228, v228, v229
    v_and_b32 v230, 3, v0
    v_lshl_add_u32 v220, v230, 3, v228
    v_add_u32 v221, 55680, v220
    s_mov_b32 s56, 0
    s_mov_b32 s57, 0
    s_mul_i32 s39, s56, 294912
    s_lshl_b32 s40, s56, 10
    s_waitcnt lgkmcnt(0)
    s_mov_b32 s12, s4
    s_mov_b32 s13, s5
    s_and_b32 s13, s13, 0xffff
    s_mov_b32 s14, 5308416
    s_mov_b32 s15, 0x00020000
    s_mov_b32 s20, s6
    s_mov_b32 s21, s7
    s_and_b32 s21, s21, 0xffff
    s_mov_b32 s22, 5308416
    s_mov_b32 s23, 0x00020000
    s_cmp_eq_u32 s36, 0
    s_cselect_b32 s46, s4, s6
    s_cselect_b32 s47, s5, s7
    s_mov_b32 s16, s46
    s_mov_b32 s17, s47
    s_and_b32 s17, s17, 0xffff
    s_mov_b32 s18, 5308416
    s_mov_b32 s19, 0x00020000
    s_add_u32 s24, s8, 2359296
    s_addc_u32 s25, s9, 0
    s_and_b32 s25, s25, 0xffff
    s_mov_b32 s26, 2359296
    s_mov_b32 s27, 0x00020000
    s_add_u32 s28, s8, 4718592
    s_addc_u32 s29, s9, 0
    s_and_b32 s29, s29, 0xffff
    s_mov_b32 s30, 98304
    s_mov_b32 s31, 0x00020000
    s_add_u32 s32, s8, 4816896
    s_addc_u32 s33, s9, 0
    s_and_b32 s33, s33, 0xffff
    s_mov_b32 s34, 18874368
    s_mov_b32 s35, 0x00020000
    buffer_load_dwordx4 v[196:199], v232, s[28:31], 0 offen offset:0
    buffer_load_dwordx4 v[200:203], v232, s[28:31], 0 offen offset:16
    buffer_load_dwordx4 v[204:207], v232, s[28:31], 0 offen offset:32
    s_mov_b32 s88, 3222493025
    s_mov_b32 s89, 3184710632
    v_mov_b32 v244, s88
    v_bfe_u32 v245, v0, 4, 1
    v_mul_u32_u24 v245, 147456, v245
    v_lshrrev_b32 v236, 5, v0
    v_lshl_add_u32 v245, v236, 8, v245
    v_and_b32 v236, 15, v0
    v_lshl_add_u32 v245, v236, 4, v245
    s_and_b32 s91, s37, 1
    s_lshl_b32 s90, s91, 12
    s_add_u32 s90, s90, s58
    s_lshl_b32 s91, s91, 9
    s_add_u32 s91, s91, s58
    s_add_u32 s91, s91, 8192
    s_cmp_ge_u32 s36, 2
    s_cbranch_scc1 L_k3_kernel_sk0
    s_add_u32 m0, s44, 0
    s_nop 0
    buffer_load_dwordx4 v224, s[20:23], s39 offen lds
L_k3_kernel_sk0:
    s_add_u32 m0, s42, 0
    s_nop 0
    buffer_load_dwordx4 v222, s[12:15], s39 offen lds
    s_add_u32 m0, s43, 0
    s_nop 0
    buffer_load_dwordx4 v223, s[16:19], s39 offen lds
    buffer_load_dwordx4 v[148:151], v225, s[24:27], s40 offen
    buffer_load_dwordx4 v[152:155], v225, s[24:27], s40 offen offset:512
    s_add_u32 s56, s56, 1
    s_cmp_eq_u32 s56, 18
    s_cselect_b32 s56, 0, s56
    s_mul_i32 s39, s56, 294912
    s_lshl_b32 s40, s56, 10
    s_cmp_ge_u32 s36, 2
    s_cbranch_scc1 L_k3_kernel_sk1
    s_add_u32 m0, s44, 18560
    s_nop 0
    buffer_load_dwordx4 v224, s[20:23], s39 offen lds
L_k3_kernel_sk1:
    s_add_u32 m0, s42, 18560
    s_nop 0
    buffer_load_dwordx4 v222, s[12:15], s39 offen lds
    s_add_u32 m0, s43, 18560
    s_nop 0
    buffer_load_dwordx4 v223, s[16:19], s39 offen lds
    buffer_load_dwordx4 v[156:159], v225, s[24:27], s40 offen
    buffer_load_dwordx4 v[160:163], v225, s[24:27], s40 offen offset:512
    s_add_u32 s56, s56, 1
    s_cmp_eq_u32 s56, 18
    s_cselect_b32 s56, 0, s56
    s_mul_i32 s39, s56, 294912
    s_lshl_b32 s40, s56, 10
    s_waitcnt vmcnt(8)
    v_add_f32 v228, v196, v198
    v_add_f32 v229, v200, v202
    v_add_f32 v230, v204, v206
    v_add_f32 v228, v228, v229
    v_add_f32 v228, v228, v230
    v_mul_f32 v228, 1042983595, v228
    v_add_f32 v229, v197, v199
    v_add_f32 v230, v201, v203
    v_add_f32 v231, v205, v207
    v_add_f32 v229, v229, v230
    v_add_f32 v229, v229, v231
    v_mov_b32 v230, 0
    v_sub_f32 v231, v196, v228
    v_fmac_f32 v230, v231, v231
    v_sub_f32 v231, v198, v228
    v_fmac_f32 v230, v231, v231
    v_sub_f32 v231, v200, v228
    v_fmac_f32 v230, v231, v231
    v_sub_f32 v231, v202, v228
    v_fmac_f32 v230, v231, v231
    v_sub_f32 v231, v204, v228
    v_fmac_f32 v230, v231, v231
    v_sub_f32 v231, v206, v228
    v_fmac_f32 v230, v231, v231
    v_fmac_f32 v229, 1119879168, v230
    v_mul_f32 v229, 987991609, v229
    v_cvt_pk_bf16_f32 v226, v228, v228
    v_lshlrev_b32 v226, 16, v226
    v_cvt_pk_bf16_f32 v229, v229, v229
    v_lshlrev_b32 v229, 16, v229
    v_add_f32 v229, 925353388, v229
    v_cvt_pk_bf16_f32 v229, v229, v229
    v_lshlrev_b32 v229, 16, v229
    v_sqrt_f32 v229, v229
    s_nop 0
    v_cvt_pk_bf16_f32 v229, v229, v229
    v_lshlrev_b32 v229, 16, v229
    v_rcp_f32 v227, v229
    s_nop 0
    v_mul_f32 v226, v226, v227
    v_sub_f32 v226, 0, v226
    s_waitcnt vmcnt(4)
    v_lshlrev_b32 v236, 16, v148
    v_and_b32 v237, 0xffff0000, v148
    v_lshlrev_b32 v238, 16, v149
    v_and_b32 v239, 0xffff0000, v149
    v_lshlrev_b32 v240, 16, v150
    v_and_b32 v241, 0xffff0000, v150
    v_lshlrev_b32 v242, 16, v151
    v_and_b32 v243, 0xffff0000, v151
    v_fma_f32 v236, v236, v227, v226
    v_fma_f32 v237, v237, v227, v226
    v_fma_f32 v238, v238, v227, v226
    v_fma_f32 v239, v239, v227, v226
    v_fma_f32 v240, v240, v227, v226
    v_fma_f32 v241, v241, v227, v226
    v_fma_f32 v242, v242, v227, v226
    v_fma_f32 v243, v243, v227, v226
    v_cvt_pk_bf16_f32 v148, v236, v237
    v_cvt_pk_bf16_f32 v149, v238, v239
    v_cvt_pk_bf16_f32 v150, v240, v241
    v_cvt_pk_bf16_f32 v151, v242, v243
    v_lshlrev_b32 v236, 16, v152
    v_and_b32 v237, 0xffff0000, v152
    v_lshlrev_b32 v238, 16, v153
    v_and_b32 v239, 0xffff0000, v153
    v_lshlrev_b32 v240, 16, v154
    v_and_b32 v241, 0xffff0000, v154
    v_lshlrev_b32 v242, 16, v155
    v_and_b32 v243, 0xffff0000, v155
    v_fma_f32 v236, v236, v227, v226
    v_fma_f32 v237, v237, v227, v226
    v_fma_f32 v238, v238, v227, v226
    v_fma_f32 v239, v239, v227, v226
    v_fma_f32 v240, v240, v227, v226
    v_fma_f32 v241, v241, v227, v226
    v_fma_f32 v242, v242, v227, v226
    v_fma_f32 v243, v243, v227, v226
    v_cvt_pk_bf16_f32 v152, v236, v237
    v_cvt_pk_bf16_f32 v153, v238, v239
    v_cvt_pk_bf16_f32 v154, v240, v241
    v_cvt_pk_bf16_f32 v155, v242, v243
    s_barrier
    ds_read_b64_tr_b16 v[196:197], v220 offset:0
    ds_read_b64_tr_b16 v[198:199], v220 offset:4608
    ds_read_b64_tr_b16 v[200:201], v220 offset:32
    ds_read_b64_tr_b16 v[202:203], v220 offset:4640
    ds_read_b64_tr_b16 v[204:205], v220 offset:64
    ds_read_b64_tr_b16 v[206:207], v220 offset:4672
    ds_read_b64_tr_b16 v[208:209], v220 offset:96
    ds_read_b64_tr_b16 v[210:211], v220 offset:4704
    ds_read_b64_tr_b16 v[212:213], v220 offset:128
    ds_read_b64_tr_b16 v[214:215], v220 offset:4736
    ds_read_b64_tr_b16 v[216:217], v220 offset:160
    ds_read_b64_tr_b16 v[218:219], v220 offset:4768
    s_waitcnt lgkmcnt(10)
    v_mfma_f32_32x32x16_bf16 v[4:19], v[196:199], v[148:151], 0
    ds_read_b64_tr_b16 v[196:197], v220 offset:192
    ds_read_b64_tr_b16 v[198:199], v220 offset:4800
    s_waitcnt lgkmcnt(10)
    v_mfma_f32_32x32x16_bf16 v[20:35], v[200:203], v[148:151], 0
    s_cmp_ge_u32 s36, 2
    s_cbranch_scc1 L_k3_kernel_sk2
    s_add_u32 m0, s44, 37120
    s_nop 0
    buffer_load_dwordx4 v224, s[20:23], s39 offen lds
L_k3_kernel_sk2:
    s_add_u32 m0, s42, 37120
    s_nop 0
    buffer_load_dwordx4 v222, s[12:15], s39 offen lds
    ds_read_b64_tr_b16 v[200:201], v220 offset:224
    ds_read_b64_tr_b16 v[202:203], v220 offset:4832
    s_waitcnt lgkmcnt(10)
    v_mfma_f32_32x32x16_bf16 v[36:51], v[204:207], v[148:151], 0
    ds_read_b64_tr_b16 v[204:205], v220 offset:256
    ds_read_b64_tr_b16 v[206:207], v220 offset:4864
    s_waitcnt lgkmcnt(10)
    v_mfma_f32_32x32x16_bf16 v[52:67], v[208:211], v[148:151], 0
    s_add_u32 m0, s43, 37120
    s_nop 0
    buffer_load_dwordx4 v223, s[16:19], s39 offen lds
    ds_read_b64_tr_b16 v[208:209], v220 offset:2304
    ds_read_b64_tr_b16 v[210:211], v220 offset:6912
    s_waitcnt lgkmcnt(10)
    v_mfma_f32_32x32x16_bf16 v[68:83], v[212:215], v[148:151], 0
    ds_read_b64_tr_b16 v[212:213], v220 offset:2336
    ds_read_b64_tr_b16 v[214:215], v220 offset:6944
    s_waitcnt lgkmcnt(10)
    v_mfma_f32_32x32x16_bf16 v[84:99], v[216:219], v[148:151], 0
    buffer_load_dwordx4 v[164:167], v225, s[24:27], s40 offen
    ds_read_b64_tr_b16 v[216:217], v220 offset:2368
    ds_read_b64_tr_b16 v[218:219], v220 offset:6976
    s_waitcnt lgkmcnt(10)
    v_mfma_f32_32x32x16_bf16 v[100:115], v[196:199], v[148:151], 0
    s_waitcnt vmcnt(3)
    v_lshlrev_b32 v236, 16, v156
    v_and_b32 v237, 0xffff0000, v156
    v_lshlrev_b32 v238, 16, v157
    ds_read_b64_tr_b16 v[196:197], v220 offset:2400
    ds_read_b64_tr_b16 v[198:199], v220 offset:7008
    s_waitcnt lgkmcnt(10)
    v_mfma_f32_32x32x16_bf16 v[116:131], v[200:203], v[148:151], 0
    buffer_load_dwordx4 v[168:171], v225, s[24:27], s40 offen offset:512
    s_add_u32 s56, s56, 1
    s_cmp_eq_u32 s56, 18
    s_cselect_b32 s56, 0, s56
    s_mul_i32 s39, s56, 294912
    s_lshl_b32 s40, s56, 10
    v_and_b32 v239, 0xffff0000, v157
    v_lshlrev_b32 v240, 16, v158
    v_and_b32 v241, 0xffff0000, v158
    v_lshlrev_b32 v242, 16, v159
    ds_read_b64_tr_b16 v[200:201], v220 offset:2432
    ds_read_b64_tr_b16 v[202:203], v220 offset:7040
    s_waitcnt lgkmcnt(10)
    v_mfma_f32_32x32x16_bf16 v[132:147], v[204:207], v[148:151], 0
    v_and_b32 v243, 0xffff0000, v159
    v_fma_f32 v236, v236, v227, v226
    v_fma_f32 v237, v237, v227, v226
    v_fma_f32 v238, v238, v227, v226
    ds_read_b64_tr_b16 v[204:205], v220 offset:2464
    ds_read_b64_tr_b16 v[206:207], v220 offset:7072
    s_waitcnt lgkmcnt(10)
    v_mfma_f32_32x32x16_bf16 v[4:19], v[208:211], v[152:155], v[4:19]
    s_cmp_ge_u32 s36, 2
    s_cbranch_scc1 L_k3_kernel_sk3
    s_add_u32 m0, s44, 55680
    s_nop 0
    buffer_load_dwordx4 v224, s[20:23], s39 offen lds
L_k3_kernel_sk3:
    s_add_u32 m0, s42, 55680
    s_nop 0
    buffer_load_dwordx4 v222, s[12:15], s39 offen lds
    v_fma_f32 v239, v239, v227, v226
    v_fma_f32 v240, v240, v227, v226
    v_fma_f32 v241, v241, v227, v226
    v_fma_f32 v242, v242, v227, v226
    ds_read_b64_tr_b16 v[208:209], v220 offset:2496
    ds_read_b64_tr_b16 v[210:211], v220 offset:7104
    s_waitcnt lgkmcnt(10)
    v_mfma_f32_32x32x16_bf16 v[20:35], v[212:215], v[152:155], v[20:35]
    v_fma_f32 v243, v243, v227, v226
    v_cvt_pk_bf16_f32 v156, v236, v237
    v_cvt_pk_bf16_f32 v157, v238, v239
    v_cvt_pk_bf16_f32 v158, v240, v241
    ds_read_b64_tr_b16 v[212:213], v220 offset:2528
    ds_read_b64_tr_b16 v[214:215], v220 offset:7136
    s_waitcnt lgkmcnt(10)
    v_mfma_f32_32x32x16_bf16 v[36:51], v[216:219], v[152:155], v[36:51]
    s_add_u32 m0, s43, 55680
    s_nop 0
    buffer_load_dwordx4 v223, s[16:19], s39 offen lds
    v_cvt_pk_bf16_f32 v159, v242, v243
    v_lshlrev_b32 v236, 16, v160
    v_and_b32 v237, 0xffff0000, v160
    v_lshlrev_b32 v238, 16, v161
    ds_read_b64_tr_b16 v[216:217], v220 offset:2560
    ds_read_b64_tr_b16 v[218:219], v220 offset:7168
    s_waitcnt lgkmcnt(10)
    v_mfma_f32_32x32x16_bf16 v[52:67], v[196:199], v[152:155], v[52:67]
    v_and_b32 v239, 0xffff0000, v161
    v_lshlrev_b32 v240, 16, v162
    v_and_b32 v241, 0xffff0000, v162
    v_lshlrev_b32 v242, 16, v163
    s_barrier
    ds_read_b64_tr_b16 v[196:197], v220 offset:18560
    ds_read_b64_tr_b16 v[198:199], v220 offset:23168
    s_waitcnt lgkmcnt(10)
    v_mfma_f32_32x32x16_bf16 v[68:83], v[200:203], v[152:155], v[68:83]
    buffer_load_dwordx4 v[172:175], v225, s[24:27], s40 offen
    v_and_b32 v243, 0xffff0000, v163
    v_fma_f32 v236, v236, v227, v226
    v_fma_f32 v237, v237, v227, v226
    v_fma_f32 v238, v238, v227, v226
    ds_read_b64_tr_b16 v[200:201], v220 offset:18592
    ds_read_b64_tr_b16 v[202:203], v220 offset:23200
    s_waitcnt lgkmcnt(10)
    v_mfma_f32_32x32x16_bf16 v[84:99], v[204:207], v[152:155], v[84:99]
    v_fma_f32 v239, v239, v227, v226
    v_fma_f32 v240, v240, v227, v226
    v_fma_f32 v241, v241, v227, v226
    v_fma_f32 v242, v242, v227, v226
    ds_read_b64_tr_b16 v[204:205], v220 offset:18624
    ds_read_b64_tr_b16 v[206:207], v220 offset:23232
    s_waitcnt lgkmcnt(10)
    v_mfma_f32_32x32x16_bf16 v[100:115], v[208:211], v[152:155], v[100:115]
    buffer_load_dwordx4 v[176:179], v225, s[24:27], s40 offen offset:512
    s_add_u32 s56, s56, 1
    s_cmp_eq_u32 s56, 18
    s_cselect_b32 s56, 0, s56
    s_mul_i32 s39, s56, 294912
    s_lshl_b32 s40, s56, 10
    v_fma_f32 v243, v243, v227, v226
    v_cvt_pk_bf16_f32 v160, v236, v237
    v_cvt_pk_bf16_f32 v161, v238, v239
    v_cvt_pk_bf16_f32 v162, v240, v241
    ds_read_b64_tr_b16 v[208:209], v220 offset:18656
    ds_read_b64_tr_b16 v[210:211], v220 offset:23264
    s_waitcnt lgkmcnt(10)
    v_mfma_f32_32x32x16_bf16 v[116:131], v[212:215], v[152:155], v[116:131]
    v_cvt_pk_bf16_f32 v163, v242, v243
    ds_read_b64_tr_b16 v[212:213], v220 offset:18688
    ds_read_b64_tr_b16 v[214:215], v220 offset:23296
    s_waitcnt lgkmcnt(10)
    v_mfma_f32_32x32x16_bf16 v[132:147], v[216:219], v[152:155], v[132:147]
    s_waitcnt vmcnt(6)
    s_barrier
    ds_read_b64_tr_b16 v[216:217], v220 offset:18720
    ds_read_b64_tr_b16 v[218:219], v220 offset:23328
    s_waitcnt lgkmcnt(10)
    v_mfma_f32_32x32x16_bf16 v[4:19], v[196:199], v[156:159], v[4:19]
    ds_read_b64_tr_b16 v[196:197], v220 offset:18752
    ds_read_b64_tr_b16 v[198:199], v220 offset:23360
    s_waitcnt lgkmcnt(10)
    v_mfma_f32_32x32x16_bf16 v[20:35], v[200:203], v[156:159], v[20:35]
    s_cmp_ge_u32 s36, 2
    s_cbranch_scc1 L_k3_kernel_sk4
    s_add_u32 m0, s44, 74240
    s_nop 0
    buffer_load_dwordx4 v224, s[20:23], s39 offen lds
L_k3_kernel_sk4:
    s_add_u32 m0, s42, 74240
    s_nop 0
    buffer_load_dwordx4 v222, s[12:15], s39 offen lds
    ds_read_b64_tr_b16 v[200:201], v220 offset:18784
    ds_read_b64_tr_b16 v[202:203], v220 offset:23392
    s_waitcnt lgkmcnt(10)
    v_mfma_f32_32x32x16_bf16 v[36:51], v[204:207], v[156:159], v[36:51]
    ds_read_b64_tr_b16 v[204:205], v220 offset:18816
    ds_read_b64_tr_b16 v[206:207], v220 offset:23424
    s_waitcnt lgkmcnt(10)
    v_mfma_f32_32x32x16_bf16 v[52:67], v[208:211], v[156:159], v[52:67]
    s_add_u32 m0, s43, 74240
    s_nop 0
    buffer_load_dwordx4 v223, s[16:19], s39 offen lds
    ds_read_b64_tr_b16 v[208:209], v220 offset:20864
    ds_read_b64_tr_b16 v[210:211], v220 offset:25472
    s_waitcnt lgkmcnt(10)
    v_mfma_f32_32x32x16_bf16 v[68:83], v[212:215], v[156:159], v[68:83]
    ds_read_b64_tr_b16 v[212:213], v220 offset:20896
    ds_read_b64_tr_b16 v[214:215], v220 offset:25504
    s_waitcnt lgkmcnt(10)
    v_mfma_f32_32x32x16_bf16 v[84:99], v[216:219], v[156:159], v[84:99]
    buffer_load_dwordx4 v[180:183], v225, s[24:27], s40 offen
    ds_read_b64_tr_b16 v[216:217], v220 offset:20928
    ds_read_b64_tr_b16 v[218:219], v220 offset:25536
    s_waitcnt lgkmcnt(10)
    v_mfma_f32_32x32x16_bf16 v[100:115], v[196:199], v[156:159], v[100:115]
    s_waitcnt vmcnt(7)
    v_lshlrev_b32 v236, 16, v164
    v_and_b32 v237, 0xffff0000, v164
    v_lshlrev_b32 v238, 16, v165
    ds_read_b64_tr_b16 v[196:197], v220 offset:20960
    ds_read_b64_tr_b16 v[198:199], v220 offset:25568
    s_waitcnt lgkmcnt(10)
    v_mfma_f32_32x32x16_bf16 v[116:131], v[200:203], v[156:159], v[116:131]
    buffer_load_dwordx4 v[184:187], v225, s[24:27], s40 offen offset:512
    s_add_u32 s56, s56, 1
    s_cmp_eq_u32 s56, 18
    s_cselect_b32 s56, 0, s56
    s_mul_i32 s39, s56, 294912
    s_lshl_b32 s40, s56, 10
    v_and_b32 v239, 0xffff0000, v165
    v_lshlrev_b32 v240, 16, v166
    v_and_b32 v241, 0xffff0000, v166
    v_lshlrev_b32 v242, 16, v167
    ds_read_b64_tr_b16 v[200:201], v220 offset:20992
    ds_read_b64_tr_b16 v[202:203], v220 offset:25600
    s_waitcnt lgkmcnt(10)
    v_mfma_f32_32x32x16_bf16 v[132:147], v[204:207], v[156:159], v[132:147]
    v_and_b32 v243, 0xffff0000, v167
    v_fma_f32 v236, v236, v227, v226
    v_fma_f32 v237, v237, v227, v226
    v_fma_f32 v238, v238, v227, v226
    ds_read_b64_tr_b16 v[204:205], v220 offset:21024
    ds_read_b64_tr_b16 v[206:207], v220 offset:25632
    s_waitcnt lgkmcnt(10)
    v_mfma_f32_32x32x16_bf16 v[4:19], v[208:211], v[160:163], v[4:19]
    s_cmp_ge_u32 s36, 2
    s_cbranch_scc1 L_k3_kernel_sk5
    s_add_u32 m0, s44, 92800
    s_nop 0
    buffer_load_dwordx4 v224, s[20:23], s39 offen lds
L_k3_kernel_sk5:
    s_add_u32 m0, s42, 92800
    s_nop 0
    buffer_load_dwordx4 v222, s[12:15], s39 offen lds
    v_fma_f32 v239, v239, v227, v226
    v_fma_f32 v240, v240, v227, v226
    v_fma_f32 v241, v241, v227, v226
    v_fma_f32 v242, v242, v227, v226
    ds_read_b64_tr_b16 v[208:209], v220 offset:21056
    ds_read_b64_tr_b16 v[210:211], v220 offset:25664
    s_waitcnt lgkmcnt(10)
    v_mfma_f32_32x32x16_bf16 v[20:35], v[212:215], v[160:163], v[20:35]
    v_fma_f32 v243, v243, v227, v226
    v_cvt_pk_bf16_f32 v164, v236, v237
    v_cvt_pk_bf16_f32 v165, v238, v239
    v_cvt_pk_bf16_f32 v166, v240, v241
    ds_read_b64_tr_b16 v[212:213], v220 offset:21088
    ds_read_b64_tr_b16 v[214:215], v220 offset:25696
    s_waitcnt lgkmcnt(10)
    v_mfma_f32_32x32x16_bf16 v[36:51], v[216:219], v[160:163], v[36:51]
    s_add_u32 m0, s43, 92800
    s_nop 0
    buffer_load_dwordx4 v223, s[16:19], s39 offen lds
    v_cvt_pk_bf16_f32 v167, v242, v243
    v_lshlrev_b32 v236, 16, v168
    v_and_b32 v237, 0xffff0000, v168
    v_lshlrev_b32 v238, 16, v169
    ds_read_b64_tr_b16 v[216:217], v220 offset:21120
    ds_read_b64_tr_b16 v[218:219], v220 offset:25728
    s_waitcnt lgkmcnt(10)
    v_mfma_f32_32x32x16_bf16 v[52:67], v[196:199], v[160:163], v[52:67]
    v_and_b32 v239, 0xffff0000, v169
    v_lshlrev_b32 v240, 16, v170
    v_and_b32 v241, 0xffff0000, v170
    v_lshlrev_b32 v242, 16, v171
    ds_read_b64_tr_b16 v[196:197], v220 offset:37120
    ds_read_b64_tr_b16 v[198:199], v220 offset:41728
    s_waitcnt lgkmcnt(10)
    v_mfma_f32_32x32x16_bf16 v[68:83], v[200:203], v[160:163], v[68:83]
    buffer_load_dwordx4 v[188:191], v225, s[24:27], s40 offen
    v_and_b32 v243, 0xffff0000, v171
    v_fma_f32 v236, v236, v227, v226
    v_fma_f32 v237, v237, v227, v226
    v_fma_f32 v238, v238, v227, v226
    ds_read_b64_tr_b16 v[200:201], v220 offset:37152
    ds_read_b64_tr_b16 v[202:203], v220 offset:41760
    s_waitcnt lgkmcnt(10)
    v_mfma_f32_32x32x16_bf16 v[84:99], v[204:207], v[160:163], v[84:99]
    v_fma_f32 v239, v239, v227, v226
    v_fma_f32 v240, v240, v227, v226
    v_fma_f32 v241, v241, v227, v226
    v_fma_f32 v242, v242, v227, v226
    ds_read_b64_tr_b16 v[204:205], v220 offset:37184
    ds_read_b64_tr_b16 v[206:207], v220 offset:41792
    s_waitcnt lgkmcnt(10)
    v_mfma_f32_32x32x16_bf16 v[100:115], v[208:211], v[160:163], v[100:115]
    buffer_load_dwordx4 v[192:195], v225, s[24:27], s40 offen offset:512
    s_add_u32 s56, s56, 1
    s_cmp_eq_u32 s56, 18
    s_cselect_b32 s56, 0, s56
    s_mul_i32 s39, s56, 294912
    s_lshl_b32 s40, s56, 10
    v_fma_f32 v243, v243, v227, v226
    v_cvt_pk_bf16_f32 v168, v236, v237
    v_cvt_pk_bf16_f32 v169, v238, v239
    v_cvt_pk_bf16_f32 v170, v240, v241
    ds_read_b64_tr_b16 v[208:209], v220 offset:37216
    ds_read_b64_tr_b16 v[210:211], v220 offset:41824
    s_waitcnt lgkmcnt(10)
    v_mfma_f32_32x32x16_bf16 v[116:131], v[212:215], v[160:163], v[116:131]
    v_cvt_pk_bf16_f32 v171, v242, v243
    ds_read_b64_tr_b16 v[212:213], v220 offset:37248
    ds_read_b64_tr_b16 v[214:215], v220 offset:41856
    s_waitcnt lgkmcnt(10)
    v_mfma_f32_32x32x16_bf16 v[132:147], v[216:219], v[160:163], v[132:147]
    s_waitcnt vmcnt(10)
    s_barrier
    ds_read_b64_tr_b16 v[216:217], v220 offset:37280
    ds_read_b64_tr_b16 v[218:219], v220 offset:41888
    s_waitcnt lgkmcnt(10)
    v_mfma_f32_32x32x16_bf16 v[4:19], v[196:199], v[164:167], v[4:19]
    ds_read_b64_tr_b16 v[196:197], v220 offset:37312
    ds_read_b64_tr_b16 v[198:199], v220 offset:41920
    s_waitcnt lgkmcnt(10)
    v_mfma_f32_32x32x16_bf16 v[20:35], v[200:203], v[164:167], v[20:35]
    s_cmp_ge_u32 s36, 2
    s_cbranch_scc1 L_k3_kernel_sk6
    s_add_u32 m0, s44, 0
    s_nop 0
    buffer_load_dwordx4 v224, s[20:23], s39 offen lds
L_k3_kernel_sk6:
    s_add_u32 m0, s42, 0
    s_nop 0
    buffer_load_dwordx4 v222, s[12:15], s39 offen lds
    ds_read_b64_tr_b16 v[200:201], v220 offset:37344
    ds_read_b64_tr_b16 v[202:203], v220 offset:41952
    s_waitcnt lgkmcnt(10)
    v_mfma_f32_32x32x16_bf16 v[36:51], v[204:207], v[164:167], v[36:51]
    ds_read_b64_tr_b16 v[204:205], v220 offset:37376
    ds_read_b64_tr_b16 v[206:207], v220 offset:41984
    s_waitcnt lgkmcnt(10)
    v_mfma_f32_32x32x16_bf16 v[52:67], v[208:211], v[164:167], v[52:67]
    s_add_u32 m0, s43, 0
    s_nop 0
    buffer_load_dwordx4 v223, s[16:19], s39 offen lds
    ds_read_b64_tr_b16 v[208:209], v220 offset:39424
    ds_read_b64_tr_b16 v[210:211], v220 offset:44032
    s_waitcnt lgkmcnt(10)
    v_mfma_f32_32x32x16_bf16 v[68:83], v[212:215], v[164:167], v[68:83]
    ds_read_b64_tr_b16 v[212:213], v220 offset:39456
    ds_read_b64_tr_b16 v[214:215], v220 offset:44064
    s_waitcnt lgkmcnt(10)
    v_mfma_f32_32x32x16_bf16 v[84:99], v[216:219], v[164:167], v[84:99]
    buffer_load_dwordx4 v[148:151], v225, s[24:27], s40 offen
    ds_read_b64_tr_b16 v[216:217], v220 offset:39488
    ds_read_b64_tr_b16 v[218:219], v220 offset:44096
    s_waitcnt lgkmcnt(10)
    v_mfma_f32_32x32x16_bf16 v[100:115], v[196:199], v[164:167], v[100:115]
    s_waitcnt vmcnt(11)
    v_lshlrev_b32 v236, 16, v172
    v_and_b32 v237, 0xffff0000, v172
    v_lshlrev_b32 v238, 16, v173
    ds_read_b64_tr_b16 v[196:197], v220 offset:39520
    ds_read_b64_tr_b16 v[198:199], v220 offset:44128
    s_waitcnt lgkmcnt(10)
    v_mfma_f32_32x32x16_bf16 v[116:131], v[200:203], v[164:167], v[116:131]
    buffer_load_dwordx4 v[152:155], v225, s[24:27], s40 offen offset:512
    s_add_u32 s56, s56, 1
    s_cmp_eq_u32 s56, 18
    s_cselect_b32 s56, 0, s56
    s_mul_i32 s39, s56, 294912
    s_lshl_b32 s40, s56, 10
    v_and_b32 v239, 0xffff0000, v173
    v_lshlrev_b32 v240, 16, v174
    v_and_b32 v241, 0xffff0000, v174
    v_lshlrev_b32 v242, 16, v175
    ds_read_b64_tr_b16 v[200:201], v220 offset:39552
    ds_read_b64_tr_b16 v[202:203], v220 offset:44160
    s_waitcnt lgkmcnt(10)
    v_mfma_f32_32x32x16_bf16 v[132:147], v[204:207], v[164:167], v[132:147]
    v_and_b32 v243, 0xffff0000, v175
    v_fma_f32 v236, v236, v227, v226
    v_fma_f32 v237, v237, v227, v226
    v_fma_f32 v238, v238, v227, v226
    ds_read_b64_tr_b16 v[204:205], v220 offset:39584
    ds_read_b64_tr_b16 v[206:207], v220 offset:44192
    s_waitcnt lgkmcnt(10)
    v_mfma_f32_32x32x16_bf16 v[4:19], v[208:211], v[168:171], v[4:19]
    s_cmp_ge_u32 s36, 2
    s_cbranch_scc1 L_k3_kernel_sk7
    s_add_u32 m0, s44, 18560
    s_nop 0
    buffer_load_dwordx4 v224, s[20:23], s39 offen lds
L_k3_kernel_sk7:
    s_add_u32 m0, s42, 18560
    s_nop 0
    buffer_load_dwordx4 v222, s[12:15], s39 offen lds
    v_fma_f32 v239, v239, v227, v226
    v_fma_f32 v240, v240, v227, v226
    v_fma_f32 v241, v241, v227, v226
    v_fma_f32 v242, v242, v227, v226
    ds_read_b64_tr_b16 v[208:209], v220 offset:39616
    ds_read_b64_tr_b16 v[210:211], v220 offset:44224
    s_waitcnt lgkmcnt(10)
    v_mfma_f32_32x32x16_bf16 v[20:35], v[212:215], v[168:171], v[20:35]
    v_fma_f32 v243, v243, v227, v226
    v_cvt_pk_bf16_f32 v172, v236, v237
    v_cvt_pk_bf16_f32 v173, v238, v239
    v_cvt_pk_bf16_f32 v174, v240, v241
    ds_read_b64_tr_b16 v[212:213], v220 offset:39648
    ds_read_b64_tr_b16 v[214:215], v220 offset:44256
    s_waitcnt lgkmcnt(10)
    v_mfma_f32_32x32x16_bf16 v[36:51], v[216:219], v[168:171], v[36:51]
    s_add_u32 m0, s43, 18560
    s_nop 0
    buffer_load_dwordx4 v223, s[16:19], s39 offen lds
    v_cvt_pk_bf16_f32 v175, v242, v243
    v_lshlrev_b32 v236, 16, v176
    v_and_b32 v237, 0xffff0000, v176
    v_lshlrev_b32 v238, 16, v177
    ds_read_b64_tr_b16 v[216:217], v220 offset:39680
    ds_read_b64_tr_b16 v[218:219], v220 offset:44288
    s_waitcnt lgkmcnt(10)
    v_mfma_f32_32x32x16_bf16 v[52:67], v[196:199], v[168:171], v[52:67]
    v_and_b32 v239, 0xffff0000, v177
    v_lshlrev_b32 v240, 16, v178
    v_and_b32 v241, 0xffff0000, v178
    v_lshlrev_b32 v242, 16, v179
    ds_read_b64_tr_b16 v[196:197], v221 offset:0
    ds_read_b64_tr_b16 v[198:199], v221 offset:4608
    s_waitcnt lgkmcnt(10)
    v_mfma_f32_32x32x16_bf16 v[68:83], v[200:203], v[168:171], v[68:83]
    buffer_load_dwordx4 v[156:159], v225, s[24:27], s40 offen
    v_and_b32 v243, 0xffff0000, v179
    v_fma_f32 v236, v236, v227, v226
    v_fma_f32 v237, v237, v227, v226
    v_fma_f32 v238, v238, v227, v226
    ds_read_b64_tr_b16 v[200:201], v221 offset:32
    ds_read_b64_tr_b16 v[202:203], v221 offset:4640
    s_waitcnt lgkmcnt(10)
    v_mfma_f32_32x32x16_bf16 v[84:99], v[204:207], v[168:171], v[84:99]
    v_fma_f32 v239, v239, v227, v226
    v_fma_f32 v240, v240, v227, v226
    v_fma_f32 v241, v241, v227, v226
    v_fma_f32 v242, v242, v227, v226
    ds_read_b64_tr_b16 v[204:205], v221 offset:64
    ds_read_b64_tr_b16 v[206:207], v221 offset:4672
    s_waitcnt lgkmcnt(10)
    v_mfma_f32_32x32x16_bf16 v[100:115], v[208:211], v[168:171], v[100:115]
    buffer_load_dwordx4 v[160:163], v225, s[24:27], s40 offen offset:512
    s_add_u32 s56, s56, 1
    s_cmp_eq_u32 s56, 18
    s_cselect_b32 s56, 0, s56
    s_mul_i32 s39, s56, 294912
    s_lshl_b32 s40, s56, 10
    v_fma_f32 v243, v243, v227, v226
    v_cvt_pk_bf16_f32 v176, v236, v237
    v_cvt_pk_bf16_f32 v177, v238, v239
    v_cvt_pk_bf16_f32 v178, v240, v241
    ds_read_b64_tr_b16 v[208:209], v221 offset:96
    ds_read_b64_tr_b16 v[210:211], v221 offset:4704
    s_waitcnt lgkmcnt(10)
    v_mfma_f32_32x32x16_bf16 v[116:131], v[212:215], v[168:171], v[116:131]
    v_cvt_pk_bf16_f32 v179, v242, v243
    ds_read_b64_tr_b16 v[212:213], v221 offset:128
    ds_read_b64_tr_b16 v[214:215], v221 offset:4736
    s_waitcnt lgkmcnt(10)
    v_mfma_f32_32x32x16_bf16 v[132:147], v[216:219], v[168:171], v[132:147]
    s_waitcnt vmcnt(14)
    s_barrier
    ds_read_b64_tr_b16 v[216:217], v221 offset:160
    ds_read_b64_tr_b16 v[218:219], v221 offset:4768
    s_waitcnt lgkmcnt(10)
    v_mfma_f32_32x32x16_bf16 v[4:19], v[196:199], v[172:175], v[4:19]
    ds_read_b64_tr_b16 v[196:197], v221 offset:192
    ds_read_b64_tr_b16 v[198:199], v221 offset:4800
    s_waitcnt lgkmcnt(10)
    v_mfma_f32_32x32x16_bf16 v[20:35], v[200:203], v[172:175], v[20:35]
    s_cmp_ge_u32 s36, 2
    s_cbranch_scc1 L_k3_kernel_sk8
    s_add_u32 m0, s44, 37120
    s_nop 0
    buffer_load_dwordx4 v224, s[20:23], s39 offen lds
L_k3_kernel_sk8:
    s_add_u32 m0, s42, 37120
    s_nop 0
    buffer_load_dwordx4 v222, s[12:15], s39 offen lds
    s_waitcnt vmcnt(13)
    v_lshlrev_b32 v236, 16, v180
    v_and_b32 v237, 0xffff0000, v180
    ds_read_b64_tr_b16 v[200:201], v221 offset:224
    ds_read_b64_tr_b16 v[202:203], v221 offset:4832
    s_waitcnt lgkmcnt(10)
    v_mfma_f32_32x32x16_bf16 v[36:51], v[204:207], v[172:175], v[36:51]
    v_lshlrev_b32 v238, 16, v181
    v_and_b32 v239, 0xffff0000, v181
    v_lshlrev_b32 v240, 16, v182
    ds_read_b64_tr_b16 v[204:205], v221 offset:256
    ds_read_b64_tr_b16 v[206:207], v221 offset:4864
    s_waitcnt lgkmcnt(10)
    v_mfma_f32_32x32x16_bf16 v[52:67], v[208:211], v[172:175], v[52:67]
    v_and_b32 v241, 0xffff0000, v182
    v_lshlrev_b32 v242, 16, v183
    v_and_b32 v243, 0xffff0000, v183
    ds_read_b64_tr_b16 v[208:209], v221 offset:2304
    ds_read_b64_tr_b16 v[210:211], v221 offset:6912
    s_waitcnt lgkmcnt(10)
    v_mfma_f32_32x32x16_bf16 v[68:83], v[212:215], v[172:175], v[68:83]
    v_fma_f32 v236, v236, v227, v226
    v_fma_f32 v237, v237, v227, v226
    v_fma_f32 v238, v238, v227, v226
    ds_read_b64_tr_b16 v[212:213], v221 offset:2336
    ds_read_b64_tr_b16 v[214:215], v221 offset:6944
    s_waitcnt lgkmcnt(10)
    v_mfma_f32_32x32x16_bf16 v[84:99], v[216:219], v[172:175], v[84:99]
    s_add_u32 m0, s43, 37120
    s_nop 0
    buffer_load_dwordx4 v223, s[16:19], s39 offen lds
    v_fma_f32 v239, v239, v227, v226
    v_fma_f32 v240, v240, v227, v226
    v_fma_f32 v241, v241, v227, v226
    ds_read_b64_tr_b16 v[216:217], v221 offset:2368
    ds_read_b64_tr_b16 v[218:219], v221 offset:6976
    s_waitcnt lgkmcnt(10)
    v_mfma_f32_32x32x16_bf16 v[100:115], v[196:199], v[172:175], v[100:115]
    v_fma_f32 v242, v242, v227, v226
    v_fma_f32 v243, v243, v227, v226
    v_cvt_pk_bf16_f32 v180, v236, v237
    ds_read_b64_tr_b16 v[196:197], v221 offset:2400
    ds_read_b64_tr_b16 v[198:199], v221 offset:7008
    s_waitcnt lgkmcnt(10)
    v_mfma_f32_32x32x16_bf16 v[116:131], v[200:203], v[172:175], v[116:131]
    v_cvt_pk_bf16_f32 v181, v238, v239
    v_cvt_pk_bf16_f32 v182, v240, v241
    v_cvt_pk_bf16_f32 v183, v242, v243
    ds_read_b64_tr_b16 v[200:201], v221 offset:2432
    ds_read_b64_tr_b16 v[202:203], v221 offset:7040
    s_waitcnt lgkmcnt(10)
    v_mfma_f32_32x32x16_bf16 v[132:147], v[204:207], v[172:175], v[132:147]
    v_lshlrev_b32 v236, 16, v184
    v_and_b32 v237, 0xffff0000, v184
    v_lshlrev_b32 v238, 16, v185
    ds_read_b64_tr_b16 v[204:205], v221 offset:2464
    ds_read_b64_tr_b16 v[206:207], v221 offset:7072
    s_waitcnt lgkmcnt(10)
    v_mfma_f32_32x32x16_bf16 v[4:19], v[208:211], v[176:179], v[4:19]
    buffer_load_dwordx4 v[164:167], v225, s[24:27], s40 offen
    v_and_b32 v239, 0xffff0000, v185
    v_lshlrev_b32 v240, 16, v186
    v_and_b32 v241, 0xffff0000, v186
    ds_read_b64_tr_b16 v[208:209], v221 offset:2496
    ds_read_b64_tr_b16 v[210:211], v221 offset:7104
    s_waitcnt lgkmcnt(10)
    v_mfma_f32_32x32x16_bf16 v[20:35], v[212:215], v[176:179], v[20:35]
    v_lshlrev_b32 v242, 16, v187
    v_and_b32 v243, 0xffff0000, v187
    v_fma_f32 v236, v236, v227, v226
    ds_read_b64_tr_b16 v[212:213], v221 offset:2528
    ds_read_b64_tr_b16 v[214:215], v221 offset:7136
    s_waitcnt lgkmcnt(10)
    v_mfma_f32_32x32x16_bf16 v[36:51], v[216:219], v[176:179], v[36:51]
    v_fma_f32 v237, v237, v227, v226
    v_fma_f32 v238, v238, v227, v226
    v_fma_f32 v239, v239, v227, v226
    ds_read_b64_tr_b16 v[216:217], v221 offset:2560
    ds_read_b64_tr_b16 v[218:219], v221 offset:7168
    s_waitcnt lgkmcnt(10)
    v_mfma_f32_32x32x16_bf16 v[52:67], v[196:199], v[176:179], v[52:67]
    v_fma_f32 v240, v240, v227, v226
    v_fma_f32 v241, v241, v227, v226
    v_fma_f32 v242, v242, v227, v226
    ds_read_b64_tr_b16 v[196:197], v221 offset:18560
    ds_read_b64_tr_b16 v[198:199], v221 offset:23168
    s_waitcnt lgkmcnt(10)
    v_mfma_f32_32x32x16_bf16 v[68:83], v[200:203], v[176:179], v[68:83]
    buffer_load_dwordx4 v[168:171], v225, s[24:27], s40 offen offset:512
    s_add_u32 s56, s56, 1
    s_cmp_eq_u32 s56, 18
    s_cselect_b32 s56, 0, s56
    s_mul_i32 s39, s56, 294912
    s_lshl_b32 s40, s56, 10
    v_fma_f32 v243, v243, v227, v226
    v_cvt_pk_bf16_f32 v184, v236, v237
    v_cvt_pk_bf16_f32 v185, v238, v239
    ds_read_b64_tr_b16 v[200:201], v221 offset:18592
    ds_read_b64_tr_b16 v[202:203], v221 offset:23200
    s_waitcnt lgkmcnt(10)
    v_mfma_f32_32x32x16_bf16 v[84:99], v[204:207], v[176:179], v[84:99]
    v_cvt_pk_bf16_f32 v186, v240, v241
    v_cvt_pk_bf16_f32 v187, v242, v243
    ds_read_b64_tr_b16 v[204:205], v221 offset:18624
    ds_read_b64_tr_b16 v[206:207], v221 offset:23232
    s_waitcnt lgkmcnt(10)
    v_mfma_f32_32x32x16_bf16 v[100:115], v[208:211], v[176:179], v[100:115]
    ds_read_b64_tr_b16 v[208:209], v221 offset:18656
    ds_read_b64_tr_b16 v[210:211], v221 offset:23264
    s_waitcnt lgkmcnt(10)
    v_mfma_f32_32x32x16_bf16 v[116:131], v[212:215], v[176:179], v[116:131]
    ds_read_b64_tr_b16 v[212:213], v221 offset:18688
    ds_read_b64_tr_b16 v[214:215], v221 offset:23296
    s_waitcnt lgkmcnt(10)
    v_mfma_f32_32x32x16_bf16 v[132:147], v[216:219], v[176:179], v[132:147]
    s_waitcnt vmcnt(14)
    s_barrier
    ds_read_b64_tr_b16 v[216:217], v221 offset:18720
    ds_read_b64_tr_b16 v[218:219], v221 offset:23328
    s_waitcnt lgkmcnt(10)
    v_mfma_f32_32x32x16_bf16 v[4:19], v[196:199], v[180:183], v[4:19]
    ds_read_b64_tr_b16 v[196:197], v221 offset:18752
    ds_read_b64_tr_b16 v[198:199], v221 offset:23360
    s_waitcnt lgkmcnt(10)
    v_mfma_f32_32x32x16_bf16 v[20:35], v[200:203], v[180:183], v[20:35]
    s_cmp_ge_u32 s36, 2
    s_cbranch_scc1 L_k3_kernel_sk9
    s_add_u32 m0, s44, 55680
    s_nop 0
    buffer_load_dwordx4 v224, s[20:23], s39 offen lds
L_k3_kernel_sk9:
    s_add_u32 m0, s42, 55680
    s_nop 0
    buffer_load_dwordx4 v222, s[12:15], s39 offen lds
    s_waitcnt vmcnt(13)
    v_lshlrev_b32 v236, 16, v188
    v_and_b32 v237, 0xffff0000, v188
    ds_read_b64_tr_b16 v[200:201], v221 offset:18784
    ds_read_b64_tr_b16 v[202:203], v221 offset:23392
    s_waitcnt lgkmcnt(10)
    v_mfma_f32_32x32x16_bf16 v[36:51], v[204:207], v[180:183], v[36:51]
    v_lshlrev_b32 v238, 16, v189
    v_and_b32 v239, 0xffff0000, v189
    v_lshlrev_b32 v240, 16, v190
    ds_read_b64_tr_b16 v[204:205], v221 offset:18816
    ds_read_b64_tr_b16 v[206:207], v221 offset:23424
    s_waitcnt lgkmcnt(10)
    v_mfma_f32_32x32x16_bf16 v[52:67], v[208:211], v[180:183], v[52:67]
    v_and_b32 v241, 0xffff0000, v190
    v_lshlrev_b32 v242, 16, v191
    v_and_b32 v243, 0xffff0000, v191
    ds_read_b64_tr_b16 v[208:209], v221 offset:20864
    ds_read_b64_tr_b16 v[210:211], v221 offset:25472
    s_waitcnt lgkmcnt(10)
    v_mfma_f32_32x32x16_bf16 v[68:83], v[212:215], v[180:183], v[68:83]
    v_fma_f32 v236, v236, v227, v226
    v_fma_f32 v237, v237, v227, v226
    v_fma_f32 v238, v238, v227, v226
    ds_read_b64_tr_b16 v[212:213], v221 offset:20896
    ds_read_b64_tr_b16 v[214:215], v221 offset:25504
    s_waitcnt lgkmcnt(10)
    v_mfma_f32_32x32x16_bf16 v[84:99], v[216:219], v[180:183], v[84:99]
    s_add_u32 m0, s43, 55680
    s_nop 0
    buffer_load_dwordx4 v223, s[16:19], s39 offen lds
    v_fma_f32 v239, v239, v227, v226
    v_fma_f32 v240, v240, v227, v226
    v_fma_f32 v241, v241, v227, v226
    ds_read_b64_tr_b16 v[216:217], v221 offset:20928
    ds_read_b64_tr_b16 v[218:219], v221 offset:25536
    s_waitcnt lgkmcnt(10)
    v_mfma_f32_32x32x16_bf16 v[100:115], v[196:199], v[180:183], v[100:115]
    v_fma_f32 v242, v242, v227, v226
    v_fma_f32 v243, v243, v227, v226
    v_cvt_pk_bf16_f32 v188, v236, v237
    ds_read_b64_tr_b16 v[196:197], v221 offset:20960
    ds_read_b64_tr_b16 v[198:199], v221 offset:25568
    s_waitcnt lgkmcnt(10)
    v_mfma_f32_32x32x16_bf16 v[116:131], v[200:203], v[180:183], v[116:131]
    v_cvt_pk_bf16_f32 v189, v238, v239
    v_cvt_pk_bf16_f32 v190, v240, v241
    v_cvt_pk_bf16_f32 v191, v242, v243
    ds_read_b64_tr_b16 v[200:201], v221 offset:20992
    ds_read_b64_tr_b16 v[202:203], v221 offset:25600
    s_waitcnt lgkmcnt(10)
    v_mfma_f32_32x32x16_bf16 v[132:147], v[204:207], v[180:183], v[132:147]
    v_lshlrev_b32 v236, 16, v192
    v_and_b32 v237, 0xffff0000, v192
    v_lshlrev_b32 v238, 16, v193
    ds_read_b64_tr_b16 v[204:205], v221 offset:21024
    ds_read_b64_tr_b16 v[206:207], v221 offset:25632
    s_waitcnt lgkmcnt(10)
    v_mfma_f32_32x32x16_bf16 v[4:19], v[208:211], v[184:187], v[4:19]
    buffer_load_dwordx4 v[172:175], v225, s[24:27], s40 offen
    v_and_b32 v239, 0xffff0000, v193
    v_lshlrev_b32 v240, 16, v194
    v_and_b32 v241, 0xffff0000, v194
    ds_read_b64_tr_b16 v[208:209], v221 offset:21056
    ds_read_b64_tr_b16 v[210:211], v221 offset:25664
    s_waitcnt lgkmcnt(10)
    v_mfma_f32_32x32x16_bf16 v[20:35], v[212:215], v[184:187], v[20:35]
    v_lshlrev_b32 v242, 16, v195
    v_and_b32 v243, 0xffff0000, v195
    v_fma_f32 v236, v236, v227, v226
    ds_read_b64_tr_b16 v[212:213], v221 offset:21088
    ds_read_b64_tr_b16 v[214:215], v221 offset:25696
    s_waitcnt lgkmcnt(10)
    v_mfma_f32_32x32x16_bf16 v[36:51], v[216:219], v[184:187], v[36:51]
    v_fma_f32 v237, v237, v227, v226
    v_fma_f32 v238, v238, v227, v226
    v_fma_f32 v239, v239, v227, v226
    ds_read_b64_tr_b16 v[216:217], v221 offset:21120
    ds_read_b64_tr_b16 v[218:219], v221 offset:25728
    s_waitcnt lgkmcnt(10)
    v_mfma_f32_32x32x16_bf16 v[52:67], v[196:199], v[184:187], v[52:67]
    v_fma_f32 v240, v240, v227, v226
    v_fma_f32 v241, v241, v227, v226
    v_fma_f32 v242, v242, v227, v226
    ds_read_b64_tr_b16 v[196:197], v221 offset:37120
    ds_read_b64_tr_b16 v[198:199], v221 offset:41728
    s_waitcnt lgkmcnt(10)
    v_mfma_f32_32x32x16_bf16 v[68:83], v[200:203], v[184:187], v[68:83]
    buffer_load_dwordx4 v[176:179], v225, s[24:27], s40 offen offset:512
    s_add_u32 s56, s56, 1
    s_cmp_eq_u32 s56, 18
    s_cselect_b32 s56, 0, s56
    s_mul_i32 s39, s56, 294912
    s_lshl_b32 s40, s56, 10
    v_fma_f32 v243, v243, v227, v226
    v_cvt_pk_bf16_f32 v192, v236, v237
    v_cvt_pk_bf16_f32 v193, v238, v239
    ds_read_b64_tr_b16 v[200:201], v221 offset:37152
    ds_read_b64_tr_b16 v[202:203], v221 offset:41760
    s_waitcnt lgkmcnt(10)
    v_mfma_f32_32x32x16_bf16 v[84:99], v[204:207], v[184:187], v[84:99]
    v_cvt_pk_bf16_f32 v194, v240, v241
    v_cvt_pk_bf16_f32 v195, v242, v243
    ds_read_b64_tr_b16 v[204:205], v221 offset:37184
    ds_read_b64_tr_b16 v[206:207], v221 offset:41792
    s_waitcnt lgkmcnt(10)
    v_mfma_f32_32x32x16_bf16 v[100:115], v[208:211], v[184:187], v[100:115]
    ds_read_b64_tr_b16 v[208:209], v221 offset:37216
    ds_read_b64_tr_b16 v[210:211], v221 offset:41824
    s_waitcnt lgkmcnt(10)
    v_mfma_f32_32x32x16_bf16 v[116:131], v[212:215], v[184:187], v[116:131]
    ds_read_b64_tr_b16 v[212:213], v221 offset:37248
    ds_read_b64_tr_b16 v[214:215], v221 offset:41856
    s_waitcnt lgkmcnt(10)
    v_mfma_f32_32x32x16_bf16 v[132:147], v[216:219], v[184:187], v[132:147]
    s_waitcnt vmcnt(14)
    s_barrier
    ds_read_b64_tr_b16 v[216:217], v221 offset:37280
    ds_read_b64_tr_b16 v[218:219], v221 offset:41888
    s_waitcnt lgkmcnt(10)
    v_mfma_f32_32x32x16_bf16 v[4:19], v[196:199], v[188:191], v[4:19]
    ds_read_b64_tr_b16 v[196:197], v221 offset:37312
    ds_read_b64_tr_b16 v[198:199], v221 offset:41920
    s_waitcnt lgkmcnt(10)
    v_mfma_f32_32x32x16_bf16 v[20:35], v[200:203], v[188:191], v[20:35]
    s_cmp_ge_u32 s36, 2
    s_cbranch_scc1 L_k3_kernel_sk10
    s_add_u32 m0, s44, 74240
    s_nop 0
    buffer_load_dwordx4 v224, s[20:23], s39 offen lds
L_k3_kernel_sk10:
    s_add_u32 m0, s42, 74240
    s_nop 0
    buffer_load_dwordx4 v222, s[12:15], s39 offen lds
    s_waitcnt vmcnt(13)
    v_lshlrev_b32 v236, 16, v148
    v_and_b32 v237, 0xffff0000, v148
    ds_read_b64_tr_b16 v[200:201], v221 offset:37344
    ds_read_b64_tr_b16 v[202:203], v221 offset:41952
    s_waitcnt lgkmcnt(10)
    v_mfma_f32_32x32x16_bf16 v[36:51], v[204:207], v[188:191], v[36:51]
    v_lshlrev_b32 v238, 16, v149
    v_and_b32 v239, 0xffff0000, v149
    v_lshlrev_b32 v240, 16, v150
    ds_read_b64_tr_b16 v[204:205], v221 offset:37376
    ds_read_b64_tr_b16 v[206:207], v221 offset:41984
    s_waitcnt lgkmcnt(10)
    v_mfma_f32_32x32x16_bf16 v[52:67], v[208:211], v[188:191], v[52:67]
    v_and_b32 v241, 0xffff0000, v150
    v_lshlrev_b32 v242, 16, v151
    v_and_b32 v243, 0xffff0000, v151
    ds_read_b64_tr_b16 v[208:209], v221 offset:39424
    ds_read_b64_tr_b16 v[210:211], v221 offset:44032
    s_waitcnt lgkmcnt(10)
    v_mfma_f32_32x32x16_bf16 v[68:83], v[212:215], v[188:191], v[68:83]
    v_fma_f32 v236, v236, v227, v226
    v_fma_f32 v237, v237, v227, v226
    v_fma_f32 v238, v238, v227, v226
    ds_read_b64_tr_b16 v[212:213], v221 offset:39456
    ds_read_b64_tr_b16 v[214:215], v221 offset:44064
    s_waitcnt lgkmcnt(10)
    v_mfma_f32_32x32x16_bf16 v[84:99], v[216:219], v[188:191], v[84:99]
    s_add_u32 m0, s43, 74240
    s_nop 0
    buffer_load_dwordx4 v223, s[16:19], s39 offen lds
    v_fma_f32 v239, v239, v227, v226
    v_fma_f32 v240, v240, v227, v226
    v_fma_f32 v241, v241, v227, v226
    ds_read_b64_tr_b16 v[216:217], v221 offset:39488
    ds_read_b64_tr_b16 v[218:219], v221 offset:44096
    s_waitcnt lgkmcnt(10)
    v_mfma_f32_32x32x16_bf16 v[100:115], v[196:199], v[188:191], v[100:115]
    v_fma_f32 v242, v242, v227, v226
    v_fma_f32 v243, v243, v227, v226
    v_cvt_pk_bf16_f32 v148, v236, v237
    ds_read_b64_tr_b16 v[196:197], v221 offset:39520
    ds_read_b64_tr_b16 v[198:199], v221 offset:44128
    s_waitcnt lgkmcnt(10)
    v_mfma_f32_32x32x16_bf16 v[116:131], v[200:203], v[188:191], v[116:131]
    v_cvt_pk_bf16_f32 v149, v238, v239
    v_cvt_pk_bf16_f32 v150, v240, v241
    v_cvt_pk_bf16_f32 v151, v242, v243
    ds_read_b64_tr_b16 v[200:201], v221 offset:39552
    ds_read_b64_tr_b16 v[202:203], v221 offset:44160
    s_waitcnt lgkmcnt(10)
    v_mfma_f32_32x32x16_bf16 v[132:147], v[204:207], v[188:191], v[132:147]
    v_lshlrev_b32 v236, 16, v152
    v_and_b32 v237, 0xffff0000, v152
    v_lshlrev_b32 v238, 16, v153
    ds_read_b64_tr_b16 v[204:205], v221 offset:39584
    ds_read_b64_tr_b16 v[206:207], v221 offset:44192
    s_waitcnt lgkmcnt(10)
    v_mfma_f32_32x32x16_bf16 v[4:19], v[208:211], v[192:195], v[4:19]
    buffer_load_dwordx4 v[180:183], v225, s[24:27], s40 offen
    v_and_b32 v239, 0xffff0000, v153
    v_lshlrev_b32 v240, 16, v154
    v_and_b32 v241, 0xffff0000, v154
    ds_read_b64_tr_b16 v[208:209], v221 offset:39616
    ds_read_b64_tr_b16 v[210:211], v221 offset:44224
    s_waitcnt lgkmcnt(10)
    v_mfma_f32_32x32x16_bf16 v[20:35], v[212:215], v[192:195], v[20:35]
    v_lshlrev_b32 v242, 16, v155
    v_and_b32 v243, 0xffff0000, v155
    v_fma_f32 v236, v236, v227, v226
    ds_read_b64_tr_b16 v[212:213], v221 offset:39648
    ds_read_b64_tr_b16 v[214:215], v221 offset:44256
    s_waitcnt lgkmcnt(10)
    v_mfma_f32_32x32x16_bf16 v[36:51], v[216:219], v[192:195], v[36:51]
    v_fma_f32 v237, v237, v227, v226
    v_fma_f32 v238, v238, v227, v226
    v_fma_f32 v239, v239, v227, v226
    ds_read_b64_tr_b16 v[216:217], v221 offset:39680
    ds_read_b64_tr_b16 v[218:219], v221 offset:44288
    s_waitcnt lgkmcnt(10)
    v_mfma_f32_32x32x16_bf16 v[52:67], v[196:199], v[192:195], v[52:67]
    v_fma_f32 v240, v240, v227, v226
    v_fma_f32 v241, v241, v227, v226
    v_fma_f32 v242, v242, v227, v226
    ds_read_b64_tr_b16 v[196:197], v220 offset:0
    ds_read_b64_tr_b16 v[198:199], v220 offset:4608
    s_waitcnt lgkmcnt(10)
    v_mfma_f32_32x32x16_bf16 v[68:83], v[200:203], v[192:195], v[68:83]
    buffer_load_dwordx4 v[184:187], v225, s[24:27], s40 offen offset:512
    s_add_u32 s56, s56, 1
    s_cmp_eq_u32 s56, 18
    s_cselect_b32 s56, 0, s56
    s_mul_i32 s39, s56, 294912
    s_lshl_b32 s40, s56, 10
    v_fma_f32 v243, v243, v227, v226
    v_cvt_pk_bf16_f32 v152, v236, v237
    v_cvt_pk_bf16_f32 v153, v238, v239
    ds_read_b64_tr_b16 v[200:201], v220 offset:32
    ds_read_b64_tr_b16 v[202:203], v220 offset:4640
    s_waitcnt lgkmcnt(10)
    v_mfma_f32_32x32x16_bf16 v[84:99], v[204:207], v[192:195], v[84:99]
    v_cvt_pk_bf16_f32 v154, v240, v241
    v_cvt_pk_bf16_f32 v155, v242, v243
    ds_read_b64_tr_b16 v[204:205], v220 offset:64
    ds_read_b64_tr_b16 v[206:207], v220 offset:4672
    s_waitcnt lgkmcnt(10)
    v_mfma_f32_32x32x16_bf16 v[100:115], v[208:211], v[192:195], v[100:115]
    ds_read_b64_tr_b16 v[208:209], v220 offset:96
    ds_read_b64_tr_b16 v[210:211], v220 offset:4704
    s_waitcnt lgkmcnt(10)
    v_mfma_f32_32x32x16_bf16 v[116:131], v[212:215], v[192:195], v[116:131]
    ds_read_b64_tr_b16 v[212:213], v220 offset:128
    ds_read_b64_tr_b16 v[214:215], v220 offset:4736
    s_waitcnt lgkmcnt(10)
    v_mfma_f32_32x32x16_bf16 v[132:147], v[216:219], v[192:195], v[132:147]
    s_waitcnt vmcnt(14)
    s_barrier
    ds_read_b64_tr_b16 v[216:217], v220 offset:160
    ds_read_b64_tr_b16 v[218:219], v220 offset:4768
    s_waitcnt lgkmcnt(10)
    v_mfma_f32_32x32x16_bf16 v[4:19], v[196:199], v[148:151], v[4:19]
    ds_read_b64_tr_b16 v[196:197], v220 offset:192
    ds_read_b64_tr_b16 v[198:199], v220 offset:4800
    s_waitcnt lgkmcnt(10)
    v_mfma_f32_32x32x16_bf16 v[20:35], v[200:203], v[148:151], v[20:35]
    s_cmp_ge_u32 s36, 2
    s_cbranch_scc1 L_k3_kernel_sk11
    s_add_u32 m0, s44, 92800
    s_nop 0
    buffer_load_dwordx4 v224, s[20:23], s39 offen lds
L_k3_kernel_sk11:
    s_add_u32 m0, s42, 92800
    s_nop 0
    buffer_load_dwordx4 v222, s[12:15], s39 offen lds
    s_waitcnt vmcnt(13)
    v_lshlrev_b32 v236, 16, v156
    v_and_b32 v237, 0xffff0000, v156
    ds_read_b64_tr_b16 v[200:201], v220 offset:224
    ds_read_b64_tr_b16 v[202:203], v220 offset:4832
    s_waitcnt lgkmcnt(10)
    v_mfma_f32_32x32x16_bf16 v[36:51], v[204:207], v[148:151], v[36:51]
    v_lshlrev_b32 v238, 16, v157
    v_and_b32 v239, 0xffff0000, v157
    v_lshlrev_b32 v240, 16, v158
    ds_read_b64_tr_b16 v[204:205], v220 offset:256
    ds_read_b64_tr_b16 v[206:207], v220 offset:4864
    s_waitcnt lgkmcnt(10)
    v_mfma_f32_32x32x16_bf16 v[52:67], v[208:211], v[148:151], v[52:67]
    v_and_b32 v241, 0xffff0000, v158
    v_lshlrev_b32 v242, 16, v159
    v_and_b32 v243, 0xffff0000, v159
    ds_read_b64_tr_b16 v[208:209], v220 offset:2304
    ds_read_b64_tr_b16 v[210:211], v220 offset:6912
    s_waitcnt lgkmcnt(10)
    v_mfma_f32_32x32x16_bf16 v[68:83], v[212:215], v[148:151], v[68:83]
    v_fma_f32 v236, v236, v227, v226
    v_fma_f32 v237, v237, v227, v226
    v_fma_f32 v238, v238, v227, v226
    ds_read_b64_tr_b16 v[212:213], v220 offset:2336
    ds_read_b64_tr_b16 v[214:215], v220 offset:6944
    s_waitcnt lgkmcnt(10)
    v_mfma_f32_32x32x16_bf16 v[84:99], v[216:219], v[148:151], v[84:99]
    s_add_u32 m0, s43, 92800
    s_nop 0
    buffer_load_dwordx4 v223, s[16:19], s39 offen lds
    v_fma_f32 v239, v239, v227, v226
    v_fma_f32 v240, v240, v227, v226
    v_fma_f32 v241, v241, v227, v226
    ds_read_b64_tr_b16 v[216:217], v220 offset:2368
    ds_read_b64_tr_b16 v[218:219], v220 offset:6976
    s_waitcnt lgkmcnt(10)
    v_mfma_f32_32x32x16_bf16 v[100:115], v[196:199], v[148:151], v[100:115]
    v_fma_f32 v242, v242, v227, v226
    v_fma_f32 v243, v243, v227, v226
    v_cvt_pk_bf16_f32 v156, v236, v237
    ds_read_b64_tr_b16 v[196:197], v220 offset:2400
    ds_read_b64_tr_b16 v[198:199], v220 offset:7008
    s_waitcnt lgkmcnt(10)
    v_mfma_f32_32x32x16_bf16 v[116:131], v[200:203], v[148:151], v[116:131]
    v_cvt_pk_bf16_f32 v157, v238, v239
    v_cvt_pk_bf16_f32 v158, v240, v241
    v_cvt_pk_bf16_f32 v159, v242, v243
    ds_read_b64_tr_b16 v[200:201], v220 offset:2432
    ds_read_b64_tr_b16 v[202:203], v220 offset:7040
    s_waitcnt lgkmcnt(10)
    v_mfma_f32_32x32x16_bf16 v[132:147], v[204:207], v[148:151], v[132:147]
    v_lshlrev_b32 v236, 16, v160
    v_and_b32 v237, 0xffff0000, v160
    v_lshlrev_b32 v238, 16, v161
    ds_read_b64_tr_b16 v[204:205], v220 offset:2464
    ds_read_b64_tr_b16 v[206:207], v220 offset:7072
    s_waitcnt lgkmcnt(10)
    v_mfma_f32_32x32x16_bf16 v[4:19], v[208:211], v[152:155], v[4:19]
    buffer_load_dwordx4 v[188:191], v225, s[24:27], s40 offen
    v_and_b32 v239, 0xffff0000, v161
    v_lshlrev_b32 v240, 16, v162
    v_and_b32 v241, 0xffff0000, v162
    ds_read_b64_tr_b16 v[208:209], v220 offset:2496
    ds_read_b64_tr_b16 v[210:211], v220 offset:7104
    s_waitcnt lgkmcnt(10)
    v_mfma_f32_32x32x16_bf16 v[20:35], v[212:215], v[152:155], v[20:35]
    v_lshlrev_b32 v242, 16, v163
    v_and_b32 v243, 0xffff0000, v163
    v_fma_f32 v236, v236, v227, v226
    ds_read_b64_tr_b16 v[212:213], v220 offset:2528
    ds_read_b64_tr_b16 v[214:215], v220 offset:7136
    s_waitcnt lgkmcnt(10)
    v_mfma_f32_32x32x16_bf16 v[36:51], v[216:219], v[152:155], v[36:51]
    v_fma_f32 v237, v237, v227, v226
    v_fma_f32 v238, v238, v227, v226
    v_fma_f32 v239, v239, v227, v226
    ds_read_b64_tr_b16 v[216:217], v220 offset:2560
    ds_read_b64_tr_b16 v[218:219], v220 offset:7168
    s_waitcnt lgkmcnt(10)
    v_mfma_f32_32x32x16_bf16 v[52:67], v[196:199], v[152:155], v[52:67]
    v_fma_f32 v240, v240, v227, v226
    v_fma_f32 v241, v241, v227, v226
    v_fma_f32 v242, v242, v227, v226
    ds_read_b64_tr_b16 v[196:197], v220 offset:18560
    ds_read_b64_tr_b16 v[198:199], v220 offset:23168
    s_waitcnt lgkmcnt(10)
    v_mfma_f32_32x32x16_bf16 v[68:83], v[200:203], v[152:155], v[68:83]
    buffer_load_dwordx4 v[192:195], v225, s[24:27], s40 offen offset:512
    s_add_u32 s56, s56, 1
    s_cmp_eq_u32 s56, 18
    s_cselect_b32 s56, 0, s56
    s_mul_i32 s39, s56, 294912
    s_lshl_b32 s40, s56, 10
    v_fma_f32 v243, v243, v227, v226
    v_cvt_pk_bf16_f32 v160, v236, v237
    v_cvt_pk_bf16_f32 v161, v238, v239
    ds_read_b64_tr_b16 v[200:201], v220 offset:18592
    ds_read_b64_tr_b16 v[202:203], v220 offset:23200
    s_waitcnt lgkmcnt(10)
    v_mfma_f32_32x32x16_bf16 v[84:99], v[204:207], v[152:155], v[84:99]
    v_cvt_pk_bf16_f32 v162, v240, v241
    v_cvt_pk_bf16_f32 v163, v242, v243
    ds_read_b64_tr_b16 v[204:205], v220 offset:18624
    ds_read_b64_tr_b16 v[206:207], v220 offset:23232
    s_waitcnt lgkmcnt(10)
    v_mfma_f32_32x32x16_bf16 v[100:115], v[208:211], v[152:155], v[100:115]
    ds_read_b64_tr_b16 v[208:209], v220 offset:18656
    ds_read_b64_tr_b16 v[210:211], v220 offset:23264
    s_waitcnt lgkmcnt(10)
    v_mfma_f32_32x32x16_bf16 v[116:131], v[212:215], v[152:155], v[116:131]
    ds_read_b64_tr_b16 v[212:213], v220 offset:18688
    ds_read_b64_tr_b16 v[214:215], v220 offset:23296
    s_waitcnt lgkmcnt(10)
    v_mfma_f32_32x32x16_bf16 v[132:147], v[216:219], v[152:155], v[132:147]
    s_waitcnt vmcnt(14)
    s_barrier
    ds_read_b64_tr_b16 v[216:217], v220 offset:18720
    ds_read_b64_tr_b16 v[218:219], v220 offset:23328
    s_waitcnt lgkmcnt(10)
    v_mfma_f32_32x32x16_bf16 v[4:19], v[196:199], v[156:159], v[4:19]
    ds_read_b64_tr_b16 v[196:197], v220 offset:18752
    ds_read_b64_tr_b16 v[198:199], v220 offset:23360
    s_waitcnt lgkmcnt(10)
    v_mfma_f32_32x32x16_bf16 v[20:35], v[200:203], v[156:159], v[20:35]
    s_cmp_ge_u32 s36, 2
    s_cbranch_scc1 L_k3_kernel_sk12
    s_add_u32 m0, s44, 0
    s_nop 0
    buffer_load_dwordx4 v224, s[20:23], s39 offen lds
L_k3_kernel_sk12:
    s_add_u32 m0, s42, 0
    s_nop 0
    buffer_load_dwordx4 v222, s[12:15], s39 offen lds
    s_waitcnt vmcnt(13)
    v_lshlrev_b32 v236, 16, v164
    v_and_b32 v237, 0xffff0000, v164
    ds_read_b64_tr_b16 v[200:201], v220 offset:18784
    ds_read_b64_tr_b16 v[202:203], v220 offset:23392
    s_waitcnt lgkmcnt(10)
    v_mfma_f32_32x32x16_bf16 v[36:51], v[204:207], v[156:159], v[36:51]
    v_lshlrev_b32 v238, 16, v165
    v_and_b32 v239, 0xffff0000, v165
    v_lshlrev_b32 v240, 16, v166
    ds_read_b64_tr_b16 v[204:205], v220 offset:18816
    ds_read_b64_tr_b16 v[206:207], v220 offset:23424
    s_waitcnt lgkmcnt(10)
    v_mfma_f32_32x32x16_bf16 v[52:67], v[208:211], v[156:159], v[52:67]
    v_and_b32 v241, 0xffff0000, v166
    v_lshlrev_b32 v242, 16, v167
    v_and_b32 v243, 0xffff0000, v167
    ds_read_b64_tr_b16 v[208:209], v220 offset:20864
    ds_read_b64_tr_b16 v[210:211], v220 offset:25472
    s_waitcnt lgkmcnt(10)
    v_mfma_f32_32x32x16_bf16 v[68:83], v[212:215], v[156:159], v[68:83]
    v_fma_f32 v236, v236, v227, v226
    v_fma_f32 v237, v237, v227, v226
    v_fma_f32 v238, v238, v227, v226
    ds_read_b64_tr_b16 v[212:213], v220 offset:20896
    ds_read_b64_tr_b16 v[214:215], v220 offset:25504
    s_waitcnt lgkmcnt(10)
    v_mfma_f32_32x32x16_bf16 v[84:99], v[216:219], v[156:159], v[84:99]
    s_add_u32 m0, s43, 0
    s_nop 0
    buffer_load_dwordx4 v223, s[16:19], s39 offen lds
    v_fma_f32 v239, v239, v227, v226
    v_fma_f32 v240, v240, v227, v226
    v_fma_f32 v241, v241, v227, v226
    ds_read_b64_tr_b16 v[216:217], v220 offset:20928
    ds_read_b64_tr_b16 v[218:219], v220 offset:25536
    s_waitcnt lgkmcnt(10)
    v_mfma_f32_32x32x16_bf16 v[100:115], v[196:199], v[156:159], v[100:115]
    v_fma_f32 v242, v242, v227, v226
    v_fma_f32 v243, v243, v227, v226
    v_cvt_pk_bf16_f32 v164, v236, v237
    ds_read_b64_tr_b16 v[196:197], v220 offset:20960
    ds_read_b64_tr_b16 v[198:199], v220 offset:25568
    s_waitcnt lgkmcnt(10)
    v_mfma_f32_32x32x16_bf16 v[116:131], v[200:203], v[156:159], v[116:131]
    v_cvt_pk_bf16_f32 v165, v238, v239
    v_cvt_pk_bf16_f32 v166, v240, v241
    v_cvt_pk_bf16_f32 v167, v242, v243
    ds_read_b64_tr_b16 v[200:201], v220 offset:20992
    ds_read_b64_tr_b16 v[202:203], v220 offset:25600
    s_waitcnt lgkmcnt(10)
    v_mfma_f32_32x32x16_bf16 v[132:147], v[204:207], v[156:159], v[132:147]
    v_lshlrev_b32 v236, 16, v168
    v_and_b32 v237, 0xffff0000, v168
    v_lshlrev_b32 v238, 16, v169
    ds_read_b64_tr_b16 v[204:205], v220 offset:21024
    ds_read_b64_tr_b16 v[206:207], v220 offset:25632
    s_waitcnt lgkmcnt(10)
    v_mfma_f32_32x32x16_bf16 v[4:19], v[208:211], v[160:163], v[4:19]
    buffer_load_dwordx4 v[148:151], v225, s[24:27], s40 offen
    v_and_b32 v239, 0xffff0000, v169
    v_lshlrev_b32 v240, 16, v170
    v_and_b32 v241, 0xffff0000, v170
    ds_read_b64_tr_b16 v[208:209], v220 offset:21056
    ds_read_b64_tr_b16 v[210:211], v220 offset:25664
    s_waitcnt lgkmcnt(10)
    v_mfma_f32_32x32x16_bf16 v[20:35], v[212:215], v[160:163], v[20:35]
    v_lshlrev_b32 v242, 16, v171
    v_and_b32 v243, 0xffff0000, v171
    v_fma_f32 v236, v236, v227, v226
    ds_read_b64_tr_b16 v[212:213], v220 offset:21088
    ds_read_b64_tr_b16 v[214:215], v220 offset:25696
    s_waitcnt lgkmcnt(10)
    v_mfma_f32_32x32x16_bf16 v[36:51], v[216:219], v[160:163], v[36:51]
    v_fma_f32 v237, v237, v227, v226
    v_fma_f32 v238, v238, v227, v226
    v_fma_f32 v239, v239, v227, v226
    ds_read_b64_tr_b16 v[216:217], v220 offset:21120
    ds_read_b64_tr_b16 v[218:219], v220 offset:25728
    s_waitcnt lgkmcnt(10)
    v_mfma_f32_32x32x16_bf16 v[52:67], v[196:199], v[160:163], v[52:67]
    v_fma_f32 v240, v240, v227, v226
    v_fma_f32 v241, v241, v227, v226
    v_fma_f32 v242, v242, v227, v226
    ds_read_b64_tr_b16 v[196:197], v220 offset:37120
    ds_read_b64_tr_b16 v[198:199], v220 offset:41728
    s_waitcnt lgkmcnt(10)
    v_mfma_f32_32x32x16_bf16 v[68:83], v[200:203], v[160:163], v[68:83]
    buffer_load_dwordx4 v[152:155], v225, s[24:27], s40 offen offset:512
    s_add_u32 s56, s56, 1
    s_cmp_eq_u32 s56, 18
    s_cselect_b32 s56, 0, s56
    s_mul_i32 s39, s56, 294912
    s_lshl_b32 s40, s56, 10
    v_fma_f32 v243, v243, v227, v226
    v_cvt_pk_bf16_f32 v168, v236, v237
    v_cvt_pk_bf16_f32 v169, v238, v239
    ds_read_b64_tr_b16 v[200:201], v220 offset:37152
    ds_read_b64_tr_b16 v[202:203], v220 offset:41760
    s_waitcnt lgkmcnt(10)
    v_mfma_f32_32x32x16_bf16 v[84:99], v[204:207], v[160:163], v[84:99]
    v_cvt_pk_bf16_f32 v170, v240, v241
    v_cvt_pk_bf16_f32 v171, v242, v243
    ds_read_b64_tr_b16 v[204:205], v220 offset:37184
    ds_read_b64_tr_b16 v[206:207], v220 offset:41792
    s_waitcnt lgkmcnt(10)
    v_mfma_f32_32x32x16_bf16 v[100:115], v[208:211], v[160:163], v[100:115]
    ds_read_b64_tr_b16 v[208:209], v220 offset:37216
    ds_read_b64_tr_b16 v[210:211], v220 offset:41824
    s_waitcnt lgkmcnt(10)
    v_mfma_f32_32x32x16_bf16 v[116:131], v[212:215], v[160:163], v[116:131]
    ds_read_b64_tr_b16 v[212:213], v220 offset:37248
    ds_read_b64_tr_b16 v[214:215], v220 offset:41856
    s_waitcnt lgkmcnt(10)
    v_mfma_f32_32x32x16_bf16 v[132:147], v[216:219], v[160:163], v[132:147]
    s_waitcnt vmcnt(14)
    s_barrier
    ds_read_b64_tr_b16 v[216:217], v220 offset:37280
    ds_read_b64_tr_b16 v[218:219], v220 offset:41888
    s_waitcnt lgkmcnt(10)
    v_mfma_f32_32x32x16_bf16 v[4:19], v[196:199], v[164:167], v[4:19]
    ds_read_b64_tr_b16 v[196:197], v220 offset:37312
    ds_read_b64_tr_b16 v[198:199], v220 offset:41920
    s_waitcnt lgkmcnt(10)
    v_mfma_f32_32x32x16_bf16 v[20:35], v[200:203], v[164:167], v[20:35]
    s_cmp_ge_u32 s36, 2
    s_cbranch_scc1 L_k3_kernel_sk13
    s_add_u32 m0, s44, 18560
    s_nop 0
    buffer_load_dwordx4 v224, s[20:23], s39 offen lds
L_k3_kernel_sk13:
    s_add_u32 m0, s42, 18560
    s_nop 0
    buffer_load_dwordx4 v222, s[12:15], s39 offen lds
    s_waitcnt vmcnt(13)
    v_lshlrev_b32 v236, 16, v172
    v_and_b32 v237, 0xffff0000, v172
    ds_read_b64_tr_b16 v[200:201], v220 offset:37344
    ds_read_b64_tr_b16 v[202:203], v220 offset:41952
    s_waitcnt lgkmcnt(10)
    v_mfma_f32_32x32x16_bf16 v[36:51], v[204:207], v[164:167], v[36:51]
    v_lshlrev_b32 v238, 16, v173
    v_and_b32 v239, 0xffff0000, v173
    v_lshlrev_b32 v240, 16, v174
    ds_read_b64_tr_b16 v[204:205], v220 offset:37376
    ds_read_b64_tr_b16 v[206:207], v220 offset:41984
    s_waitcnt lgkmcnt(10)
    v_mfma_f32_32x32x16_bf16 v[52:67], v[208:211], v[164:167], v[52:67]
    v_and_b32 v241, 0xffff0000, v174
    v_lshlrev_b32 v242, 16, v175
    v_and_b32 v243, 0xffff0000, v175
    ds_read_b64_tr_b16 v[208:209], v220 offset:39424
    ds_read_b64_tr_b16 v[210:211], v220 offset:44032
    s_waitcnt lgkmcnt(10)
    v_mfma_f32_32x32x16_bf16 v[68:83], v[212:215], v[164:167], v[68:83]
    v_fma_f32 v236, v236, v227, v226
    v_fma_f32 v237, v237, v227, v226
    v_fma_f32 v238, v238, v227, v226
    ds_read_b64_tr_b16 v[212:213], v220 offset:39456
    ds_read_b64_tr_b16 v[214:215], v220 offset:44064
    s_waitcnt lgkmcnt(10)
    v_mfma_f32_32x32x16_bf16 v[84:99], v[216:219], v[164:167], v[84:99]
    s_add_u32 m0, s43, 18560
    s_nop 0
    buffer_load_dwordx4 v223, s[16:19], s39 offen lds
    v_fma_f32 v239, v239, v227, v226
    v_fma_f32 v240, v240, v227, v226
    v_fma_f32 v241, v241, v227, v226
    ds_read_b64_tr_b16 v[216:217], v220 offset:39488
    ds_read_b64_tr_b16 v[218:219], v220 offset:44096
    s_waitcnt lgkmcnt(10)
    v_mfma_f32_32x32x16_bf16 v[100:115], v[196:199], v[164:167], v[100:115]
    v_fma_f32 v242, v242, v227, v226
    v_fma_f32 v243, v243, v227, v226
    v_cvt_pk_bf16_f32 v172, v236, v237
    ds_read_b64_tr_b16 v[196:197], v220 offset:39520
    ds_read_b64_tr_b16 v[198:199], v220 offset:44128
    s_waitcnt lgkmcnt(10)
    v_mfma_f32_32x32x16_bf16 v[116:131], v[200:203], v[164:167], v[116:131]
    v_cvt_pk_bf16_f32 v173, v238, v239
    v_cvt_pk_bf16_f32 v174, v240, v241
    v_cvt_pk_bf16_f32 v175, v242, v243
    ds_read_b64_tr_b16 v[200:201], v220 offset:39552
    ds_read_b64_tr_b16 v[202:203], v220 offset:44160
    s_waitcnt lgkmcnt(10)
    v_mfma_f32_32x32x16_bf16 v[132:147], v[204:207], v[164:167], v[132:147]
    v_lshlrev_b32 v236, 16, v176
    v_and_b32 v237, 0xffff0000, v176
    v_lshlrev_b32 v238, 16, v177
    ds_read_b64_tr_b16 v[204:205], v220 offset:39584
    ds_read_b64_tr_b16 v[206:207], v220 offset:44192
    s_waitcnt lgkmcnt(10)
    v_mfma_f32_32x32x16_bf16 v[4:19], v[208:211], v[168:171], v[4:19]
    buffer_load_dwordx4 v[156:159], v225, s[24:27], s40 offen
    v_and_b32 v239, 0xffff0000, v177
    v_lshlrev_b32 v240, 16, v178
    v_and_b32 v241, 0xffff0000, v178
    ds_read_b64_tr_b16 v[208:209], v220 offset:39616
    ds_read_b64_tr_b16 v[210:211], v220 offset:44224
    s_waitcnt lgkmcnt(10)
    v_mfma_f32_32x32x16_bf16 v[20:35], v[212:215], v[168:171], v[20:35]
    v_lshlrev_b32 v242, 16, v179
    v_and_b32 v243, 0xffff0000, v179
    v_fma_f32 v236, v236, v227, v226
    ds_read_b64_tr_b16 v[212:213], v220 offset:39648
    ds_read_b64_tr_b16 v[214:215], v220 offset:44256
    s_waitcnt lgkmcnt(10)
    v_mfma_f32_32x32x16_bf16 v[36:51], v[216:219], v[168:171], v[36:51]
    v_fma_f32 v237, v237, v227, v226
    v_fma_f32 v238, v238, v227, v226
    v_fma_f32 v239, v239, v227, v226
    ds_read_b64_tr_b16 v[216:217], v220 offset:39680
    ds_read_b64_tr_b16 v[218:219], v220 offset:44288
    s_waitcnt lgkmcnt(10)
    v_mfma_f32_32x32x16_bf16 v[52:67], v[196:199], v[168:171], v[52:67]
    v_fma_f32 v240, v240, v227, v226
    v_fma_f32 v241, v241, v227, v226
    v_fma_f32 v242, v242, v227, v226
    ds_read_b64_tr_b16 v[196:197], v221 offset:0
    ds_read_b64_tr_b16 v[198:199], v221 offset:4608
    s_waitcnt lgkmcnt(10)
    v_mfma_f32_32x32x16_bf16 v[68:83], v[200:203], v[168:171], v[68:83]
    buffer_load_dwordx4 v[160:163], v225, s[24:27], s40 offen offset:512
    s_add_u32 s56, s56, 1
    s_cmp_eq_u32 s56, 18
    s_cselect_b32 s56, 0, s56
    s_mul_i32 s39, s56, 294912
    s_lshl_b32 s40, s56, 10
    v_fma_f32 v243, v243, v227, v226
    v_cvt_pk_bf16_f32 v176, v236, v237
    v_cvt_pk_bf16_f32 v177, v238, v239
    ds_read_b64_tr_b16 v[200:201], v221 offset:32
    ds_read_b64_tr_b16 v[202:203], v221 offset:4640
    s_waitcnt lgkmcnt(10)
    v_mfma_f32_32x32x16_bf16 v[84:99], v[204:207], v[168:171], v[84:99]
    v_cvt_pk_bf16_f32 v178, v240, v241
    v_cvt_pk_bf16_f32 v179, v242, v243
    ds_read_b64_tr_b16 v[204:205], v221 offset:64
    ds_read_b64_tr_b16 v[206:207], v221 offset:4672
    s_waitcnt lgkmcnt(10)
    v_mfma_f32_32x32x16_bf16 v[100:115], v[208:211], v[168:171], v[100:115]
    ds_read_b64_tr_b16 v[208:209], v221 offset:96
    ds_read_b64_tr_b16 v[210:211], v221 offset:4704
    s_waitcnt lgkmcnt(10)
    v_mfma_f32_32x32x16_bf16 v[116:131], v[212:215], v[168:171], v[116:131]
    ds_read_b64_tr_b16 v[212:213], v221 offset:128
    ds_read_b64_tr_b16 v[214:215], v221 offset:4736
    s_waitcnt lgkmcnt(10)
    v_mfma_f32_32x32x16_bf16 v[132:147], v[216:219], v[168:171], v[132:147]
    s_waitcnt vmcnt(14)
    s_barrier
    ds_read_b64_tr_b16 v[216:217], v221 offset:160
    ds_read_b64_tr_b16 v[218:219], v221 offset:4768
    s_waitcnt lgkmcnt(10)
    v_mfma_f32_32x32x16_bf16 v[4:19], v[196:199], v[172:175], v[4:19]
    ds_read_b64_tr_b16 v[196:197], v221 offset:192
    ds_read_b64_tr_b16 v[198:199], v221 offset:4800
    s_waitcnt lgkmcnt(10)
    v_mfma_f32_32x32x16_bf16 v[20:35], v[200:203], v[172:175], v[20:35]
    s_cmp_ge_u32 s36, 2
    s_cbranch_scc1 L_k3_kernel_sk14
    s_add_u32 m0, s44, 37120
    s_nop 0
    buffer_load_dwordx4 v224, s[20:23], s39 offen lds
L_k3_kernel_sk14:
    s_add_u32 m0, s42, 37120
    s_nop 0
    buffer_load_dwordx4 v222, s[12:15], s39 offen lds
    s_waitcnt vmcnt(13)
    v_lshlrev_b32 v236, 16, v180
    v_and_b32 v237, 0xffff0000, v180
    ds_read_b64_tr_b16 v[200:201], v221 offset:224
    ds_read_b64_tr_b16 v[202:203], v221 offset:4832
    s_waitcnt lgkmcnt(10)
    v_mfma_f32_32x32x16_bf16 v[36:51], v[204:207], v[172:175], v[36:51]
    v_lshlrev_b32 v238, 16, v181
    v_and_b32 v239, 0xffff0000, v181
    v_lshlrev_b32 v240, 16, v182
    ds_read_b64_tr_b16 v[204:205], v221 offset:256
    ds_read_b64_tr_b16 v[206:207], v221 offset:4864
    s_waitcnt lgkmcnt(10)
    v_mfma_f32_32x32x16_bf16 v[52:67], v[208:211], v[172:175], v[52:67]
    v_and_b32 v241, 0xffff0000, v182
    v_lshlrev_b32 v242, 16, v183
    v_and_b32 v243, 0xffff0000, v183
    ds_read_b64_tr_b16 v[208:209], v221 offset:2304
    ds_read_b64_tr_b16 v[210:211], v221 offset:6912
    s_waitcnt lgkmcnt(10)
    v_mfma_f32_32x32x16_bf16 v[68:83], v[212:215], v[172:175], v[68:83]
    v_fma_f32 v236, v236, v227, v226
    v_fma_f32 v237, v237, v227, v226
    v_fma_f32 v238, v238, v227, v226
    ds_read_b64_tr_b16 v[212:213], v221 offset:2336
    ds_read_b64_tr_b16 v[214:215], v221 offset:6944
    s_waitcnt lgkmcnt(10)
    v_mfma_f32_32x32x16_bf16 v[84:99], v[216:219], v[172:175], v[84:99]
    s_add_u32 m0, s43, 37120
    s_nop 0
    buffer_load_dwordx4 v223, s[16:19], s39 offen lds
    v_fma_f32 v239, v239, v227, v226
    v_fma_f32 v240, v240, v227, v226
    v_fma_f32 v241, v241, v227, v226
    ds_read_b64_tr_b16 v[216:217], v221 offset:2368
    ds_read_b64_tr_b16 v[218:219], v221 offset:6976
    s_waitcnt lgkmcnt(10)
    v_mfma_f32_32x32x16_bf16 v[100:115], v[196:199], v[172:175], v[100:115]
    v_fma_f32 v242, v242, v227, v226
    v_fma_f32 v243, v243, v227, v226
    v_cvt_pk_bf16_f32 v180, v236, v237
    ds_read_b64_tr_b16 v[196:197], v221 offset:2400
    ds_read_b64_tr_b16 v[198:199], v221 offset:7008
    s_waitcnt lgkmcnt(10)
    v_mfma_f32_32x32x16_bf16 v[116:131], v[200:203], v[172:175], v[116:131]
    v_cvt_pk_bf16_f32 v181, v238, v239
    v_cvt_pk_bf16_f32 v182, v240, v241
    v_cvt_pk_bf16_f32 v183, v242, v243
    ds_read_b64_tr_b16 v[200:201], v221 offset:2432
    ds_read_b64_tr_b16 v[202:203], v221 offset:7040
    s_waitcnt lgkmcnt(10)
    v_mfma_f32_32x32x16_bf16 v[132:147], v[204:207], v[172:175], v[132:147]
    v_lshlrev_b32 v236, 16, v184
    v_and_b32 v237, 0xffff0000, v184
    v_lshlrev_b32 v238, 16, v185
    ds_read_b64_tr_b16 v[204:205], v221 offset:2464
    ds_read_b64_tr_b16 v[206:207], v221 offset:7072
    s_waitcnt lgkmcnt(10)
    v_mfma_f32_32x32x16_bf16 v[4:19], v[208:211], v[176:179], v[4:19]
    buffer_load_dwordx4 v[164:167], v225, s[24:27], s40 offen
    v_and_b32 v239, 0xffff0000, v185
    v_lshlrev_b32 v240, 16, v186
    v_and_b32 v241, 0xffff0000, v186
    ds_read_b64_tr_b16 v[208:209], v221 offset:2496
    ds_read_b64_tr_b16 v[210:211], v221 offset:7104
    s_waitcnt lgkmcnt(10)
    v_mfma_f32_32x32x16_bf16 v[20:35], v[212:215], v[176:179], v[20:35]
    v_lshlrev_b32 v242, 16, v187
    v_and_b32 v243, 0xffff0000, v187
    v_fma_f32 v236, v236, v227, v226
    ds_read_b64_tr_b16 v[212:213], v221 offset:2528
    ds_read_b64_tr_b16 v[214:215], v221 offset:7136
    s_waitcnt lgkmcnt(10)
    v_mfma_f32_32x32x16_bf16 v[36:51], v[216:219], v[176:179], v[36:51]
    v_fma_f32 v237, v237, v227, v226
    v_fma_f32 v238, v238, v227, v226
    v_fma_f32 v239, v239, v227, v226
    ds_read_b64_tr_b16 v[216:217], v221 offset:2560
    ds_read_b64_tr_b16 v[218:219], v221 offset:7168
    s_waitcnt lgkmcnt(10)
    v_mfma_f32_32x32x16_bf16 v[52:67], v[196:199], v[176:179], v[52:67]
    v_fma_f32 v240, v240, v227, v226
    v_fma_f32 v241, v241, v227, v226
    v_fma_f32 v242, v242, v227, v226
    ds_read_b64_tr_b16 v[196:197], v221 offset:18560
    ds_read_b64_tr_b16 v[198:199], v221 offset:23168
    s_waitcnt lgkmcnt(10)
    v_mfma_f32_32x32x16_bf16 v[68:83], v[200:203], v[176:179], v[68:83]
    buffer_load_dwordx4 v[168:171], v225, s[24:27], s40 offen offset:512
    s_add_u32 s56, s56, 1
    s_cmp_eq_u32 s56, 18
    s_cselect_b32 s56, 0, s56
    s_mul_i32 s39, s56, 294912
    s_lshl_b32 s40, s56, 10
    v_fma_f32 v243, v243, v227, v226
    v_cvt_pk_bf16_f32 v184, v236, v237
    v_cvt_pk_bf16_f32 v185, v238, v239
    ds_read_b64_tr_b16 v[200:201], v221 offset:18592
    ds_read_b64_tr_b16 v[202:203], v221 offset:23200
    s_waitcnt lgkmcnt(10)
    v_mfma_f32_32x32x16_bf16 v[84:99], v[204:207], v[176:179], v[84:99]
    v_cvt_pk_bf16_f32 v186, v240, v241
    v_cvt_pk_bf16_f32 v187, v242, v243
    ds_read_b64_tr_b16 v[204:205], v221 offset:18624
    ds_read_b64_tr_b16 v[206:207], v221 offset:23232
    s_waitcnt lgkmcnt(10)
    v_mfma_f32_32x32x16_bf16 v[100:115], v[208:211], v[176:179], v[100:115]
    ds_read_b64_tr_b16 v[208:209], v221 offset:18656
    ds_read_b64_tr_b16 v[210:211], v221 offset:23264
    s_waitcnt lgkmcnt(10)
    v_mfma_f32_32x32x16_bf16 v[116:131], v[212:215], v[176:179], v[116:131]
    ds_read_b64_tr_b16 v[212:213], v221 offset:18688
    ds_read_b64_tr_b16 v[214:215], v221 offset:23296
    s_waitcnt lgkmcnt(10)
    v_mfma_f32_32x32x16_bf16 v[132:147], v[216:219], v[176:179], v[132:147]
    s_waitcnt vmcnt(14)
    s_barrier
    ds_read_b64_tr_b16 v[216:217], v221 offset:18720
    ds_read_b64_tr_b16 v[218:219], v221 offset:23328
    s_waitcnt lgkmcnt(10)
    v_mfma_f32_32x32x16_bf16 v[4:19], v[196:199], v[180:183], v[4:19]
    ds_read_b64_tr_b16 v[196:197], v221 offset:18752
    ds_read_b64_tr_b16 v[198:199], v221 offset:23360
    s_waitcnt lgkmcnt(10)
    v_mfma_f32_32x32x16_bf16 v[20:35], v[200:203], v[180:183], v[20:35]
    s_cmp_ge_u32 s36, 2
    s_cbranch_scc1 L_k3_kernel_sk15
    s_add_u32 m0, s44, 55680
    s_nop 0
    buffer_load_dwordx4 v224, s[20:23], s39 offen lds
L_k3_kernel_sk15:
    s_add_u32 m0, s42, 55680
    s_nop 0
    buffer_load_dwordx4 v222, s[12:15], s39 offen lds
    s_waitcnt vmcnt(13)
    v_lshlrev_b32 v236, 16, v188
    v_and_b32 v237, 0xffff0000, v188
    ds_read_b64_tr_b16 v[200:201], v221 offset:18784
    ds_read_b64_tr_b16 v[202:203], v221 offset:23392
    s_waitcnt lgkmcnt(10)
    v_mfma_f32_32x32x16_bf16 v[36:51], v[204:207], v[180:183], v[36:51]
    v_lshlrev_b32 v238, 16, v189
    v_and_b32 v239, 0xffff0000, v189
    v_lshlrev_b32 v240, 16, v190
    ds_read_b64_tr_b16 v[204:205], v221 offset:18816
    ds_read_b64_tr_b16 v[206:207], v221 offset:23424
    s_waitcnt lgkmcnt(10)
    v_mfma_f32_32x32x16_bf16 v[52:67], v[208:211], v[180:183], v[52:67]
    v_and_b32 v241, 0xffff0000, v190
    v_lshlrev_b32 v242, 16, v191
    v_and_b32 v243, 0xffff0000, v191
    ds_read_b64_tr_b16 v[208:209], v221 offset:20864
    ds_read_b64_tr_b16 v[210:211], v221 offset:25472
    s_waitcnt lgkmcnt(10)
    v_mfma_f32_32x32x16_bf16 v[68:83], v[212:215], v[180:183], v[68:83]
    v_fma_f32 v236, v236, v227, v226
    v_fma_f32 v237, v237, v227, v226
    v_fma_f32 v238, v238, v227, v226
    ds_read_b64_tr_b16 v[212:213], v221 offset:20896
    ds_read_b64_tr_b16 v[214:215], v221 offset:25504
    s_waitcnt lgkmcnt(10)
    v_mfma_f32_32x32x16_bf16 v[84:99], v[216:219], v[180:183], v[84:99]
    s_add_u32 m0, s43, 55680
    s_nop 0
    buffer_load_dwordx4 v223, s[16:19], s39 offen lds
    v_fma_f32 v239, v239, v227, v226
    v_fma_f32 v240, v240, v227, v226
    v_fma_f32 v241, v241, v227, v226
    ds_read_b64_tr_b16 v[216:217], v221 offset:20928
    ds_read_b64_tr_b16 v[218:219], v221 offset:25536
    s_waitcnt lgkmcnt(10)
    v_mfma_f32_32x32x16_bf16 v[100:115], v[196:199], v[180:183], v[100:115]
    v_fma_f32 v242, v242, v227, v226
    v_fma_f32 v243, v243, v227, v226
    v_cvt_pk_bf16_f32 v188, v236, v237
    ds_read_b64_tr_b16 v[196:197], v221 offset:20960
    ds_read_b64_tr_b16 v[198:199], v221 offset:25568
    s_waitcnt lgkmcnt(10)
    v_mfma_f32_32x32x16_bf16 v[116:131], v[200:203], v[180:183], v[116:131]
    v_cvt_pk_bf16_f32 v189, v238, v239
    v_cvt_pk_bf16_f32 v190, v240, v241
    v_cvt_pk_bf16_f32 v191, v242, v243
    ds_read_b64_tr_b16 v[200:201], v221 offset:20992
    ds_read_b64_tr_b16 v[202:203], v221 offset:25600
    s_waitcnt lgkmcnt(10)
    v_mfma_f32_32x32x16_bf16 v[132:147], v[204:207], v[180:183], v[132:147]
    v_lshlrev_b32 v236, 16, v192
    v_and_b32 v237, 0xffff0000, v192
    v_lshlrev_b32 v238, 16, v193
    ds_read_b64_tr_b16 v[204:205], v221 offset:21024
    ds_read_b64_tr_b16 v[206:207], v221 offset:25632
    s_waitcnt lgkmcnt(10)
    v_mfma_f32_32x32x16_bf16 v[4:19], v[208:211], v[184:187], v[4:19]
    buffer_load_dwordx4 v[172:175], v225, s[24:27], s40 offen
    v_and_b32 v239, 0xffff0000, v193
    v_lshlrev_b32 v240, 16, v194
    v_and_b32 v241, 0xffff0000, v194
    ds_read_b64_tr_b16 v[208:209], v221 offset:21056
    ds_read_b64_tr_b16 v[210:211], v221 offset:25664
    s_waitcnt lgkmcnt(10)
    v_mfma_f32_32x32x16_bf16 v[20:35], v[212:215], v[184:187], v[20:35]
    v_lshlrev_b32 v242, 16, v195
    v_and_b32 v243, 0xffff0000, v195
    v_fma_f32 v236, v236, v227, v226
    ds_read_b64_tr_b16 v[212:213], v221 offset:21088
    ds_read_b64_tr_b16 v[214:215], v221 offset:25696
    s_waitcnt lgkmcnt(10)
    v_mfma_f32_32x32x16_bf16 v[36:51], v[216:219], v[184:187], v[36:51]
    v_fma_f32 v237, v237, v227, v226
    v_fma_f32 v238, v238, v227, v226
    v_fma_f32 v239, v239, v227, v226
    ds_read_b64_tr_b16 v[216:217], v221 offset:21120
    ds_read_b64_tr_b16 v[218:219], v221 offset:25728
    s_waitcnt lgkmcnt(10)
    v_mfma_f32_32x32x16_bf16 v[52:67], v[196:199], v[184:187], v[52:67]
    v_fma_f32 v240, v240, v227, v226
    v_fma_f32 v241, v241, v227, v226
    v_fma_f32 v242, v242, v227, v226
    ds_read_b64_tr_b16 v[196:197], v221 offset:37120
    ds_read_b64_tr_b16 v[198:199], v221 offset:41728
    s_waitcnt lgkmcnt(10)
    v_mfma_f32_32x32x16_bf16 v[68:83], v[200:203], v[184:187], v[68:83]
    buffer_load_dwordx4 v[176:179], v225, s[24:27], s40 offen offset:512
    s_add_u32 s56, s56, 1
    s_cmp_eq_u32 s56, 18
    s_cselect_b32 s56, 0, s56
    s_mul_i32 s39, s56, 294912
    s_lshl_b32 s40, s56, 10
    v_fma_f32 v243, v243, v227, v226
    v_cvt_pk_bf16_f32 v192, v236, v237
    v_cvt_pk_bf16_f32 v193, v238, v239
    ds_read_b64_tr_b16 v[200:201], v221 offset:37152
    ds_read_b64_tr_b16 v[202:203], v221 offset:41760
    s_waitcnt lgkmcnt(10)
    v_mfma_f32_32x32x16_bf16 v[84:99], v[204:207], v[184:187], v[84:99]
    v_cvt_pk_bf16_f32 v194, v240, v241
    v_cvt_pk_bf16_f32 v195, v242, v243
    ds_read_b64_tr_b16 v[204:205], v221 offset:37184
    ds_read_b64_tr_b16 v[206:207], v221 offset:41792
    s_waitcnt lgkmcnt(10)
    v_mfma_f32_32x32x16_bf16 v[100:115], v[208:211], v[184:187], v[100:115]
    ds_read_b64_tr_b16 v[208:209], v221 offset:37216
    ds_read_b64_tr_b16 v[210:211], v221 offset:41824
    s_waitcnt lgkmcnt(10)
    v_mfma_f32_32x32x16_bf16 v[116:131], v[212:215], v[184:187], v[116:131]
    ds_read_b64_tr_b16 v[212:213], v221 offset:37248
    ds_read_b64_tr_b16 v[214:215], v221 offset:41856
    s_waitcnt lgkmcnt(10)
    v_mfma_f32_32x32x16_bf16 v[132:147], v[216:219], v[184:187], v[132:147]
    s_waitcnt vmcnt(14)
    s_barrier
    ds_read_b64_tr_b16 v[216:217], v221 offset:37280
    ds_read_b64_tr_b16 v[218:219], v221 offset:41888
    s_waitcnt lgkmcnt(10)
    v_mfma_f32_32x32x16_bf16 v[4:19], v[196:199], v[188:191], v[4:19]
    ds_read_b64_tr_b16 v[196:197], v221 offset:37312
    ds_read_b64_tr_b16 v[198:199], v221 offset:41920
    s_waitcnt lgkmcnt(10)
    v_mfma_f32_32x32x16_bf16 v[20:35], v[200:203], v[188:191], v[20:35]
    s_cmp_ge_u32 s36, 2
    s_cbranch_scc1 L_k3_kernel_sk16
    s_add_u32 m0, s44, 74240
    s_nop 0
    buffer_load_dwordx4 v224, s[20:23], s39 offen lds
L_k3_kernel_sk16:
    s_add_u32 m0, s42, 74240
    s_nop 0
    buffer_load_dwordx4 v222, s[12:15], s39 offen lds
    s_waitcnt vmcnt(13)
    v_lshlrev_b32 v236, 16, v148
    v_and_b32 v237, 0xffff0000, v148
    ds_read_b64_tr_b16 v[200:201], v221 offset:37344
    ds_read_b64_tr_b16 v[202:203], v221 offset:41952
    s_waitcnt lgkmcnt(10)
    v_mfma_f32_32x32x16_bf16 v[36:51], v[204:207], v[188:191], v[36:51]
    v_lshlrev_b32 v238, 16, v149
    v_and_b32 v239, 0xffff0000, v149
    v_lshlrev_b32 v240, 16, v150
    ds_read_b64_tr_b16 v[204:205], v221 offset:37376
    ds_read_b64_tr_b16 v[206:207], v221 offset:41984
    s_waitcnt lgkmcnt(10)
    v_mfma_f32_32x32x16_bf16 v[52:67], v[208:211], v[188:191], v[52:67]
    v_and_b32 v241, 0xffff0000, v150
    v_lshlrev_b32 v242, 16, v151
    v_and_b32 v243, 0xffff0000, v151
    ds_read_b64_tr_b16 v[208:209], v221 offset:39424
    ds_read_b64_tr_b16 v[210:211], v221 offset:44032
    s_waitcnt lgkmcnt(10)
    v_mfma_f32_32x32x16_bf16 v[68:83], v[212:215], v[188:191], v[68:83]
    v_fma_f32 v236, v236, v227, v226
    v_fma_f32 v237, v237, v227, v226
    v_fma_f32 v238, v238, v227, v226
    ds_read_b64_tr_b16 v[212:213], v221 offset:39456
    ds_read_b64_tr_b16 v[214:215], v221 offset:44064
    s_waitcnt lgkmcnt(10)
    v_mfma_f32_32x32x16_bf16 v[84:99], v[216:219], v[188:191], v[84:99]
    s_add_u32 m0, s43, 74240
    s_nop 0
    buffer_load_dwordx4 v223, s[16:19], s39 offen lds
    v_fma_f32 v239, v239, v227, v226
    v_fma_f32 v240, v240, v227, v226
    v_fma_f32 v241, v241, v227, v226
    ds_read_b64_tr_b16 v[216:217], v221 offset:39488
    ds_read_b64_tr_b16 v[218:219], v221 offset:44096
    s_waitcnt lgkmcnt(10)
    v_mfma_f32_32x32x16_bf16 v[100:115], v[196:199], v[188:191], v[100:115]
    v_fma_f32 v242, v242, v227, v226
    v_fma_f32 v243, v243, v227, v226
    v_cvt_pk_bf16_f32 v148, v236, v237
    ds_read_b64_tr_b16 v[196:197], v221 offset:39520
    ds_read_b64_tr_b16 v[198:199], v221 offset:44128
    s_waitcnt lgkmcnt(10)
    v_mfma_f32_32x32x16_bf16 v[116:131], v[200:203], v[188:191], v[116:131]
    v_cvt_pk_bf16_f32 v149, v238, v239
    v_cvt_pk_bf16_f32 v150, v240, v241
    v_cvt_pk_bf16_f32 v151, v242, v243
    ds_read_b64_tr_b16 v[200:201], v221 offset:39552
    ds_read_b64_tr_b16 v[202:203], v221 offset:44160
    s_waitcnt lgkmcnt(10)
    v_mfma_f32_32x32x16_bf16 v[132:147], v[204:207], v[188:191], v[132:147]
    v_lshlrev_b32 v236, 16, v152
    v_and_b32 v237, 0xffff0000, v152
    v_lshlrev_b32 v238, 16, v153
    ds_read_b64_tr_b16 v[204:205], v221 offset:39584
    ds_read_b64_tr_b16 v[206:207], v221 offset:44192
    s_waitcnt lgkmcnt(10)
    v_mfma_f32_32x32x16_bf16 v[4:19], v[208:211], v[192:195], v[4:19]
    buffer_load_dwordx4 v[180:183], v225, s[24:27], s40 offen
    v_and_b32 v239, 0xffff0000, v153
    v_lshlrev_b32 v240, 16, v154
    v_and_b32 v241, 0xffff0000, v154
    ds_read_b64_tr_b16 v[208:209], v221 offset:39616
    ds_read_b64_tr_b16 v[210:211], v221 offset:44224
    s_waitcnt lgkmcnt(10)
    v_mfma_f32_32x32x16_bf16 v[20:35], v[212:215], v[192:195], v[20:35]
    v_lshlrev_b32 v242, 16, v155
    v_and_b32 v243, 0xffff0000, v155
    v_fma_f32 v236, v236, v227, v226
    ds_read_b64_tr_b16 v[212:213], v221 offset:39648
    ds_read_b64_tr_b16 v[214:215], v221 offset:44256
    s_waitcnt lgkmcnt(10)
    v_mfma_f32_32x32x16_bf16 v[36:51], v[216:219], v[192:195], v[36:51]
    v_fma_f32 v237, v237, v227, v226
    v_fma_f32 v238, v238, v227, v226
    v_fma_f32 v239, v239, v227, v226
    ds_read_b64_tr_b16 v[216:217], v221 offset:39680
    ds_read_b64_tr_b16 v[218:219], v221 offset:44288
    s_waitcnt lgkmcnt(10)
    v_mfma_f32_32x32x16_bf16 v[52:67], v[196:199], v[192:195], v[52:67]
    v_fma_f32 v240, v240, v227, v226
    v_fma_f32 v241, v241, v227, v226
    v_fma_f32 v242, v242, v227, v226
    ds_read_b64_tr_b16 v[196:197], v220 offset:0
    ds_read_b64_tr_b16 v[198:199], v220 offset:4608
    s_waitcnt lgkmcnt(10)
    v_mfma_f32_32x32x16_bf16 v[68:83], v[200:203], v[192:195], v[68:83]
    buffer_load_dwordx4 v[184:187], v225, s[24:27], s40 offen offset:512
    s_add_u32 s56, s56, 1
    s_cmp_eq_u32 s56, 18
    s_cselect_b32 s56, 0, s56
    s_mul_i32 s39, s56, 294912
    s_lshl_b32 s40, s56, 10
    v_fma_f32 v243, v243, v227, v226
    v_cvt_pk_bf16_f32 v152, v236, v237
    v_cvt_pk_bf16_f32 v153, v238, v239
    ds_read_b64_tr_b16 v[200:201], v220 offset:32
    ds_read_b64_tr_b16 v[202:203], v220 offset:4640
    s_waitcnt lgkmcnt(10)
    v_mfma_f32_32x32x16_bf16 v[84:99], v[204:207], v[192:195], v[84:99]
    v_cvt_pk_bf16_f32 v154, v240, v241
    v_cvt_pk_bf16_f32 v155, v242, v243
    ds_read_b64_tr_b16 v[204:205], v220 offset:64
    ds_read_b64_tr_b16 v[206:207], v220 offset:4672
    s_waitcnt lgkmcnt(10)
    v_mfma_f32_32x32x16_bf16 v[100:115], v[208:211], v[192:195], v[100:115]
    ds_read_b64_tr_b16 v[208:209], v220 offset:96
    ds_read_b64_tr_b16 v[210:211], v220 offset:4704
    s_waitcnt lgkmcnt(10)
    v_mfma_f32_32x32x16_bf16 v[116:131], v[212:215], v[192:195], v[116:131]
    ds_read_b64_tr_b16 v[212:213], v220 offset:128
    ds_read_b64_tr_b16 v[214:215], v220 offset:4736
    s_waitcnt lgkmcnt(10)
    v_mfma_f32_32x32x16_bf16 v[132:147], v[216:219], v[192:195], v[132:147]
    s_waitcnt vmcnt(14)
    s_barrier
    ds_read_b64_tr_b16 v[216:217], v220 offset:160
    ds_read_b64_tr_b16 v[218:219], v220 offset:4768
    s_waitcnt lgkmcnt(10)
    v_mfma_f32_32x32x16_bf16 v[4:19], v[196:199], v[148:151], v[4:19]
    ds_read_b64_tr_b16 v[196:197], v220 offset:192
    ds_read_b64_tr_b16 v[198:199], v220 offset:4800
    s_waitcnt lgkmcnt(10)
    v_mfma_f32_32x32x16_bf16 v[20:35], v[200:203], v[148:151], v[20:35]
    s_cmp_ge_u32 s36, 2
    s_cbranch_scc1 L_k3_kernel_sk17
    s_add_u32 m0, s44, 92800
    s_nop 0
    buffer_load_dwordx4 v224, s[20:23], s39 offen lds
L_k3_kernel_sk17:
    s_add_u32 m0, s42, 92800
    s_nop 0
    buffer_load_dwordx4 v222, s[12:15], s39 offen lds
    s_waitcnt vmcnt(13)
    v_lshlrev_b32 v236, 16, v156
    v_and_b32 v237, 0xffff0000, v156
    v_lshlrev_b32 v238, 16, v157
    v_and_b32 v239, 0xffff0000, v157
    v_lshlrev_b32 v240, 16, v158
    ds_read_b64_tr_b16 v[200:201], v220 offset:224
    ds_read_b64_tr_b16 v[202:203], v220 offset:4832
    s_waitcnt lgkmcnt(10)
    v_mfma_f32_32x32x16_bf16 v[36:51], v[204:207], v[148:151], v[36:51]
    v_and_b32 v241, 0xffff0000, v158
    v_lshlrev_b32 v242, 16, v159
    v_and_b32 v243, 0xffff0000, v159
    v_fma_f32 v236, v236, v227, v226
    v_fma_f32 v237, v237, v227, v226
    v_fma_f32 v238, v238, v227, v226
    ds_read_b64_tr_b16 v[204:205], v220 offset:256
    ds_read_b64_tr_b16 v[206:207], v220 offset:4864
    s_waitcnt lgkmcnt(10)
    v_mfma_f32_32x32x16_bf16 v[52:67], v[208:211], v[148:151], v[52:67]
    v_fma_f32 v239, v239, v227, v226
    v_fma_f32 v240, v240, v227, v226
    v_fma_f32 v241, v241, v227, v226
    v_fma_f32 v242, v242, v227, v226
    v_fma_f32 v243, v243, v227, v226
    v_cvt_pk_bf16_f32 v156, v236, v237
    ds_read_b64_tr_b16 v[208:209], v220 offset:2304
    ds_read_b64_tr_b16 v[210:211], v220 offset:6912
    s_waitcnt lgkmcnt(10)
    v_mfma_f32_32x32x16_bf16 v[68:83], v[212:215], v[148:151], v[68:83]
    v_cvt_pk_bf16_f32 v157, v238, v239
    v_cvt_pk_bf16_f32 v158, v240, v241
    v_cvt_pk_bf16_f32 v159, v242, v243
    v_lshlrev_b32 v236, 16, v160
    v_and_b32 v237, 0xffff0000, v160
    v_lshlrev_b32 v238, 16, v161
    ds_read_b64_tr_b16 v[212:213], v220 offset:2336
    ds_read_b64_tr_b16 v[214:215], v220 offset:6944
    s_waitcnt lgkmcnt(10)
    v_mfma_f32_32x32x16_bf16 v[84:99], v[216:219], v[148:151], v[84:99]
    s_add_u32 m0, s43, 92800
    s_nop 0
    buffer_load_dwordx4 v223, s[16:19], s39 offen lds
    v_and_b32 v239, 0xffff0000, v161
    v_lshlrev_b32 v240, 16, v162
    v_and_b32 v241, 0xffff0000, v162
    v_lshlrev_b32 v242, 16, v163
    v_and_b32 v243, 0xffff0000, v163
    v_fma_f32 v236, v236, v227, v226
    ds_read_b64_tr_b16 v[216:217], v220 offset:2368
    ds_read_b64_tr_b16 v[218:219], v220 offset:6976
    s_waitcnt lgkmcnt(10)
    v_mfma_f32_32x32x16_bf16 v[100:115], v[196:199], v[148:151], v[100:115]
    v_fma_f32 v237, v237, v227, v226
    v_fma_f32 v238, v238, v227, v226
    v_fma_f32 v239, v239, v227, v226
    v_fma_f32 v240, v240, v227, v226
    v_fma_f32 v241, v241, v227, v226
    v_fma_f32 v242, v242, v227, v226
    ds_read_b64_tr_b16 v[196:197], v220 offset:2400
    ds_read_b64_tr_b16 v[198:199], v220 offset:7008
    s_waitcnt lgkmcnt(10)
    v_mfma_f32_32x32x16_bf16 v[116:131], v[200:203], v[148:151], v[116:131]
    v_fma_f32 v243, v243, v227, v226
    v_cvt_pk_bf16_f32 v160, v236, v237
    v_cvt_pk_bf16_f32 v161, v238, v239
    v_cvt_pk_bf16_f32 v162, v240, v241
    v_cvt_pk_bf16_f32 v163, v242, v243
    s_waitcnt vmcnt(6)
    ds_read_b64_tr_b16 v[200:201], v220 offset:2432
    ds_read_b64_tr_b16 v[202:203], v220 offset:7040
    s_waitcnt lgkmcnt(10)
    v_mfma_f32_32x32x16_bf16 v[132:147], v[204:207], v[148:151], v[132:147]
    v_lshlrev_b32 v236, 16, v172
    v_and_b32 v237, 0xffff0000, v172
    v_lshlrev_b32 v238, 16, v173
    v_and_b32 v239, 0xffff0000, v173
    v_lshlrev_b32 v240, 16, v174
    v_and_b32 v241, 0xffff0000, v174
    ds_read_b64_tr_b16 v[204:205], v220 offset:2464
    ds_read_b64_tr_b16 v[206:207], v220 offset:7072
    s_waitcnt lgkmcnt(10)
    v_mfma_f32_32x32x16_bf16 v[4:19], v[208:211], v[152:155], v[4:19]
    buffer_load_dwordx4 v[188:191], v225, s[24:27], s40 offen
    v_lshlrev_b32 v242, 16, v175
    v_and_b32 v243, 0xffff0000, v175
    v_fma_f32 v236, v236, v227, v226
    v_fma_f32 v237, v237, v227, v226
    v_fma_f32 v238, v238, v227, v226
    v_fma_f32 v239, v239, v227, v226
    ds_read_b64_tr_b16 v[208:209], v220 offset:2496
    ds_read_b64_tr_b16 v[210:211], v220 offset:7104
    s_waitcnt lgkmcnt(10)
    v_mfma_f32_32x32x16_bf16 v[20:35], v[212:215], v[152:155], v[20:35]
    v_fma_f32 v240, v240, v227, v226
    v_fma_f32 v241, v241, v227, v226
    v_fma_f32 v242, v242, v227, v226
    v_fma_f32 v243, v243, v227, v226
    v_cvt_pk_bf16_f32 v172, v236, v237
    v_cvt_pk_bf16_f32 v173, v238, v239
    ds_read_b64_tr_b16 v[212:213], v220 offset:2528
    ds_read_b64_tr_b16 v[214:215], v220 offset:7136
    s_waitcnt lgkmcnt(10)
    v_mfma_f32_32x32x16_bf16 v[36:51], v[216:219], v[152:155], v[36:51]
    v_cvt_pk_bf16_f32 v174, v240, v241
    v_cvt_pk_bf16_f32 v175, v242, v243
    v_lshlrev_b32 v236, 16, v176
    v_and_b32 v237, 0xffff0000, v176
    v_lshlrev_b32 v238, 16, v177
    v_and_b32 v239, 0xffff0000, v177
    ds_read_b64_tr_b16 v[216:217], v220 offset:2560
    ds_read_b64_tr_b16 v[218:219], v220 offset:7168
    s_waitcnt lgkmcnt(10)
    v_mfma_f32_32x32x16_bf16 v[52:67], v[196:199], v[152:155], v[52:67]
    v_lshlrev_b32 v240, 16, v178
    v_and_b32 v241, 0xffff0000, v178
    v_lshlrev_b32 v242, 16, v179
    v_and_b32 v243, 0xffff0000, v179
    v_fma_f32 v236, v236, v227, v226
    v_fma_f32 v237, v237, v227, v226
    ds_read_b64_tr_b16 v[196:197], v220 offset:18560
    ds_read_b64_tr_b16 v[198:199], v220 offset:23168
    s_waitcnt lgkmcnt(10)
    v_mfma_f32_32x32x16_bf16 v[68:83], v[200:203], v[152:155], v[68:83]
    buffer_load_dwordx4 v[192:195], v225, s[24:27], s40 offen offset:512
    s_add_u32 s56, s56, 1
    s_cmp_eq_u32 s56, 18
    s_cselect_b32 s56, 0, s56
    s_mul_i32 s39, s56, 294912
    s_lshl_b32 s40, s56, 10
    v_fma_f32 v238, v238, v227, v226
    v_fma_f32 v239, v239, v227, v226
    v_fma_f32 v240, v240, v227, v226
    v_fma_f32 v241, v241, v227, v226
    v_fma_f32 v242, v242, v227, v226
    v_fma_f32 v243, v243, v227, v226
    ds_read_b64_tr_b16 v[200:201], v220 offset:18592
    ds_read_b64_tr_b16 v[202:203], v220 offset:23200
    s_waitcnt lgkmcnt(10)
    v_mfma_f32_32x32x16_bf16 v[84:99], v[204:207], v[152:155], v[84:99]
    v_cvt_pk_bf16_f32 v176, v236, v237
    v_cvt_pk_bf16_f32 v177, v238, v239
    v_cvt_pk_bf16_f32 v178, v240, v241
    v_cvt_pk_bf16_f32 v179, v242, v243
    ds_read_b64_tr_b16 v[204:205], v220 offset:18624
    ds_read_b64_tr_b16 v[206:207], v220 offset:23232
    s_waitcnt lgkmcnt(10)
    v_mfma_f32_32x32x16_bf16 v[100:115], v[208:211], v[152:155], v[100:115]
    ds_read_b64_tr_b16 v[208:209], v220 offset:18656
    ds_read_b64_tr_b16 v[210:211], v220 offset:23264
    s_waitcnt lgkmcnt(10)
    v_mfma_f32_32x32x16_bf16 v[116:131], v[212:215], v[152:155], v[116:131]
    ds_read_b64_tr_b16 v[212:213], v220 offset:18688
    ds_read_b64_tr_b16 v[214:215], v220 offset:23296
    s_waitcnt lgkmcnt(10)
    v_mfma_f32_32x32x16_bf16 v[132:147], v[216:219], v[152:155], v[132:147]
    s_barrier
    ds_read_b64_tr_b16 v[216:217], v220 offset:18720
    ds_read_b64_tr_b16 v[218:219], v220 offset:23328
    s_waitcnt lgkmcnt(10)
    v_mfma_f32_32x32x16_bf16 v[4:19], v[196:199], v[156:159], v[4:19]
    ds_read_b64_tr_b16 v[196:197], v220 offset:18752
    ds_read_b64_tr_b16 v[198:199], v220 offset:23360
    s_waitcnt lgkmcnt(10)
    v_mfma_f32_32x32x16_bf16 v[20:35], v[200:203], v[156:159], v[20:35]
    v_lshlrev_b32 v236, 16, v164
    v_and_b32 v237, 0xffff0000, v164
    v_lshlrev_b32 v238, 16, v165
    v_and_b32 v239, 0xffff0000, v165
    v_lshlrev_b32 v240, 16, v166
    v_and_b32 v241, 0xffff0000, v166
    v_lshlrev_b32 v242, 16, v167
    ds_read_b64_tr_b16 v[200:201], v220 offset:18784
    ds_read_b64_tr_b16 v[202:203], v220 offset:23392
    s_waitcnt lgkmcnt(10)
    v_mfma_f32_32x32x16_bf16 v[36:51], v[204:207], v[156:159], v[36:51]
    v_and_b32 v243, 0xffff0000, v167
    v_fma_f32 v236, v236, v227, v226
    v_fma_f32 v237, v237, v227, v226
    v_fma_f32 v238, v238, v227, v226
    v_fma_f32 v239, v239, v227, v226
    v_fma_f32 v240, v240, v227, v226
    v_fma_f32 v241, v241, v227, v226
    v_fma_f32 v242, v242, v227, v226
    ds_read_b64_tr_b16 v[204:205], v220 offset:18816
    ds_read_b64_tr_b16 v[206:207], v220 offset:23424
    s_waitcnt lgkmcnt(10)
    v_mfma_f32_32x32x16_bf16 v[52:67], v[208:211], v[156:159], v[52:67]
    v_fma_f32 v243, v243, v227, v226
    v_cvt_pk_bf16_f32 v164, v236, v237
    v_cvt_pk_bf16_f32 v165, v238, v239
    v_cvt_pk_bf16_f32 v166, v240, v241
    v_cvt_pk_bf16_f32 v167, v242, v243
    v_lshlrev_b32 v236, 16, v168
    v_and_b32 v237, 0xffff0000, v168
    v_lshlrev_b32 v238, 16, v169
    ds_read_b64_tr_b16 v[208:209], v220 offset:20864
    ds_read_b64_tr_b16 v[210:211], v220 offset:25472
    s_waitcnt lgkmcnt(10)
    v_mfma_f32_32x32x16_bf16 v[68:83], v[212:215], v[156:159], v[68:83]
    v_and_b32 v239, 0xffff0000, v169
    v_lshlrev_b32 v240, 16, v170
    v_and_b32 v241, 0xffff0000, v170
    v_lshlrev_b32 v242, 16, v171
    v_and_b32 v243, 0xffff0000, v171
    v_fma_f32 v236, v236, v227, v226
    v_fma_f32 v237, v237, v227, v226
    v_fma_f32 v238, v238, v227, v226
    ds_read_b64_tr_b16 v[212:213], v220 offset:20896
    ds_read_b64_tr_b16 v[214:215], v220 offset:25504
    s_waitcnt lgkmcnt(10)
    v_mfma_f32_32x32x16_bf16 v[84:99], v[216:219], v[156:159], v[84:99]
    v_fma_f32 v239, v239, v227, v226
    v_fma_f32 v240, v240, v227, v226
    v_fma_f32 v241, v241, v227, v226
    v_fma_f32 v242, v242, v227, v226
    v_fma_f32 v243, v243, v227, v226
    v_cvt_pk_bf16_f32 v168, v236, v237
    v_cvt_pk_bf16_f32 v169, v238, v239
    v_cvt_pk_bf16_f32 v170, v240, v241
    ds_read_b64_tr_b16 v[216:217], v220 offset:20928
    ds_read_b64_tr_b16 v[218:219], v220 offset:25536
    s_waitcnt lgkmcnt(10)
    v_mfma_f32_32x32x16_bf16 v[100:115], v[196:199], v[156:159], v[100:115]
    v_cvt_pk_bf16_f32 v171, v242, v243
    s_waitcnt vmcnt(4)
    v_lshlrev_b32 v236, 16, v180
    v_and_b32 v237, 0xffff0000, v180
    v_lshlrev_b32 v238, 16, v181
    v_and_b32 v239, 0xffff0000, v181
    v_lshlrev_b32 v240, 16, v182
    v_and_b32 v241, 0xffff0000, v182
    ds_read_b64_tr_b16 v[196:197], v220 offset:20960
    ds_read_b64_tr_b16 v[198:199], v220 offset:25568
    s_waitcnt lgkmcnt(10)
    v_mfma_f32_32x32x16_bf16 v[116:131], v[200:203], v[156:159], v[116:131]
    v_lshlrev_b32 v242, 16, v183
    v_and_b32 v243, 0xffff0000, v183
    v_fma_f32 v236, v236, v227, v226
    v_fma_f32 v237, v237, v227, v226
    v_fma_f32 v238, v238, v227, v226
    v_fma_f32 v239, v239, v227, v226
    v_fma_f32 v240, v240, v227, v226
    v_fma_f32 v241, v241, v227, v226
    ds_read_b64_tr_b16 v[200:201], v220 offset:20992
    ds_read_b64_tr_b16 v[202:203], v220 offset:25600
    s_waitcnt lgkmcnt(10)
    v_mfma_f32_32x32x16_bf16 v[132:147], v[204:207], v[156:159], v[132:147]
    v_fma_f32 v242, v242, v227, v226
    v_fma_f32 v243, v243, v227, v226
    v_cvt_pk_bf16_f32 v180, v236, v237
    v_cvt_pk_bf16_f32 v181, v238, v239
    v_cvt_pk_bf16_f32 v182, v240, v241
    v_cvt_pk_bf16_f32 v183, v242, v243
    v_lshlrev_b32 v236, 16, v184
    v_and_b32 v237, 0xffff0000, v184
    ds_read_b64_tr_b16 v[204:205], v220 offset:21024
    ds_read_b64_tr_b16 v[206:207], v220 offset:25632
    s_waitcnt lgkmcnt(10)
    v_mfma_f32_32x32x16_bf16 v[4:19], v[208:211], v[160:163], v[4:19]
    v_lshlrev_b32 v238, 16, v185
    v_and_b32 v239, 0xffff0000, v185
    v_lshlrev_b32 v240, 16, v186
    v_and_b32 v241, 0xffff0000, v186
    v_lshlrev_b32 v242, 16, v187
    v_and_b32 v243, 0xffff0000, v187
    v_fma_f32 v236, v236, v227, v226
    v_fma_f32 v237, v237, v227, v226
    ds_read_b64_tr_b16 v[208:209], v220 offset:21056
    ds_read_b64_tr_b16 v[210:211], v220 offset:25664
    s_waitcnt lgkmcnt(10)
    v_mfma_f32_32x32x16_bf16 v[20:35], v[212:215], v[160:163], v[20:35]
    v_fma_f32 v238, v238, v227, v226
    v_fma_f32 v239, v239, v227, v226
    v_fma_f32 v240, v240, v227, v226
    v_fma_f32 v241, v241, v227, v226
    v_fma_f32 v242, v242, v227, v226
    v_fma_f32 v243, v243, v227, v226
    v_cvt_pk_bf16_f32 v184, v236, v237
    v_cvt_pk_bf16_f32 v185, v238, v239
    ds_read_b64_tr_b16 v[212:213], v220 offset:21088
    ds_read_b64_tr_b16 v[214:215], v220 offset:25696
    s_waitcnt lgkmcnt(10)
    v_mfma_f32_32x32x16_bf16 v[36:51], v[216:219], v[160:163], v[36:51]
    v_cvt_pk_bf16_f32 v186, v240, v241
    v_cvt_pk_bf16_f32 v187, v242, v243
    s_waitcnt vmcnt(0)
    v_lshlrev_b32 v236, 16, v188
    v_and_b32 v237, 0xffff0000, v188
    v_lshlrev_b32 v238, 16, v189
    v_and_b32 v239, 0xffff0000, v189
    v_lshlrev_b32 v240, 16, v190
    ds_read_b64_tr_b16 v[216:217], v220 offset:21120
    ds_read_b64_tr_b16 v[218:219], v220 offset:25728
    s_waitcnt lgkmcnt(10)
    v_mfma_f32_32x32x16_bf16 v[52:67], v[196:199], v[160:163], v[52:67]
    v_and_b32 v241, 0xffff0000, v190
    v_lshlrev_b32 v242, 16, v191
    v_and_b32 v243, 0xffff0000, v191
    v_fma_f32 v236, v236, v227, v226
    v_fma_f32 v237, v237, v227, v226
    v_fma_f32 v238, v238, v227, v226
    v_fma_f32 v239, v239, v227, v226
    v_fma_f32 v240, v240, v227, v226
    s_barrier
    ds_read_b64_tr_b16 v[196:197], v220 offset:37120
    ds_read_b64_tr_b16 v[198:199], v220 offset:41728
    s_waitcnt lgkmcnt(10)
    v_mfma_f32_32x32x16_bf16 v[68:83], v[200:203], v[160:163], v[68:83]
    v_fma_f32 v241, v241, v227, v226
    v_fma_f32 v242, v242, v227, v226
    v_fma_f32 v243, v243, v227, v226
    v_cvt_pk_bf16_f32 v188, v236, v237
    v_cvt_pk_bf16_f32 v189, v238, v239
    v_cvt_pk_bf16_f32 v190, v240, v241
    v_cvt_pk_bf16_f32 v191, v242, v243
    v_lshlrev_b32 v236, 16, v192
    ds_read_b64_tr_b16 v[200:201], v220 offset:39424
    ds_read_b64_tr_b16 v[202:203], v220 offset:44032
    s_waitcnt lgkmcnt(10)
    v_mfma_f32_32x32x16_bf16 v[84:99], v[204:207], v[160:163], v[84:99]
    v_and_b32 v237, 0xffff0000, v192
    v_lshlrev_b32 v238, 16, v193
    v_and_b32 v239, 0xffff0000, v193
    v_lshlrev_b32 v240, 16, v194
    v_and_b32 v241, 0xffff0000, v194
    v_lshlrev_b32 v242, 16, v195
    v_and_b32 v243, 0xffff0000, v195
    v_fma_f32 v236, v236, v227, v226
    ds_read_b64_tr_b16 v[204:205], v221 offset:0
    ds_read_b64_tr_b16 v[206:207], v221 offset:4608
    s_waitcnt lgkmcnt(10)
    v_mfma_f32_32x32x16_bf16 v[100:115], v[208:211], v[160:163], v[100:115]
    v_fma_f32 v237, v237, v227, v226
    v_fma_f32 v238, v238, v227, v226
    v_fma_f32 v239, v239, v227, v226
    v_fma_f32 v240, v240, v227, v226
    v_fma_f32 v241, v241, v227, v226
    v_fma_f32 v242, v242, v227, v226
    v_fma_f32 v243, v243, v227, v226
    v_cvt_pk_bf16_f32 v192, v236, v237
    ds_read_b64_tr_b16 v[208:209], v221 offset:2304
    ds_read_b64_tr_b16 v[210:211], v221 offset:6912
    s_waitcnt lgkmcnt(10)
    v_mfma_f32_32x32x16_bf16 v[116:131], v[212:215], v[160:163], v[116:131]
    v_cvt_pk_bf16_f32 v193, v238, v239
    v_cvt_pk_bf16_f32 v194, v240, v241
    v_cvt_pk_bf16_f32 v195, v242, v243
    ds_read_b64_tr_b16 v[212:213], v221 offset:18560
    ds_read_b64_tr_b16 v[214:215], v221 offset:23168
    s_waitcnt lgkmcnt(10)
    v_mfma_f32_32x32x16_bf16 v[132:147], v[216:219], v[160:163], v[132:147]
    ds_read_b64_tr_b16 v[216:217], v221 offset:20864
    ds_read_b64_tr_b16 v[218:219], v221 offset:25472
    s_waitcnt lgkmcnt(10)
    v_mfma_f32_32x32x16_bf16 v[4:19], v[196:199], v[164:167], v[4:19]
    ds_read_b64_tr_b16 v[196:197], v221 offset:37120
    ds_read_b64_tr_b16 v[198:199], v221 offset:41728
    s_waitcnt lgkmcnt(10)
    v_mfma_f32_32x32x16_bf16 v[4:19], v[200:203], v[168:171], v[4:19]
    ds_read_b64_tr_b16 v[200:201], v221 offset:39424
    ds_read_b64_tr_b16 v[202:203], v221 offset:44032
    s_waitcnt lgkmcnt(10)
    v_mfma_f32_32x32x16_bf16 v[4:19], v[204:207], v[172:175], v[4:19]
    ds_read_b64_tr_b16 v[204:205], v220 offset:37152
    ds_read_b64_tr_b16 v[206:207], v220 offset:41760
    s_waitcnt lgkmcnt(10)
    v_mfma_f32_32x32x16_bf16 v[4:19], v[208:211], v[176:179], v[4:19]
    ds_read_b64_tr_b16 v[208:209], v220 offset:39456
    ds_read_b64_tr_b16 v[210:211], v220 offset:44064
    s_waitcnt lgkmcnt(10)
    v_mfma_f32_32x32x16_bf16 v[4:19], v[212:215], v[180:183], v[4:19]
    ds_read_b64_tr_b16 v[212:213], v221 offset:32
    ds_read_b64_tr_b16 v[214:215], v221 offset:4640
    s_waitcnt lgkmcnt(10)
    v_mfma_f32_32x32x16_bf16 v[4:19], v[216:219], v[184:187], v[4:19]
    ds_read_b64_tr_b16 v[216:217], v221 offset:2336
    ds_read_b64_tr_b16 v[218:219], v221 offset:6944
    s_waitcnt lgkmcnt(10)
    v_mfma_f32_32x32x16_bf16 v[4:19], v[196:199], v[188:191], v[4:19]
    ds_read_b64_tr_b16 v[196:197], v221 offset:18592
    ds_read_b64_tr_b16 v[198:199], v221 offset:23200
    s_waitcnt lgkmcnt(10)
    v_mfma_f32_32x32x16_bf16 v[4:19], v[200:203], v[192:195], v[4:19]
    ds_read_b64_tr_b16 v[200:201], v221 offset:20896
    ds_read_b64_tr_b16 v[202:203], v221 offset:25504
    s_waitcnt lgkmcnt(10)
    v_mfma_f32_32x32x16_bf16 v[20:35], v[204:207], v[164:167], v[20:35]
    ds_read_b64_tr_b16 v[204:205], v221 offset:37152
    ds_read_b64_tr_b16 v[206:207], v221 offset:41760
    s_waitcnt lgkmcnt(10)
    v_mfma_f32_32x32x16_bf16 v[20:35], v[208:211], v[168:171], v[20:35]
    ds_read_b64_tr_b16 v[208:209], v221 offset:39456
    ds_read_b64_tr_b16 v[210:211], v221 offset:44064
    s_waitcnt lgkmcnt(10)
    v_mfma_f32_32x32x16_bf16 v[20:35], v[212:215], v[172:175], v[20:35]
    v_mul_f32 v232, v4, v4
    v_mul_f32 v233, v5, v5
    v_mul_f32 v234, v6, v6
    v_mul_f32 v235, v7, v7
    v_fma_f32 v232, v232, s89, v244
    v_fma_f32 v233, v233, s89, v244
    v_fma_f32 v234, v234, s89, v244
    v_fma_f32 v235, v235, s89, v244
    v_mul_f32 v232, v232, v4
    v_mul_f32 v233, v233, v5
    v_mul_f32 v234, v234, v6
    v_mul_f32 v235, v235, v7
    ds_read_b64_tr_b16 v[212:213], v220 offset:37184
    ds_read_b64_tr_b16 v[214:215], v220 offset:41792
    s_waitcnt lgkmcnt(10)
    v_mfma_f32_32x32x16_bf16 v[20:35], v[216:219], v[176:179], v[20:35]
    v_exp_f32 v232, v232
    v_exp_f32 v233, v233
    v_exp_f32 v234, v234
    v_exp_f32 v235, v235
    v_mul_f32 v12, v12, v4
    v_mul_f32 v13, v13, v5
    v_mul_f32 v14, v14, v6
    v_mul_f32 v15, v15, v7
    v_add_f32 v232, 1.0, v232
    v_add_f32 v233, 1.0, v233
    v_add_f32 v234, 1.0, v234
    v_add_f32 v235, 1.0, v235
    ds_read_b64_tr_b16 v[216:217], v220 offset:39488
    ds_read_b64_tr_b16 v[218:219], v220 offset:44096
    s_waitcnt lgkmcnt(10)
    v_mfma_f32_32x32x16_bf16 v[20:35], v[196:199], v[180:183], v[20:35]
    v_rcp_f32 v232, v232
    v_rcp_f32 v233, v233
    v_rcp_f32 v234, v234
    v_rcp_f32 v235, v235
    v_mul_f32 v232, v232, v12
    v_mul_f32 v233, v233, v13
    v_mul_f32 v234, v234, v14
    v_mul_f32 v235, v235, v15
    v_cvt_pk_bf16_f32 v246, v232, v233
    v_cvt_pk_bf16_f32 v247, v234, v235
    v_mul_f32 v232, v8, v8
    v_mul_f32 v233, v9, v9
    ds_read_b64_tr_b16 v[196:197], v221 offset:64
    ds_read_b64_tr_b16 v[198:199], v221 offset:4672
    s_waitcnt lgkmcnt(10)
    v_mfma_f32_32x32x16_bf16 v[20:35], v[200:203], v[184:187], v[20:35]
    v_mul_f32 v234, v10, v10
    v_mul_f32 v235, v11, v11
    v_fma_f32 v232, v232, s89, v244
    v_fma_f32 v233, v233, s89, v244
    v_fma_f32 v234, v234, s89, v244
    v_fma_f32 v235, v235, s89, v244
    v_mul_f32 v232, v232, v8
    v_mul_f32 v233, v233, v9
    v_mul_f32 v234, v234, v10
    v_mul_f32 v235, v235, v11
    v_exp_f32 v232, v232
    v_exp_f32 v233, v233
    ds_read_b64_tr_b16 v[200:201], v221 offset:2368
    ds_read_b64_tr_b16 v[202:203], v221 offset:6976
    s_waitcnt lgkmcnt(10)
    v_mfma_f32_32x32x16_bf16 v[20:35], v[204:207], v[188:191], v[20:35]
    v_exp_f32 v234, v234
    v_exp_f32 v235, v235
    v_mul_f32 v16, v16, v8
    v_mul_f32 v17, v17, v9
    v_mul_f32 v18, v18, v10
    v_mul_f32 v19, v19, v11
    v_add_f32 v232, 1.0, v232
    v_add_f32 v233, 1.0, v233
    v_add_f32 v234, 1.0, v234
    v_add_f32 v235, 1.0, v235
    v_rcp_f32 v232, v232
    v_rcp_f32 v233, v233
    ds_read_b64_tr_b16 v[204:205], v221 offset:18624
    ds_read_b64_tr_b16 v[206:207], v221 offset:23232
    s_waitcnt lgkmcnt(10)
    v_mfma_f32_32x32x16_bf16 v[20:35], v[208:211], v[192:195], v[20:35]
    v_rcp_f32 v234, v234
    v_rcp_f32 v235, v235
    v_mul_f32 v232, v232, v16
    v_mul_f32 v233, v233, v17
    v_mul_f32 v234, v234, v18
    v_mul_f32 v235, v235, v19
    v_cvt_pk_bf16_f32 v248, v232, v233
    v_cvt_pk_bf16_f32 v249, v234, v235
    buffer_store_dwordx4 v[246:249], v245, s[32:35], s90 offen offset:0 sc1
    ds_read_b64_tr_b16 v[208:209], v221 offset:20928
    ds_read_b64_tr_b16 v[210:211], v221 offset:25536
    s_waitcnt lgkmcnt(10)
    v_mfma_f32_32x32x16_bf16 v[36:51], v[212:215], v[164:167], v[36:51]
    ds_read_b64_tr_b16 v[212:213], v221 offset:37184
    ds_read_b64_tr_b16 v[214:215], v221 offset:41792
    s_waitcnt lgkmcnt(10)
    v_mfma_f32_32x32x16_bf16 v[36:51], v[216:219], v[168:171], v[36:51]
    ds_read_b64_tr_b16 v[216:217], v221 offset:39488
    ds_read_b64_tr_b16 v[218:219], v221 offset:44096
    s_waitcnt lgkmcnt(10)
    v_mfma_f32_32x32x16_bf16 v[36:51], v[196:199], v[172:175], v[36:51]
    v_mul_f32 v232, v20, v20
    v_mul_f32 v233, v21, v21
    v_mul_f32 v234, v22, v22
    v_mul_f32 v235, v23, v23
    v_fma_f32 v232, v232, s89, v244
    v_fma_f32 v233, v233, s89, v244
    v_fma_f32 v234, v234, s89, v244
    v_fma_f32 v235, v235, s89, v244
    v_mul_f32 v232, v232, v20
    v_mul_f32 v233, v233, v21
    v_mul_f32 v234, v234, v22
    v_mul_f32 v235, v235, v23
    ds_read_b64_tr_b16 v[196:197], v220 offset:37216
    ds_read_b64_tr_b16 v[198:199], v220 offset:41824
    s_waitcnt lgkmcnt(10)
    v_mfma_f32_32x32x16_bf16 v[36:51], v[200:203], v[176:179], v[36:51]
    v_exp_f32 v232, v232
    v_exp_f32 v233, v233
    v_exp_f32 v234, v234
    v_exp_f32 v235, v235
    v_mul_f32 v28, v28, v20
    v_mul_f32 v29, v29, v21
    v_mul_f32 v30, v30, v22
    v_mul_f32 v31, v31, v23
    v_add_f32 v232, 1.0, v232
    v_add_f32 v233, 1.0, v233
    v_add_f32 v234, 1.0, v234
    v_add_f32 v235, 1.0, v235
    ds_read_b64_tr_b16 v[200:201], v220 offset:39520
    ds_read_b64_tr_b16 v[202:203], v220 offset:44128
    s_waitcnt lgkmcnt(10)
    v_mfma_f32_32x32x16_bf16 v[36:51], v[204:207], v[180:183], v[36:51]
    v_rcp_f32 v232, v232
    v_rcp_f32 v233, v233
    v_rcp_f32 v234, v234
    v_rcp_f32 v235, v235
    v_mul_f32 v232, v232, v28
    v_mul_f32 v233, v233, v29
    v_mul_f32 v234, v234, v30
    v_mul_f32 v235, v235, v31
    v_cvt_pk_bf16_f32 v250, v232, v233
    v_cvt_pk_bf16_f32 v251, v234, v235
    v_mul_f32 v232, v24, v24
    v_mul_f32 v233, v25, v25
    ds_read_b64_tr_b16 v[204:205], v221 offset:96
    ds_read_b64_tr_b16 v[206:207], v221 offset:4704
    s_waitcnt lgkmcnt(10)
    v_mfma_f32_32x32x16_bf16 v[36:51], v[208:211], v[184:187], v[36:51]
    v_mul_f32 v234, v26, v26
    v_mul_f32 v235, v27, v27
    v_fma_f32 v232, v232, s89, v244
    v_fma_f32 v233, v233, s89, v244
    v_fma_f32 v234, v234, s89, v244
    v_fma_f32 v235, v235, s89, v244
    v_mul_f32 v232, v232, v24
    v_mul_f32 v233, v233, v25
    v_mul_f32 v234, v234, v26
    v_mul_f32 v235, v235, v27
    v_exp_f32 v232, v232
    v_exp_f32 v233, v233
    ds_read_b64_tr_b16 v[208:209], v221 offset:2400
    ds_read_b64_tr_b16 v[210:211], v221 offset:7008
    s_waitcnt lgkmcnt(10)
    v_mfma_f32_32x32x16_bf16 v[36:51], v[212:215], v[188:191], v[36:51]
    v_exp_f32 v234, v234
    v_exp_f32 v235, v235
    v_mul_f32 v32, v32, v24
    v_mul_f32 v33, v33, v25
    v_mul_f32 v34, v34, v26
    v_mul_f32 v35, v35, v27
    v_add_f32 v232, 1.0, v232
    v_add_f32 v233, 1.0, v233
    v_add_f32 v234, 1.0, v234
    v_add_f32 v235, 1.0, v235
    v_rcp_f32 v232, v232
    v_rcp_f32 v233, v233
    ds_read_b64_tr_b16 v[212:213], v221 offset:18656
    ds_read_b64_tr_b16 v[214:215], v221 offset:23264
    s_waitcnt lgkmcnt(10)
    v_mfma_f32_32x32x16_bf16 v[36:51], v[216:219], v[192:195], v[36:51]
    v_rcp_f32 v234, v234
    v_rcp_f32 v235, v235
    v_mul_f32 v232, v232, v32
    v_mul_f32 v233, v233, v33
    v_mul_f32 v234, v234, v34
    v_mul_f32 v235, v235, v35
    v_cvt_pk_bf16_f32 v252, v232, v233
    v_cvt_pk_bf16_f32 v253, v234, v235
    buffer_store_dwordx4 v[250:253], v245, s[32:35], s90 offen offset:512 sc1
    ds_read_b64_tr_b16 v[216:217], v221 offset:20960
    ds_read_b64_tr_b16 v[218:219], v221 offset:25568
    s_waitcnt lgkmcnt(10)
    v_mfma_f32_32x32x16_bf16 v[52:67], v[196:199], v[164:167], v[52:67]
    ds_read_b64_tr_b16 v[196:197], v221 offset:37216
    ds_read_b64_tr_b16 v[198:199], v221 offset:41824
    s_waitcnt lgkmcnt(10)
    v_mfma_f32_32x32x16_bf16 v[52:67], v[200:203], v[168:171], v[52:67]
    ds_read_b64_tr_b16 v[200:201], v221 offset:39520
    ds_read_b64_tr_b16 v[202:203], v221 offset:44128
    s_waitcnt lgkmcnt(10)
    v_mfma_f32_32x32x16_bf16 v[52:67], v[204:207], v[172:175], v[52:67]
    v_mul_f32 v232, v36, v36
    v_mul_f32 v233, v37, v37
    v_mul_f32 v234, v38, v38
    v_mul_f32 v235, v39, v39
    v_fma_f32 v232, v232, s89, v244
    v_fma_f32 v233, v233, s89, v244
    v_fma_f32 v234, v234, s89, v244
    v_fma_f32 v235, v235, s89, v244
    v_mul_f32 v232, v232, v36
    v_mul_f32 v233, v233, v37
    v_mul_f32 v234, v234, v38
    v_mul_f32 v235, v235, v39
    ds_read_b64_tr_b16 v[204:205], v220 offset:37248
    ds_read_b64_tr_b16 v[206:207], v220 offset:41856
    s_waitcnt lgkmcnt(10)
    v_mfma_f32_32x32x16_bf16 v[52:67], v[208:211], v[176:179], v[52:67]
    v_exp_f32 v232, v232
    v_exp_f32 v233, v233
    v_exp_f32 v234, v234
    v_exp_f32 v235, v235
    v_mul_f32 v44, v44, v36
    v_mul_f32 v45, v45, v37
    v_mul_f32 v46, v46, v38
    v_mul_f32 v47, v47, v39
    v_add_f32 v232, 1.0, v232
    v_add_f32 v233, 1.0, v233
    v_add_f32 v234, 1.0, v234
    v_add_f32 v235, 1.0, v235
    ds_read_b64_tr_b16 v[208:209], v220 offset:39552
    ds_read_b64_tr_b16 v[210:211], v220 offset:44160
    s_waitcnt lgkmcnt(10)
    v_mfma_f32_32x32x16_bf16 v[52:67], v[212:215], v[180:183], v[52:67]
    v_rcp_f32 v232, v232
    v_rcp_f32 v233, v233
    v_rcp_f32 v234, v234
    v_rcp_f32 v235, v235
    v_mul_f32 v232, v232, v44
    v_mul_f32 v233, v233, v45
    v_mul_f32 v234, v234, v46
    v_mul_f32 v235, v235, v47
    v_cvt_pk_bf16_f32 v246, v232, v233
    v_cvt_pk_bf16_f32 v247, v234, v235
    v_mul_f32 v232, v40, v40
    v_mul_f32 v233, v41, v41
    ds_read_b64_tr_b16 v[212:213], v221 offset:128
    ds_read_b64_tr_b16 v[214:215], v221 offset:4736
    s_waitcnt lgkmcnt(10)
    v_mfma_f32_32x32x16_bf16 v[52:67], v[216:219], v[184:187], v[52:67]
    v_mul_f32 v234, v42, v42
    v_mul_f32 v235, v43, v43
    v_fma_f32 v232, v232, s89, v244
    v_fma_f32 v233, v233, s89, v244
    v_fma_f32 v234, v234, s89, v244
    v_fma_f32 v235, v235, s89, v244
    v_mul_f32 v232, v232, v40
    v_mul_f32 v233, v233, v41
    v_mul_f32 v234, v234, v42
    v_mul_f32 v235, v235, v43
    v_exp_f32 v232, v232
    v_exp_f32 v233, v233
    ds_read_b64_tr_b16 v[216:217], v221 offset:2432
    ds_read_b64_tr_b16 v[218:219], v221 offset:7040
    s_waitcnt lgkmcnt(10)
    v_mfma_f32_32x32x16_bf16 v[52:67], v[196:199], v[188:191], v[52:67]
    v_exp_f32 v234, v234
    v_exp_f32 v235, v235
    v_mul_f32 v48, v48, v40
    v_mul_f32 v49, v49, v41
    v_mul_f32 v50, v50, v42
    v_mul_f32 v51, v51, v43
    v_add_f32 v232, 1.0, v232
    v_add_f32 v233, 1.0, v233
    v_add_f32 v234, 1.0, v234
    v_add_f32 v235, 1.0, v235
    v_rcp_f32 v232, v232
    v_rcp_f32 v233, v233
    ds_read_b64_tr_b16 v[196:197], v221 offset:18688
    ds_read_b64_tr_b16 v[198:199], v221 offset:23296
    s_waitcnt lgkmcnt(10)
    v_mfma_f32_32x32x16_bf16 v[52:67], v[200:203], v[192:195], v[52:67]
    v_rcp_f32 v234, v234
    v_rcp_f32 v235, v235
    v_mul_f32 v232, v232, v48
    v_mul_f32 v233, v233, v49
    v_mul_f32 v234, v234, v50
    v_mul_f32 v235, v235, v51
    v_cvt_pk_bf16_f32 v248, v232, v233
    v_cvt_pk_bf16_f32 v249, v234, v235
    buffer_store_dwordx4 v[246:249], v245, s[32:35], s90 offen offset:1024 sc1
    ds_read_b64_tr_b16 v[200:201], v221 offset:20992
    ds_read_b64_tr_b16 v[202:203], v221 offset:25600
    s_waitcnt lgkmcnt(10)
    v_mfma_f32_32x32x16_bf16 v[68:83], v[204:207], v[164:167], v[68:83]
    ds_read_b64_tr_b16 v[204:205], v221 offset:37248
    ds_read_b64_tr_b16 v[206:207], v221 offset:41856
    s_waitcnt lgkmcnt(10)
    v_mfma_f32_32x32x16_bf16 v[68:83], v[208:211], v[168:171], v[68:83]
    ds_read_b64_tr_b16 v[208:209], v221 offset:39552
    ds_read_b64_tr_b16 v[210:211], v221 offset:44160
    s_waitcnt lgkmcnt(10)
    v_mfma_f32_32x32x16_bf16 v[68:83], v[212:215], v[172:175], v[68:83]
    v_mul_f32 v232, v52, v52
    v_mul_f32 v233, v53, v53
    v_mul_f32 v234, v54, v54
    v_mul_f32 v235, v55, v55
    v_fma_f32 v232, v232, s89, v244
    v_fma_f32 v233, v233, s89, v244
    v_fma_f32 v234, v234, s89, v244
    v_fma_f32 v235, v235, s89, v244
    v_mul_f32 v232, v232, v52
    v_mul_f32 v233, v233, v53
    v_mul_f32 v234, v234, v54
    v_mul_f32 v235, v235, v55
    ds_read_b64_tr_b16 v[212:213], v220 offset:37280
    ds_read_b64_tr_b16 v[214:215], v220 offset:41888
    s_waitcnt lgkmcnt(10)
    v_mfma_f32_32x32x16_bf16 v[68:83], v[216:219], v[176:179], v[68:83]
    v_exp_f32 v232, v232
    v_exp_f32 v233, v233
    v_exp_f32 v234, v234
    v_exp_f32 v235, v235
    v_mul_f32 v60, v60, v52
    v_mul_f32 v61, v61, v53
    v_mul_f32 v62, v62, v54
    v_mul_f32 v63, v63, v55
    v_add_f32 v232, 1.0, v232
    v_add_f32 v233, 1.0, v233
    v_add_f32 v234, 1.0, v234
    v_add_f32 v235, 1.0, v235
    ds_read_b64_tr_b16 v[216:217], v220 offset:39584
    ds_read_b64_tr_b16 v[218:219], v220 offset:44192
    s_waitcnt lgkmcnt(10)
    v_mfma_f32_32x32x16_bf16 v[68:83], v[196:199], v[180:183], v[68:83]
    v_rcp_f32 v232, v232
    v_rcp_f32 v233, v233
    v_rcp_f32 v234, v234
    v_rcp_f32 v235, v235
    v_mul_f32 v232, v232, v60
    v_mul_f32 v233, v233, v61
    v_mul_f32 v234, v234, v62
    v_mul_f32 v235, v235, v63
    v_cvt_pk_bf16_f32 v250, v232, v233
    v_cvt_pk_bf16_f32 v251, v234, v235
    v_mul_f32 v232, v56, v56
    v_mul_f32 v233, v57, v57
    ds_read_b64_tr_b16 v[196:197], v221 offset:160
    ds_read_b64_tr_b16 v[198:199], v221 offset:4768
    s_waitcnt lgkmcnt(10)
    v_mfma_f32_32x32x16_bf16 v[68:83], v[200:203], v[184:187], v[68:83]
    v_mul_f32 v234, v58, v58
    v_mul_f32 v235, v59, v59
    v_fma_f32 v232, v232, s89, v244
    v_fma_f32 v233, v233, s89, v244
    v_fma_f32 v234, v234, s89, v244
    v_fma_f32 v235, v235, s89, v244
    v_mul_f32 v232, v232, v56
    v_mul_f32 v233, v233, v57
    v_mul_f32 v234, v234, v58
    v_mul_f32 v235, v235, v59
    v_exp_f32 v232, v232
    v_exp_f32 v233, v233
    ds_read_b64_tr_b16 v[200:201], v221 offset:2464
    ds_read_b64_tr_b16 v[202:203], v221 offset:7072
    s_waitcnt lgkmcnt(10)
    v_mfma_f32_32x32x16_bf16 v[68:83], v[204:207], v[188:191], v[68:83]
    v_exp_f32 v234, v234
    v_exp_f32 v235, v235
    v_mul_f32 v64, v64, v56
    v_mul_f32 v65, v65, v57
    v_mul_f32 v66, v66, v58
    v_mul_f32 v67, v67, v59
    v_add_f32 v232, 1.0, v232
    v_add_f32 v233, 1.0, v233
    v_add_f32 v234, 1.0, v234
    v_add_f32 v235, 1.0, v235
    v_rcp_f32 v232, v232
    v_rcp_f32 v233, v233
    ds_read_b64_tr_b16 v[204:205], v221 offset:18720
    ds_read_b64_tr_b16 v[206:207], v221 offset:23328
    s_waitcnt lgkmcnt(10)
    v_mfma_f32_32x32x16_bf16 v[68:83], v[208:211], v[192:195], v[68:83]
    v_rcp_f32 v234, v234
    v_rcp_f32 v235, v235
    v_mul_f32 v232, v232, v64
    v_mul_f32 v233, v233, v65
    v_mul_f32 v234, v234, v66
    v_mul_f32 v235, v235, v67
    v_cvt_pk_bf16_f32 v252, v232, v233
    v_cvt_pk_bf16_f32 v253, v234, v235
    buffer_store_dwordx4 v[250:253], v245, s[32:35], s90 offen offset:1536 sc1
    ds_read_b64_tr_b16 v[208:209], v221 offset:21024
    ds_read_b64_tr_b16 v[210:211], v221 offset:25632
    s_waitcnt lgkmcnt(10)
    v_mfma_f32_32x32x16_bf16 v[84:99], v[212:215], v[164:167], v[84:99]
    ds_read_b64_tr_b16 v[212:213], v221 offset:37280
    ds_read_b64_tr_b16 v[214:215], v221 offset:41888
    s_waitcnt lgkmcnt(10)
    v_mfma_f32_32x32x16_bf16 v[84:99], v[216:219], v[168:171], v[84:99]
    ds_read_b64_tr_b16 v[216:217], v221 offset:39584
    ds_read_b64_tr_b16 v[218:219], v221 offset:44192
    s_waitcnt lgkmcnt(10)
    v_mfma_f32_32x32x16_bf16 v[84:99], v[196:199], v[172:175], v[84:99]
    v_mul_f32 v232, v68, v68
    v_mul_f32 v233, v69, v69
    v_mul_f32 v234, v70, v70
    v_mul_f32 v235, v71, v71
    v_fma_f32 v232, v232, s89, v244
    v_fma_f32 v233, v233, s89, v244
    v_fma_f32 v234, v234, s89, v244
    v_fma_f32 v235, v235, s89, v244
    v_mul_f32 v232, v232, v68
    v_mul_f32 v233, v233, v69
    v_mul_f32 v234, v234, v70
    v_mul_f32 v235, v235, v71
    ds_read_b64_tr_b16 v[196:197], v220 offset:37312
    ds_read_b64_tr_b16 v[198:199], v220 offset:41920
    s_waitcnt lgkmcnt(10)
    v_mfma_f32_32x32x16_bf16 v[84:99], v[200:203], v[176:179], v[84:99]
    v_exp_f32 v232, v232
    v_exp_f32 v233, v233
    v_exp_f32 v234, v234
    v_exp_f32 v235, v235
    v_mul_f32 v76, v76, v68
    v_mul_f32 v77, v77, v69
    v_mul_f32 v78, v78, v70
    v_mul_f32 v79, v79, v71
    v_add_f32 v232, 1.0, v232
    v_add_f32 v233, 1.0, v233
    v_add_f32 v234, 1.0, v234
    v_add_f32 v235, 1.0, v235
    ds_read_b64_tr_b16 v[200:201], v220 offset:39616
    ds_read_b64_tr_b16 v[202:203], v220 offset:44224
    s_waitcnt lgkmcnt(10)
    v_mfma_f32_32x32x16_bf16 v[84:99], v[204:207], v[180:183], v[84:99]
    v_rcp_f32 v232, v232
    v_rcp_f32 v233, v233
    v_rcp_f32 v234, v234
    v_rcp_f32 v235, v235
    v_mul_f32 v232, v232, v76
    v_mul_f32 v233, v233, v77
    v_mul_f32 v234, v234, v78
    v_mul_f32 v235, v235, v79
    v_cvt_pk_bf16_f32 v246, v232, v233
    v_cvt_pk_bf16_f32 v247, v234, v235
    v_mul_f32 v232, v72, v72
    v_mul_f32 v233, v73, v73
    ds_read_b64_tr_b16 v[204:205], v221 offset:192
    ds_read_b64_tr_b16 v[206:207], v221 offset:4800
    s_waitcnt lgkmcnt(10)
    v_mfma_f32_32x32x16_bf16 v[84:99], v[208:211], v[184:187], v[84:99]
    v_mul_f32 v234, v74, v74
    v_mul_f32 v235, v75, v75
    v_fma_f32 v232, v232, s89, v244
    v_fma_f32 v233, v233, s89, v244
    v_fma_f32 v234, v234, s89, v244
    v_fma_f32 v235, v235, s89, v244
    v_mul_f32 v232, v232, v72
    v_mul_f32 v233, v233, v73
    v_mul_f32 v234, v234, v74
    v_mul_f32 v235, v235, v75
    v_exp_f32 v232, v232
    v_exp_f32 v233, v233
    ds_read_b64_tr_b16 v[208:209], v221 offset:2496
    ds_read_b64_tr_b16 v[210:211], v221 offset:7104
    s_waitcnt lgkmcnt(10)
    v_mfma_f32_32x32x16_bf16 v[84:99], v[212:215], v[188:191], v[84:99]
    v_exp_f32 v234, v234
    v_exp_f32 v235, v235
    v_mul_f32 v80, v80, v72
    v_mul_f32 v81, v81, v73
    v_mul_f32 v82, v82, v74
    v_mul_f32 v83, v83, v75
    v_add_f32 v232, 1.0, v232
    v_add_f32 v233, 1.0, v233
    v_add_f32 v234, 1.0, v234
    v_add_f32 v235, 1.0, v235
    v_rcp_f32 v232, v232
    v_rcp_f32 v233, v233
    ds_read_b64_tr_b16 v[212:213], v221 offset:18752
    ds_read_b64_tr_b16 v[214:215], v221 offset:23360
    s_waitcnt lgkmcnt(10)
    v_mfma_f32_32x32x16_bf16 v[84:99], v[216:219], v[192:195], v[84:99]
    v_rcp_f32 v234, v234
    v_rcp_f32 v235, v235
    v_mul_f32 v232, v232, v80
    v_mul_f32 v233, v233, v81
    v_mul_f32 v234, v234, v82
    v_mul_f32 v235, v235, v83
    v_cvt_pk_bf16_f32 v248, v232, v233
    v_cvt_pk_bf16_f32 v249, v234, v235
    buffer_store_dwordx4 v[246:249], v245, s[32:35], s90 offen offset:2048 sc1
    ds_read_b64_tr_b16 v[216:217], v221 offset:21056
    ds_read_b64_tr_b16 v[218:219], v221 offset:25664
    s_waitcnt lgkmcnt(10)
    v_mfma_f32_32x32x16_bf16 v[100:115], v[196:199], v[164:167], v[100:115]
    ds_read_b64_tr_b16 v[196:197], v221 offset:37312
    ds_read_b64_tr_b16 v[198:199], v221 offset:41920
    s_waitcnt lgkmcnt(10)
    v_mfma_f32_32x32x16_bf16 v[100:115], v[200:203], v[168:171], v[100:115]
    ds_read_b64_tr_b16 v[200:201], v221 offset:39616
    ds_read_b64_tr_b16 v[202:203], v221 offset:44224
    s_waitcnt lgkmcnt(10)
    v_mfma_f32_32x32x16_bf16 v[100:115], v[204:207], v[172:175], v[100:115]
    v_mul_f32 v232, v84, v84
    v_mul_f32 v233, v85, v85
    v_mul_f32 v234, v86, v86
    v_mul_f32 v235, v87, v87
    v_fma_f32 v232, v232, s89, v244
    v_fma_f32 v233, v233, s89, v244
    v_fma_f32 v234, v234, s89, v244
    v_fma_f32 v235, v235, s89, v244
    v_mul_f32 v232, v232, v84
    v_mul_f32 v233, v233, v85
    v_mul_f32 v234, v234, v86
    v_mul_f32 v235, v235, v87
    ds_read_b64_tr_b16 v[204:205], v220 offset:37344
    ds_read_b64_tr_b16 v[206:207], v220 offset:41952
    s_waitcnt lgkmcnt(10)
    v_mfma_f32_32x32x16_bf16 v[100:115], v[208:211], v[176:179], v[100:115]
    v_exp_f32 v232, v232
    v_exp_f32 v233, v233
    v_exp_f32 v234, v234
    v_exp_f32 v235, v235
    v_mul_f32 v92, v92, v84
    v_mul_f32 v93, v93, v85
    v_mul_f32 v94, v94, v86
    v_mul_f32 v95, v95, v87
    v_add_f32 v232, 1.0, v232
    v_add_f32 v233, 1.0, v233
    v_add_f32 v234, 1.0, v234
    v_add_f32 v235, 1.0, v235
    ds_read_b64_tr_b16 v[208:209], v220 offset:39648
    ds_read_b64_tr_b16 v[210:211], v220 offset:44256
    s_waitcnt lgkmcnt(10)
    v_mfma_f32_32x32x16_bf16 v[100:115], v[212:215], v[180:183], v[100:115]
    v_rcp_f32 v232, v232
    v_rcp_f32 v233, v233
    v_rcp_f32 v234, v234
    v_rcp_f32 v235, v235
    v_mul_f32 v232, v232, v92
    v_mul_f32 v233, v233, v93
    v_mul_f32 v234, v234, v94
    v_mul_f32 v235, v235, v95
    v_cvt_pk_bf16_f32 v250, v232, v233
    v_cvt_pk_bf16_f32 v251, v234, v235
    v_mul_f32 v232, v88, v88
    v_mul_f32 v233, v89, v89
    ds_read_b64_tr_b16 v[212:213], v221 offset:224
    ds_read_b64_tr_b16 v[214:215], v221 offset:4832
    s_waitcnt lgkmcnt(10)
    v_mfma_f32_32x32x16_bf16 v[100:115], v[216:219], v[184:187], v[100:115]
    v_mul_f32 v234, v90, v90
    v_mul_f32 v235, v91, v91
    v_fma_f32 v232, v232, s89, v244
    v_fma_f32 v233, v233, s89, v244
    v_fma_f32 v234, v234, s89, v244
    v_fma_f32 v235, v235, s89, v244
    v_mul_f32 v232, v232, v88
    v_mul_f32 v233, v233, v89
    v_mul_f32 v234, v234, v90
    v_mul_f32 v235, v235, v91
    v_exp_f32 v232, v232
    v_exp_f32 v233, v233
    ds_read_b64_tr_b16 v[216:217], v221 offset:2528
    ds_read_b64_tr_b16 v[218:219], v221 offset:7136
    s_waitcnt lgkmcnt(10)
    v_mfma_f32_32x32x16_bf16 v[100:115], v[196:199], v[188:191], v[100:115]
    v_exp_f32 v234, v234
    v_exp_f32 v235, v235
    v_mul_f32 v96, v96, v88
    v_mul_f32 v97, v97, v89
    v_mul_f32 v98, v98, v90
    v_mul_f32 v99, v99, v91
    v_add_f32 v232, 1.0, v232
    v_add_f32 v233, 1.0, v233
    v_add_f32 v234, 1.0, v234
    v_add_f32 v235, 1.0, v235
    v_rcp_f32 v232, v232
    v_rcp_f32 v233, v233
    ds_read_b64_tr_b16 v[196:197], v221 offset:18784
    ds_read_b64_tr_b16 v[198:199], v221 offset:23392
    s_waitcnt lgkmcnt(10)
    v_mfma_f32_32x32x16_bf16 v[100:115], v[200:203], v[192:195], v[100:115]
    v_rcp_f32 v234, v234
    v_rcp_f32 v235, v235
    v_mul_f32 v232, v232, v96
    v_mul_f32 v233, v233, v97
    v_mul_f32 v234, v234, v98
    v_mul_f32 v235, v235, v99
    v_cvt_pk_bf16_f32 v252, v232, v233
    v_cvt_pk_bf16_f32 v253, v234, v235
    buffer_store_dwordx4 v[250:253], v245, s[32:35], s90 offen offset:2560 sc1
    ds_read_b64_tr_b16 v[200:201], v221 offset:21088
    ds_read_b64_tr_b16 v[202:203], v221 offset:25696
    s_waitcnt lgkmcnt(10)
    v_mfma_f32_32x32x16_bf16 v[116:131], v[204:207], v[164:167], v[116:131]
    ds_read_b64_tr_b16 v[204:205], v221 offset:37344
    ds_read_b64_tr_b16 v[206:207], v221 offset:41952
    s_waitcnt lgkmcnt(10)
    v_mfma_f32_32x32x16_bf16 v[116:131], v[208:211], v[168:171], v[116:131]
    ds_read_b64_tr_b16 v[208:209], v221 offset:39648
    ds_read_b64_tr_b16 v[210:211], v221 offset:44256
    s_waitcnt lgkmcnt(10)
    v_mfma_f32_32x32x16_bf16 v[116:131], v[212:215], v[172:175], v[116:131]
    v_mul_f32 v232, v100, v100
    v_mul_f32 v233, v101, v101
    v_mul_f32 v234, v102, v102
    v_mul_f32 v235, v103, v103
    v_fma_f32 v232, v232, s89, v244
    v_fma_f32 v233, v233, s89, v244
    v_fma_f32 v234, v234, s89, v244
    v_fma_f32 v235, v235, s89, v244
    v_mul_f32 v232, v232, v100
    v_mul_f32 v233, v233, v101
    v_mul_f32 v234, v234, v102
    v_mul_f32 v235, v235, v103
    ds_read_b64_tr_b16 v[212:213], v220 offset:37376
    ds_read_b64_tr_b16 v[214:215], v220 offset:41984
    s_waitcnt lgkmcnt(10)
    v_mfma_f32_32x32x16_bf16 v[116:131], v[216:219], v[176:179], v[116:131]
    v_exp_f32 v232, v232
    v_exp_f32 v233, v233
    v_exp_f32 v234, v234
    v_exp_f32 v235, v235
    v_mul_f32 v108, v108, v100
    v_mul_f32 v109, v109, v101
    v_mul_f32 v110, v110, v102
    v_mul_f32 v111, v111, v103
    v_add_f32 v232, 1.0, v232
    v_add_f32 v233, 1.0, v233
    v_add_f32 v234, 1.0, v234
    v_add_f32 v235, 1.0, v235
    ds_read_b64_tr_b16 v[216:217], v220 offset:39680
    ds_read_b64_tr_b16 v[218:219], v220 offset:44288
    s_waitcnt lgkmcnt(10)
    v_mfma_f32_32x32x16_bf16 v[116:131], v[196:199], v[180:183], v[116:131]
    v_rcp_f32 v232, v232
    v_rcp_f32 v233, v233
    v_rcp_f32 v234, v234
    v_rcp_f32 v235, v235
    v_mul_f32 v232, v232, v108
    v_mul_f32 v233, v233, v109
    v_mul_f32 v234, v234, v110
    v_mul_f32 v235, v235, v111
    v_cvt_pk_bf16_f32 v246, v232, v233
    v_cvt_pk_bf16_f32 v247, v234, v235
    v_mul_f32 v232, v104, v104
    v_mul_f32 v233, v105, v105
    ds_read_b64_tr_b16 v[196:197], v221 offset:256
    ds_read_b64_tr_b16 v[198:199], v221 offset:4864
    s_waitcnt lgkmcnt(10)
    v_mfma_f32_32x32x16_bf16 v[116:131], v[200:203], v[184:187], v[116:131]
    v_mul_f32 v234, v106, v106
    v_mul_f32 v235, v107, v107
    v_fma_f32 v232, v232, s89, v244
    v_fma_f32 v233, v233, s89, v244
    v_fma_f32 v234, v234, s89, v244
    v_fma_f32 v235, v235, s89, v244
    v_mul_f32 v232, v232, v104
    v_mul_f32 v233, v233, v105
    v_mul_f32 v234, v234, v106
    v_mul_f32 v235, v235, v107
    v_exp_f32 v232, v232
    v_exp_f32 v233, v233
    ds_read_b64_tr_b16 v[200:201], v221 offset:2560
    ds_read_b64_tr_b16 v[202:203], v221 offset:7168
    s_waitcnt lgkmcnt(10)
    v_mfma_f32_32x32x16_bf16 v[116:131], v[204:207], v[188:191], v[116:131]
    v_exp_f32 v234, v234
    v_exp_f32 v235, v235
    v_mul_f32 v112, v112, v104
    v_mul_f32 v113, v113, v105
    v_mul_f32 v114, v114, v106
    v_mul_f32 v115, v115, v107
    v_add_f32 v232, 1.0, v232
    v_add_f32 v233, 1.0, v233
    v_add_f32 v234, 1.0, v234
    v_add_f32 v235, 1.0, v235
    v_rcp_f32 v232, v232
    v_rcp_f32 v233, v233
    ds_read_b64_tr_b16 v[204:205], v221 offset:18816
    ds_read_b64_tr_b16 v[206:207], v221 offset:23424
    s_waitcnt lgkmcnt(10)
    v_mfma_f32_32x32x16_bf16 v[116:131], v[208:211], v[192:195], v[116:131]
    v_rcp_f32 v234, v234
    v_rcp_f32 v235, v235
    v_mul_f32 v232, v232, v112
    v_mul_f32 v233, v233, v113
    v_mul_f32 v234, v234, v114
    v_mul_f32 v235, v235, v115
    v_cvt_pk_bf16_f32 v248, v232, v233
    v_cvt_pk_bf16_f32 v249, v234, v235
    buffer_store_dwordx4 v[246:249], v245, s[32:35], s90 offen offset:3072 sc1
    ds_read_b64_tr_b16 v[208:209], v221 offset:21120
    ds_read_b64_tr_b16 v[210:211], v221 offset:25728
    s_waitcnt lgkmcnt(10)
    v_mfma_f32_32x32x16_bf16 v[132:147], v[212:215], v[164:167], v[132:147]
    ds_read_b64_tr_b16 v[212:213], v221 offset:37376
    ds_read_b64_tr_b16 v[214:215], v221 offset:41984
    s_waitcnt lgkmcnt(10)
    v_mfma_f32_32x32x16_bf16 v[132:147], v[216:219], v[168:171], v[132:147]
    ds_read_b64_tr_b16 v[216:217], v221 offset:39680
    ds_read_b64_tr_b16 v[218:219], v221 offset:44288
    s_waitcnt lgkmcnt(10)
    v_mfma_f32_32x32x16_bf16 v[132:147], v[196:199], v[172:175], v[132:147]
    v_mul_f32 v232, v116, v116
    v_mul_f32 v233, v117, v117
    v_mul_f32 v234, v118, v118
    v_mul_f32 v235, v119, v119
    v_fma_f32 v232, v232, s89, v244
    v_fma_f32 v233, v233, s89, v244
    v_fma_f32 v234, v234, s89, v244
    v_fma_f32 v235, v235, s89, v244
    v_mul_f32 v232, v232, v116
    v_mul_f32 v233, v233, v117
    v_mul_f32 v234, v234, v118
    v_mul_f32 v235, v235, v119
    s_waitcnt lgkmcnt(8)
    v_mfma_f32_32x32x16_bf16 v[132:147], v[200:203], v[176:179], v[132:147]
    v_exp_f32 v232, v232
    v_exp_f32 v233, v233
    v_exp_f32 v234, v234
    v_exp_f32 v235, v235
    v_mul_f32 v124, v124, v116
    v_mul_f32 v125, v125, v117
    v_mul_f32 v126, v126, v118
    v_mul_f32 v127, v127, v119
    v_add_f32 v232, 1.0, v232
    v_add_f32 v233, 1.0, v233
    v_add_f32 v234, 1.0, v234
    v_add_f32 v235, 1.0, v235
    s_waitcnt lgkmcnt(6)
    v_mfma_f32_32x32x16_bf16 v[132:147], v[204:207], v[180:183], v[132:147]
    v_rcp_f32 v232, v232
    v_rcp_f32 v233, v233
    v_rcp_f32 v234, v234
    v_rcp_f32 v235, v235
    v_mul_f32 v232, v232, v124
    v_mul_f32 v233, v233, v125
    v_mul_f32 v234, v234, v126
    v_mul_f32 v235, v235, v127
    v_cvt_pk_bf16_f32 v250, v232, v233
    v_cvt_pk_bf16_f32 v251, v234, v235
    v_mul_f32 v232, v120, v120
    v_mul_f32 v233, v121, v121
    s_waitcnt lgkmcnt(4)
    v_mfma_f32_32x32x16_bf16 v[132:147], v[208:211], v[184:187], v[132:147]
    v_mul_f32 v234, v122, v122
    v_mul_f32 v235, v123, v123
    v_fma_f32 v232, v232, s89, v244
    v_fma_f32 v233, v233, s89, v244
    v_fma_f32 v234, v234, s89, v244
    v_fma_f32 v235, v235, s89, v244
    v_mul_f32 v232, v232, v120
    v_mul_f32 v233, v233, v121
    v_mul_f32 v234, v234, v122
    v_mul_f32 v235, v235, v123
    v_exp_f32 v232, v232
    v_exp_f32 v233, v233
    s_waitcnt lgkmcnt(2)
    v_mfma_f32_32x32x16_bf16 v[132:147], v[212:215], v[188:191], v[132:147]
    v_exp_f32 v234, v234
    v_exp_f32 v235, v235
    v_mul_f32 v128, v128, v120
    v_mul_f32 v129, v129, v121
    v_mul_f32 v130, v130, v122
    v_mul_f32 v131, v131, v123
    v_add_f32 v232, 1.0, v232
    v_add_f32 v233, 1.0, v233
    v_add_f32 v234, 1.0, v234
    v_add_f32 v235, 1.0, v235
    v_rcp_f32 v232, v232
    v_rcp_f32 v233, v233
    s_waitcnt lgkmcnt(0)
    v_mfma_f32_32x32x16_bf16 v[132:147], v[216:219], v[192:195], v[132:147]
    v_rcp_f32 v234, v234
    v_rcp_f32 v235, v235
    v_mul_f32 v232, v232, v128
    v_mul_f32 v233, v233, v129
    v_mul_f32 v234, v234, v130
    v_mul_f32 v235, v235, v131
    v_cvt_pk_bf16_f32 v252, v232, v233
    v_cvt_pk_bf16_f32 v253, v234, v235
    buffer_store_dwordx4 v[250:253], v245, s[32:35], s90 offen offset:3584 sc1
    s_nop 7
    s_nop 7
    v_mul_f32 v232, v132, v132
    v_mul_f32 v233, v133, v133
    v_mul_f32 v234, v134, v134
    v_mul_f32 v235, v135, v135
    v_fma_f32 v232, v232, s89, v244
    v_fma_f32 v233, v233, s89, v244
    v_fma_f32 v234, v234, s89, v244
    v_fma_f32 v235, v235, s89, v244
    v_mul_f32 v232, v232, v132
    v_mul_f32 v233, v233, v133
    v_mul_f32 v234, v234, v134
    v_mul_f32 v235, v235, v135
    v_exp_f32 v232, v232
    v_exp_f32 v233, v233
    v_exp_f32 v234, v234
    v_exp_f32 v235, v235
    v_mul_f32 v140, v140, v132
    v_mul_f32 v141, v141, v133
    v_mul_f32 v142, v142, v134
    v_mul_f32 v143, v143, v135
    v_add_f32 v232, 1.0, v232
    v_add_f32 v233, 1.0, v233
    v_add_f32 v234, 1.0, v234
    v_add_f32 v235, 1.0, v235
    v_rcp_f32 v232, v232
    v_rcp_f32 v233, v233
    v_rcp_f32 v234, v234
    v_rcp_f32 v235, v235
    v_mul_f32 v232, v232, v140
    v_mul_f32 v233, v233, v141
    v_mul_f32 v234, v234, v142
    v_mul_f32 v235, v235, v143
    v_cvt_pk_bf16_f32 v246, v232, v233
    v_cvt_pk_bf16_f32 v247, v234, v235
    v_mul_f32 v232, v136, v136
    v_mul_f32 v233, v137, v137
    v_mul_f32 v234, v138, v138
    v_mul_f32 v235, v139, v139
    v_fma_f32 v232, v232, s89, v244
    v_fma_f32 v233, v233, s89, v244
    v_fma_f32 v234, v234, s89, v244
    v_fma_f32 v235, v235, s89, v244
    v_mul_f32 v232, v232, v136
    v_mul_f32 v233, v233, v137
    v_mul_f32 v234, v234, v138
    v_mul_f32 v235, v235, v139
    v_exp_f32 v232, v232
    v_exp_f32 v233, v233
    v_exp_f32 v234, v234
    v_exp_f32 v235, v235
    v_mul_f32 v144, v144, v136
    v_mul_f32 v145, v145, v137
    v_mul_f32 v146, v146, v138
    v_mul_f32 v147, v147, v139
    v_add_f32 v232, 1.0, v232
    v_add_f32 v233, 1.0, v233
    v_add_f32 v234, 1.0, v234
    v_add_f32 v235, 1.0, v235
    v_rcp_f32 v232, v232
    v_rcp_f32 v233, v233
    v_rcp_f32 v234, v234
    v_rcp_f32 v235, v235
    v_mul_f32 v232, v232, v144
    v_mul_f32 v233, v233, v145
    v_mul_f32 v234, v234, v146
    v_mul_f32 v235, v235, v147
    v_cvt_pk_bf16_f32 v248, v232, v233
    v_cvt_pk_bf16_f32 v249, v234, v235
    buffer_store_dwordx4 v[246:249], v245, s[32:35], s91 offen sc1
L_k3_kernel_epi:
L_k3_kernel_done:
    s_endpgm

.globl k4_kernel
.p2align 8
.type k4_kernel,@function
k4_kernel:
    s_cmp_ge_u32 s2, 256
    s_cbranch_scc1 L_k4_kernel_done
    s_load_dwordx2 s[4:5], s[0:1], 48
    s_load_dwordx2 s[8:9], s[0:1], 72
    v_lshrrev_b32 v1, 6, v0
    v_and_b32 v0, 63, v0
    s_nop 0
    v_readfirstlane_b32 s28, v1
    s_and_b32 s40, s2, 7
    s_lshr_b32 s41, s2, 3
    s_lshr_b32 s29, s40, 1
    s_and_b32 s31, s41, 3
    s_and_b32 s40, s40, 1
    s_lshl_b32 s40, s40, 3
    s_lshr_b32 s30, s41, 2
    s_add_u32 s30, s30, s40
    s_lshl_b32 s40, s28, 6
    s_sub_u32 s41, s40, 64
    s_cmp_eq_u32 s28, 0
    s_cselect_b32 s41, 512, s41
    s_cselect_b32 s43, 0, 0
    s_add_u32 s42, s40, 448
    s_lshl_b32 s36, s28, 10
    s_add_u32 s37, s36, 8192
    s_add_u32 s37, s37, s43
    s_add_u32 s38, s36, 16384
    v_add_u32 v161, s40, v0
    v_mul_u32_u24 v162, 3641, v161
    v_lshrrev_b32 v168, 16, v162
    v_mul_u32_u24 v163, 18, v168
    v_sub_u32 v163, v161, v163
    v_mul_u32_u24 v162, 1152, v168
    v_lshl_add_u32 v150, v163, 4, v162
    v_add_u32 v161, s41, v0
    v_mul_u32_u24 v162, 3641, v161
    v_lshrrev_b32 v169, 16, v162
    v_mul_u32_u24 v163, 18, v169
    v_sub_u32 v163, v161, v163
    v_mul_u32_u24 v162, 1152, v169
    v_lshl_add_u32 v151, v163, 4, v162
    v_add_u32 v161, s42, v0
    v_mul_u32_u24 v162, 3641, v161
    v_lshrrev_b32 v170, 16, v162
    v_mul_u32_u24 v163, 18, v170
    v_sub_u32 v163, v161, v163
    v_mul_u32_u24 v162, 1152, v170
    v_lshl_add_u32 v152, v163, 4, v162
    s_cmp_eq_u32 s28, 0
    s_cselect_b32 s40, 0, 663552
    v_add_u32 v151, s40, v151
    v_add_u32 v152, 663552, v152
    s_mov_b32 s40, 147456
    v_cmp_lt_u32 vcc, 15, v168
    v_mov_b32 v161, s40
    s_nop 0
    v_cndmask_b32 v161, 0, v161, vcc
    v_add_u32 v153, v150, v161
    v_cmp_lt_u32 vcc, 15, v169
    v_mov_b32 v161, s40
    s_nop 0
    v_cndmask_b32 v161, 0, v161, vcc
    v_add_u32 v154, v151, v161
    v_cmp_lt_u32 vcc, 15, v170
    v_mov_b32 v161, s40
    s_nop 0
    v_cndmask_b32 v161, 0, v161, vcc
    v_add_u32 v155, v152, v161
    s_mul_i32 s32, s29, 1327104
    s_mul_i32 s40, s31, 288
    s_add_u32 s32, s32, s40
    s_lshr_b32 s40, s28, 2
    s_lshl_b32 s41, s29, 1
    s_add_u32 s41, s41, s40
    s_and_b32 s42, s28, 3
    s_lshl_b32 s33, s30, 3
    s_lshl_b32 s43, s42, 1
    s_add_u32 s33, s33, s43
    s_mov_b32 s44, s33
    s_mul_i32 s33, s33, 144
    s_mul_i32 s43, s41, 18
    s_add_u32 s33, s33, s43
    s_lshl_b32 s33, s33, 10
    v_lshlrev_b32 v156, 4, v0
    v_add_u32 v156, s33, v156
    v_add_u32 v157, 147456, v156
    s_lshl_b32 s34, s29, 7
    s_add_u32 s34, s34, s44
    s_add_u32 s34, s34, s40
    s_mul_i32 s34, s34, 36
    s_mul_i32 s46, s31, 9
    s_add_u32 s34, s34, s46
    s_lshl_b32 s34, s34, 9
    v_lshrrev_b32 v165, 5, v0
    v_lshlrev_b32 v165, 4, v165
    v_bfe_u32 v166, v0, 2, 3
    v_add_u32 v165, v165, v166
    v_mul_u32_u24 v165, 288, v165
    v_and_b32 v166, 3, v0
    v_lshl_add_u32 v148, v166, 3, v165
    s_mul_i32 s46, s40, 9216
    v_add_u32 v148, s46, v148
    v_add_u32 v149, 55296, v148
    s_waitcnt lgkmcnt(0)
    s_mov_b32 s12, s4
    s_mov_b32 s13, s5
    s_and_b32 s13, s13, 0xffff
    s_mov_b32 s14, 5308416
    s_mov_b32 s15, 0x00020000
    s_add_u32 s16, s8, 4816896
    s_addc_u32 s17, s9, 0
    s_and_b32 s17, s17, 0xffff
    s_mov_b32 s18, 18874368
    s_mov_b32 s19, 0x00020000
    s_add_u32 s20, s8, 23691264
    s_addc_u32 s21, s9, 0
    s_and_b32 s21, s21, 0xffff
    s_mov_b32 s22, 18874368
    s_mov_b32 s23, 0x00020000
    s_add_u32 s52, s32, 0
    s_cmp_ge_u32 s28, 2
    s_cbranch_scc1 L_k4_kernel_sk0
    s_add_u32 m0, s38, 0
    s_nop 0
    buffer_load_dwordx4 v152, s[12:15], s52 offen lds
L_k4_kernel_sk0:
    s_add_u32 m0, s36, 0
    s_nop 0
    buffer_load_dwordx4 v150, s[12:15], s52 offen lds
    s_add_u32 m0, s37, 0
    s_nop 0
    buffer_load_dwordx4 v151, s[12:15], s52 offen lds
    s_mov_b32 s53, 0
    buffer_load_dwordx4 v[76:79], v156, s[16:19], s53 offen
    buffer_load_dwordx4 v[80:83], v157, s[16:19], s53 offen
    s_add_u32 s52, s32, 36864
    s_cmp_ge_u32 s28, 2
    s_cbranch_scc1 L_k4_kernel_sk1
    s_add_u32 m0, s38, 18432
    s_nop 0
    buffer_load_dwordx4 v152, s[12:15], s52 offen lds
L_k4_kernel_sk1:
    s_add_u32 m0, s36, 18432
    s_nop 0
    buffer_load_dwordx4 v150, s[12:15], s52 offen lds
    s_add_u32 m0, s37, 18432
    s_nop 0
    buffer_load_dwordx4 v151, s[12:15], s52 offen lds
    s_mov_b32 s53, 1024
    buffer_load_dwordx4 v[84:87], v156, s[16:19], s53 offen
    buffer_load_dwordx4 v[88:91], v157, s[16:19], s53 offen
    v_mov_b64 v[4:5], 0
    v_mov_b64 v[6:7], 0
    v_mov_b64 v[8:9], 0
    v_mov_b64 v[10:11], 0
    v_mov_b64 v[12:13], 0
    v_mov_b64 v[14:15], 0
    v_mov_b64 v[16:17], 0
    v_mov_b64 v[18:19], 0
    v_mov_b64 v[20:21], 0
    v_mov_b64 v[22:23], 0
    v_mov_b64 v[24:25], 0
    v_mov_b64 v[26:27], 0
    v_mov_b64 v[28:29], 0
    v_mov_b64 v[30:31], 0
    v_mov_b64 v[32:33], 0
    v_mov_b64 v[34:35], 0
    v_mov_b64 v[36:37], 0
    v_mov_b64 v[38:39], 0
    v_mov_b64 v[40:41], 0
    v_mov_b64 v[42:43], 0
    v_mov_b64 v[44:45], 0
    v_mov_b64 v[46:47], 0
    v_mov_b64 v[48:49], 0
    v_mov_b64 v[50:51], 0
    v_mov_b64 v[52:53], 0
    v_mov_b64 v[54:55], 0
    v_mov_b64 v[56:57], 0
    v_mov_b64 v[58:59], 0
    v_mov_b64 v[60:61], 0
    v_mov_b64 v[62:63], 0
    v_mov_b64 v[64:65], 0
    v_mov_b64 v[66:67], 0
    v_mov_b64 v[68:69], 0
    v_mov_b64 v[70:71], 0
    v_mov_b64 v[72:73], 0
    v_mov_b64 v[74:75], 0
    s_waitcnt vmcnt(4)
    s_barrier
    ds_read_b64_tr_b16 v[124:125], v148 offset:0
    ds_read_b64_tr_b16 v[126:127], v148 offset:2304
    ds_read_b64_tr_b16 v[128:129], v148 offset:32
    ds_read_b64_tr_b16 v[130:131], v148 offset:2336
    ds_read_b64_tr_b16 v[132:133], v148 offset:64
    ds_read_b64_tr_b16 v[134:135], v148 offset:2368
    ds_read_b64_tr_b16 v[136:137], v148 offset:96
    ds_read_b64_tr_b16 v[138:139], v148 offset:2400
    ds_read_b64_tr_b16 v[140:141], v148 offset:128
    ds_read_b64_tr_b16 v[142:143], v148 offset:2432
    ds_read_b64_tr_b16 v[144:145], v148 offset:160
    ds_read_b64_tr_b16 v[146:147], v148 offset:2464
    s_waitcnt lgkmcnt(10)
    v_mfma_f32_16x16x32_bf16 v[4:7], v[124:127], v[76:79], v[4:7]
    v_mfma_f32_16x16x32_bf16 v[8:11], v[124:127], v[80:83], v[8:11]
    s_add_u32 s52, s32, 73728
    s_cmp_ge_u32 s28, 2
    s_cbranch_scc1 L_k4_kernel_sk2
    s_add_u32 m0, s38, 36864
    s_nop 0
    buffer_load_dwordx4 v152, s[12:15], s52 offen lds
L_k4_kernel_sk2:
    s_add_u32 m0, s36, 36864
    s_nop 0
    buffer_load_dwordx4 v150, s[12:15], s52 offen lds
    ds_read_b64_tr_b16 v[124:125], v148 offset:192
    ds_read_b64_tr_b16 v[126:127], v148 offset:2496
    s_waitcnt lgkmcnt(10)
    v_mfma_f32_16x16x32_bf16 v[12:15], v[128:131], v[76:79], v[12:15]
    v_mfma_f32_16x16x32_bf16 v[16:19], v[128:131], v[80:83], v[16:19]
    s_add_u32 m0, s37, 36864
    s_nop 0
    buffer_load_dwordx4 v151, s[12:15], s52 offen lds
    ds_read_b64_tr_b16 v[128:129], v148 offset:224
    ds_read_b64_tr_b16 v[130:131], v148 offset:2528
    s_waitcnt lgkmcnt(10)
    v_mfma_f32_16x16x32_bf16 v[20:23], v[132:135], v[76:79], v[20:23]
    v_mfma_f32_16x16x32_bf16 v[24:27], v[132:135], v[80:83], v[24:27]
    s_mov_b32 s53, 2048
    buffer_load_dwordx4 v[92:95], v156, s[16:19], s53 offen
    ds_read_b64_tr_b16 v[132:133], v148 offset:256
    ds_read_b64_tr_b16 v[134:135], v148 offset:2560
    s_waitcnt lgkmcnt(10)
    v_mfma_f32_16x16x32_bf16 v[28:31], v[136:139], v[76:79], v[28:31]
    v_mfma_f32_16x16x32_bf16 v[32:35], v[136:139], v[80:83], v[32:35]
    buffer_load_dwordx4 v[96:99], v157, s[16:19], s53 offen
    s_waitcnt vmcnt(6)
    s_barrier
    ds_read_b64_tr_b16 v[136:137], v148 offset:18432
    ds_read_b64_tr_b16 v[138:139], v148 offset:20736
    s_waitcnt lgkmcnt(10)
    v_mfma_f32_16x16x32_bf16 v[36:39], v[140:143], v[76:79], v[36:39]
    v_mfma_f32_16x16x32_bf16 v[40:43], v[140:143], v[80:83], v[40:43]
    s_add_u32 s52, s32, 110592
    s_cmp_ge_u32 s28, 2
    s_cbranch_scc1 L_k4_kernel_sk3
    s_add_u32 m0, s38, 55296
    s_nop 0
    buffer_load_dwordx4 v152, s[12:15], s52 offen lds
L_k4_kernel_sk3:
    s_add_u32 m0, s36, 55296
    s_nop 0
    buffer_load_dwordx4 v150, s[12:15], s52 offen lds
    ds_read_b64_tr_b16 v[140:141], v148 offset:18464
    ds_read_b64_tr_b16 v[142:143], v148 offset:20768
    s_waitcnt lgkmcnt(10)
    v_mfma_f32_16x16x32_bf16 v[44:47], v[144:147], v[76:79], v[44:47]
    v_mfma_f32_16x16x32_bf16 v[48:51], v[144:147], v[80:83], v[48:51]
    s_add_u32 m0, s37, 55296
    s_nop 0
    buffer_load_dwordx4 v151, s[12:15], s52 offen lds
    ds_read_b64_tr_b16 v[144:145], v148 offset:18496
    ds_read_b64_tr_b16 v[146:147], v148 offset:20800
    s_waitcnt lgkmcnt(10)
    v_mfma_f32_16x16x32_bf16 v[52:55], v[124:127], v[76:79], v[52:55]
    v_mfma_f32_16x16x32_bf16 v[56:59], v[124:127], v[80:83], v[56:59]
    s_mov_b32 s53, 3072
    buffer_load_dwordx4 v[100:103], v156, s[16:19], s53 offen
    ds_read_b64_tr_b16 v[124:125], v148 offset:18528
    ds_read_b64_tr_b16 v[126:127], v148 offset:20832
    s_waitcnt lgkmcnt(10)
    v_mfma_f32_16x16x32_bf16 v[60:63], v[128:131], v[76:79], v[60:63]
    v_mfma_f32_16x16x32_bf16 v[64:67], v[128:131], v[80:83], v[64:67]
    buffer_load_dwordx4 v[104:107], v157, s[16:19], s53 offen
    ds_read_b64_tr_b16 v[128:129], v148 offset:18560
    ds_read_b64_tr_b16 v[130:131], v148 offset:20864
    s_waitcnt lgkmcnt(10)
    v_mfma_f32_16x16x32_bf16 v[68:71], v[132:135], v[76:79], v[68:71]
    v_mfma_f32_16x16x32_bf16 v[72:75], v[132:135], v[80:83], v[72:75]
    s_waitcnt vmcnt(6)
    s_barrier
    ds_read_b64_tr_b16 v[132:133], v148 offset:18592
    ds_read_b64_tr_b16 v[134:135], v148 offset:20896
    s_waitcnt lgkmcnt(10)
    v_mfma_f32_16x16x32_bf16 v[4:7], v[136:139], v[84:87], v[4:7]
    v_mfma_f32_16x16x32_bf16 v[8:11], v[136:139], v[88:91], v[8:11]
    s_add_u32 s52, s32, 165888
    s_cmp_ge_u32 s28, 2
    s_cbranch_scc1 L_k4_kernel_sk4
    s_add_u32 m0, s38, 73728
    s_nop 0
    buffer_load_dwordx4 v152, s[12:15], s52 offen lds
L_k4_kernel_sk4:
    s_add_u32 m0, s36, 73728
    s_nop 0
    buffer_load_dwordx4 v150, s[12:15], s52 offen lds
    ds_read_b64_tr_b16 v[136:137], v148 offset:18624
    ds_read_b64_tr_b16 v[138:139], v148 offset:20928
    s_waitcnt lgkmcnt(10)
    v_mfma_f32_16x16x32_bf16 v[12:15], v[140:143], v[84:87], v[12:15]
    v_mfma_f32_16x16x32_bf16 v[16:19], v[140:143], v[88:91], v[16:19]
    s_add_u32 m0, s37, 73728
    s_nop 0
    buffer_load_dwordx4 v151, s[12:15], s52 offen lds
    ds_read_b64_tr_b16 v[140:141], v148 offset:18656
    ds_read_b64_tr_b16 v[142:143], v148 offset:20960
    s_waitcnt lgkmcnt(10)
    v_mfma_f32_16x16x32_bf16 v[20:23], v[144:147], v[84:87], v[20:23]
    v_mfma_f32_16x16x32_bf16 v[24:27], v[144:147], v[88:91], v[24:27]
    s_mov_b32 s53, 4096
    buffer_load_dwordx4 v[108:111], v156, s[16:19], s53 offen
    ds_read_b64_tr_b16 v[144:145], v148 offset:18688
    ds_read_b64_tr_b16 v[146:147], v148 offset:20992
    s_waitcnt lgkmcnt(10)
    v_mfma_f32_16x16x32_bf16 v[28:31], v[124:127], v[84:87], v[28:31]
    v_mfma_f32_16x16x32_bf16 v[32:35], v[124:127], v[88:91], v[32:35]
    buffer_load_dwordx4 v[112:115], v157, s[16:19], s53 offen
    ds_read_b64_tr_b16 v[124:125], v148 offset:36864
    ds_read_b64_tr_b16 v[126:127], v148 offset:39168
    s_waitcnt lgkmcnt(10)
    v_mfma_f32_16x16x32_bf16 v[36:39], v[128:131], v[84:87], v[36:39]
    v_mfma_f32_16x16x32_bf16 v[40:43], v[128:131], v[88:91], v[40:43]
    s_add_u32 s52, s32, 202752
    s_cmp_ge_u32 s28, 2
    s_cbranch_scc1 L_k4_kernel_sk5
    s_add_u32 m0, s38, 92160
    s_nop 0
    buffer_load_dwordx4 v152, s[12:15], s52 offen lds
L_k4_kernel_sk5:
    s_add_u32 m0, s36, 92160
    s_nop 0
    buffer_load_dwordx4 v150, s[12:15], s52 offen lds
    ds_read_b64_tr_b16 v[128:129], v148 offset:36896
    ds_read_b64_tr_b16 v[130:131], v148 offset:39200
    s_waitcnt lgkmcnt(10)
    v_mfma_f32_16x16x32_bf16 v[44:47], v[132:135], v[84:87], v[44:47]
    v_mfma_f32_16x16x32_bf16 v[48:51], v[132:135], v[88:91], v[48:51]
    s_add_u32 m0, s37, 92160
    s_nop 0
    buffer_load_dwordx4 v151, s[12:15], s52 offen lds
    ds_read_b64_tr_b16 v[132:133], v148 offset:36928
    ds_read_b64_tr_b16 v[134:135], v148 offset:39232
    s_waitcnt lgkmcnt(10)
    v_mfma_f32_16x16x32_bf16 v[52:55], v[136:139], v[84:87], v[52:55]
    v_mfma_f32_16x16x32_bf16 v[56:59], v[136:139], v[88:91], v[56:59]
    s_mov_b32 s53, 5120
    buffer_load_dwordx4 v[116:119], v156, s[16:19], s53 offen
    ds_read_b64_tr_b16 v[136:137], v148 offset:36960
    ds_read_b64_tr_b16 v[138:139], v148 offset:39264
    s_waitcnt lgkmcnt(10)
    v_mfma_f32_16x16x32_bf16 v[60:63], v[140:143], v[84:87], v[60:63]
    v_mfma_f32_16x16x32_bf16 v[64:67], v[140:143], v[88:91], v[64:67]
    buffer_load_dwordx4 v[120:123], v157, s[16:19], s53 offen
    ds_read_b64_tr_b16 v[140:141], v148 offset:36992
    ds_read_b64_tr_b16 v[142:143], v148 offset:39296
    s_waitcnt lgkmcnt(10)
    v_mfma_f32_16x16x32_bf16 v[68:71], v[144:147], v[84:87], v[68:71]
    v_mfma_f32_16x16x32_bf16 v[72:75], v[144:147], v[88:91], v[72:75]
    s_waitcnt vmcnt(10)
    s_barrier
    ds_read_b64_tr_b16 v[144:145], v148 offset:37024
    ds_read_b64_tr_b16 v[146:147], v148 offset:39328
    s_waitcnt lgkmcnt(10)
    v_mfma_f32_16x16x32_bf16 v[4:7], v[124:127], v[92:95], v[4:7]
    v_mfma_f32_16x16x32_bf16 v[8:11], v[124:127], v[96:99], v[8:11]
    s_add_u32 s52, s32, 239616
    s_cmp_ge_u32 s28, 2
    s_cbranch_scc1 L_k4_kernel_sk6
    s_add_u32 m0, s38, 0
    s_nop 0
    buffer_load_dwordx4 v152, s[12:15], s52 offen lds
L_k4_kernel_sk6:
    s_add_u32 m0, s36, 0
    s_nop 0
    buffer_load_dwordx4 v150, s[12:15], s52 offen lds
    ds_read_b64_tr_b16 v[124:125], v148 offset:37056
    ds_read_b64_tr_b16 v[126:127], v148 offset:39360
    s_waitcnt lgkmcnt(10)
    v_mfma_f32_16x16x32_bf16 v[12:15], v[128:131], v[92:95], v[12:15]
    v_mfma_f32_16x16x32_bf16 v[16:19], v[128:131], v[96:99], v[16:19]
    s_add_u32 m0, s37, 0
    s_nop 0
    buffer_load_dwordx4 v151, s[12:15], s52 offen lds
    ds_read_b64_tr_b16 v[128:129], v148 offset:37088
    ds_read_b64_tr_b16 v[130:131], v148 offset:39392
    s_waitcnt lgkmcnt(10)
    v_mfma_f32_16x16x32_bf16 v[20:23], v[132:135], v[92:95], v[20:23]
    v_mfma_f32_16x16x32_bf16 v[24:27], v[132:135], v[96:99], v[24:27]
    s_mov_b32 s53, 6144
    buffer_load_dwordx4 v[76:79], v156, s[16:19], s53 offen
    ds_read_b64_tr_b16 v[132:133], v148 offset:37120
    ds_read_b64_tr_b16 v[134:135], v148 offset:39424
    s_waitcnt lgkmcnt(10)
    v_mfma_f32_16x16x32_bf16 v[28:31], v[136:139], v[92:95], v[28:31]
    v_mfma_f32_16x16x32_bf16 v[32:35], v[136:139], v[96:99], v[32:35]
    buffer_load_dwordx4 v[80:83], v157, s[16:19], s53 offen
    ds_read_b64_tr_b16 v[136:137], v149 offset:0
    ds_read_b64_tr_b16 v[138:139], v149 offset:2304
    s_waitcnt lgkmcnt(10)
    v_mfma_f32_16x16x32_bf16 v[36:39], v[140:143], v[92:95], v[36:39]
    v_mfma_f32_16x16x32_bf16 v[40:43], v[140:143], v[96:99], v[40:43]
    s_add_u32 s52, s32, 276480
    s_cmp_ge_u32 s28, 2
    s_cbranch_scc1 L_k4_kernel_sk7
    s_add_u32 m0, s38, 18432
    s_nop 0
    buffer_load_dwordx4 v152, s[12:15], s52 offen lds
L_k4_kernel_sk7:
    s_add_u32 m0, s36, 18432
    s_nop 0
    buffer_load_dwordx4 v150, s[12:15], s52 offen lds
    ds_read_b64_tr_b16 v[140:141], v149 offset:32
    ds_read_b64_tr_b16 v[142:143], v149 offset:2336
    s_waitcnt lgkmcnt(10)
    v_mfma_f32_16x16x32_bf16 v[44:47], v[144:147], v[92:95], v[44:47]
    v_mfma_f32_16x16x32_bf16 v[48:51], v[144:147], v[96:99], v[48:51]
    s_add_u32 m0, s37, 18432
    s_nop 0
    buffer_load_dwordx4 v151, s[12:15], s52 offen lds
    ds_read_b64_tr_b16 v[144:145], v149 offset:64
    ds_read_b64_tr_b16 v[146:147], v149 offset:2368
    s_waitcnt lgkmcnt(10)
    v_mfma_f32_16x16x32_bf16 v[52:55], v[124:127], v[92:95], v[52:55]
    v_mfma_f32_16x16x32_bf16 v[56:59], v[124:127], v[96:99], v[56:59]
    s_mov_b32 s53, 7168
    buffer_load_dwordx4 v[84:87], v156, s[16:19], s53 offen
    ds_read_b64_tr_b16 v[124:125], v149 offset:96
    ds_read_b64_tr_b16 v[126:127], v149 offset:2400
    s_waitcnt lgkmcnt(10)
    v_mfma_f32_16x16x32_bf16 v[60:63], v[128:131], v[92:95], v[60:63]
    v_mfma_f32_16x16x32_bf16 v[64:67], v[128:131], v[96:99], v[64:67]
    buffer_load_dwordx4 v[88:91], v157, s[16:19], s53 offen
    ds_read_b64_tr_b16 v[128:129], v149 offset:128
    ds_read_b64_tr_b16 v[130:131], v149 offset:2432
    s_waitcnt lgkmcnt(10)
    v_mfma_f32_16x16x32_bf16 v[68:71], v[132:135], v[92:95], v[68:71]
    v_mfma_f32_16x16x32_bf16 v[72:75], v[132:135], v[96:99], v[72:75]
    s_waitcnt vmcnt(14)
    s_barrier
    ds_read_b64_tr_b16 v[132:133], v149 offset:160
    ds_read_b64_tr_b16 v[134:135], v149 offset:2464
    s_waitcnt lgkmcnt(10)
    v_mfma_f32_16x16x32_bf16 v[4:7], v[136:139], v[100:103], v[4:7]
    v_mfma_f32_16x16x32_bf16 v[8:11], v[136:139], v[104:107], v[8:11]
    s_add_u32 s52, s32, 147456
    s_cmp_ge_u32 s28, 2
    s_cbranch_scc1 L_k4_kernel_sk8
    s_add_u32 m0, s38, 36864
    s_nop 0
    buffer_load_dwordx4 v155, s[12:15], s52 offen lds
L_k4_kernel_sk8:
    s_add_u32 m0, s36, 36864
    s_nop 0
    buffer_load_dwordx4 v153, s[12:15], s52 offen lds
    ds_read_b64_tr_b16 v[136:137], v149 offset:192
    ds_read_b64_tr_b16 v[138:139], v149 offset:2496
    s_waitcnt lgkmcnt(10)
    v_mfma_f32_16x16x32_bf16 v[12:15], v[140:143], v[100:103], v[12:15]
    v_mfma_f32_16x16x32_bf16 v[16:19], v[140:143], v[104:107], v[16:19]
    ds_read_b64_tr_b16 v[140:141], v149 offset:224
    ds_read_b64_tr_b16 v[142:143], v149 offset:2528
    s_waitcnt lgkmcnt(10)
    v_mfma_f32_16x16x32_bf16 v[20:23], v[144:147], v[100:103], v[20:23]
    v_mfma_f32_16x16x32_bf16 v[24:27], v[144:147], v[104:107], v[24:27]
    s_add_u32 m0, s37, 36864
    s_nop 0
    buffer_load_dwordx4 v154, s[12:15], s52 offen lds
    ds_read_b64_tr_b16 v[144:145], v149 offset:256
    ds_read_b64_tr_b16 v[146:147], v149 offset:2560
    s_waitcnt lgkmcnt(10)
    v_mfma_f32_16x16x32_bf16 v[28:31], v[124:127], v[100:103], v[28:31]
    v_mfma_f32_16x16x32_bf16 v[32:35], v[124:127], v[104:107], v[32:35]
    ds_read_b64_tr_b16 v[124:125], v149 offset:18432
    ds_read_b64_tr_b16 v[126:127], v149 offset:20736
    s_waitcnt lgkmcnt(10)
    v_mfma_f32_16x16x32_bf16 v[36:39], v[128:131], v[100:103], v[36:39]
    v_mfma_f32_16x16x32_bf16 v[40:43], v[128:131], v[104:107], v[40:43]
    s_mov_b32 s53, 8192
    buffer_load_dwordx4 v[92:95], v156, s[16:19], s53 offen
    ds_read_b64_tr_b16 v[128:129], v149 offset:18464
    ds_read_b64_tr_b16 v[130:131], v149 offset:20768
    s_waitcnt lgkmcnt(10)
    v_mfma_f32_16x16x32_bf16 v[44:47], v[132:135], v[100:103], v[44:47]
    v_mfma_f32_16x16x32_bf16 v[48:51], v[132:135], v[104:107], v[48:51]
    ds_read_b64_tr_b16 v[132:133], v149 offset:18496
    ds_read_b64_tr_b16 v[134:135], v149 offset:20800
    s_waitcnt lgkmcnt(10)
    v_mfma_f32_16x16x32_bf16 v[52:55], v[136:139], v[100:103], v[52:55]
    v_mfma_f32_16x16x32_bf16 v[56:59], v[136:139], v[104:107], v[56:59]
    buffer_load_dwordx4 v[96:99], v157, s[16:19], s53 offen
    ds_read_b64_tr_b16 v[136:137], v149 offset:18528
    ds_read_b64_tr_b16 v[138:139], v149 offset:20832
    s_waitcnt lgkmcnt(10)
    v_mfma_f32_16x16x32_bf16 v[60:63], v[140:143], v[100:103], v[60:63]
    v_mfma_f32_16x16x32_bf16 v[64:67], v[140:143], v[104:107], v[64:67]
    ds_read_b64_tr_b16 v[140:141], v149 offset:18560
    ds_read_b64_tr_b16 v[142:143], v149 offset:20864
    s_waitcnt lgkmcnt(10)
    v_mfma_f32_16x16x32_bf16 v[68:71], v[144:147], v[100:103], v[68:71]
    v_mfma_f32_16x16x32_bf16 v[72:75], v[144:147], v[104:107], v[72:75]
    s_waitcnt vmcnt(14)
    s_barrier
    ds_read_b64_tr_b16 v[144:145], v149 offset:18592
    ds_read_b64_tr_b16 v[146:147], v149 offset:20896
    s_waitcnt lgkmcnt(10)
    v_mfma_f32_16x16x32_bf16 v[4:7], v[124:127], v[108:111], v[4:7]
    v_mfma_f32_16x16x32_bf16 v[8:11], v[124:127], v[112:115], v[8:11]
    s_add_u32 s52, s32, 331776
    s_cmp_ge_u32 s28, 2
    s_cbranch_scc1 L_k4_kernel_sk9
    s_add_u32 m0, s38, 55296
    s_nop 0
    buffer_load_dwordx4 v152, s[12:15], s52 offen lds
L_k4_kernel_sk9:
    s_add_u32 m0, s36, 55296
    s_nop 0
    buffer_load_dwordx4 v150, s[12:15], s52 offen lds
    ds_read_b64_tr_b16 v[124:125], v149 offset:18624
    ds_read_b64_tr_b16 v[126:127], v149 offset:20928
    s_waitcnt lgkmcnt(10)
    v_mfma_f32_16x16x32_bf16 v[12:15], v[128:131], v[108:111], v[12:15]
    v_mfma_f32_16x16x32_bf16 v[16:19], v[128:131], v[112:115], v[16:19]
    ds_read_b64_tr_b16 v[128:129], v149 offset:18656
    ds_read_b64_tr_b16 v[130:131], v149 offset:20960
    s_waitcnt lgkmcnt(10)
    v_mfma_f32_16x16x32_bf16 v[20:23], v[132:135], v[108:111], v[20:23]
    v_mfma_f32_16x16x32_bf16 v[24:27], v[132:135], v[112:115], v[24:27]
    s_add_u32 m0, s37, 55296
    s_nop 0
    buffer_load_dwordx4 v151, s[12:15], s52 offen lds
    ds_read_b64_tr_b16 v[132:133], v149 offset:18688
    ds_read_b64_tr_b16 v[134:135], v149 offset:20992
    s_waitcnt lgkmcnt(10)
    v_mfma_f32_16x16x32_bf16 v[28:31], v[136:139], v[108:111], v[28:31]
    v_mfma_f32_16x16x32_bf16 v[32:35], v[136:139], v[112:115], v[32:35]
    ds_read_b64_tr_b16 v[136:137], v149 offset:36864
    ds_read_b64_tr_b16 v[138:139], v149 offset:39168
    s_waitcnt lgkmcnt(10)
    v_mfma_f32_16x16x32_bf16 v[36:39], v[140:143], v[108:111], v[36:39]
    v_mfma_f32_16x16x32_bf16 v[40:43], v[140:143], v[112:115], v[40:43]
    s_mov_b32 s53, 9216
    buffer_load_dwordx4 v[100:103], v156, s[16:19], s53 offen
    ds_read_b64_tr_b16 v[140:141], v149 offset:36896
    ds_read_b64_tr_b16 v[142:143], v149 offset:39200
    s_waitcnt lgkmcnt(10)
    v_mfma_f32_16x16x32_bf16 v[44:47], v[144:147], v[108:111], v[44:47]
    v_mfma_f32_16x16x32_bf16 v[48:51], v[144:147], v[112:115], v[48:51]
    ds_read_b64_tr_b16 v[144:145], v149 offset:36928
    ds_read_b64_tr_b16 v[146:147], v149 offset:39232
    s_waitcnt lgkmcnt(10)
    v_mfma_f32_16x16x32_bf16 v[52:55], v[124:127], v[108:111], v[52:55]
    v_mfma_f32_16x16x32_bf16 v[56:59], v[124:127], v[112:115], v[56:59]
    buffer_load_dwordx4 v[104:107], v157, s[16:19], s53 offen
    ds_read_b64_tr_b16 v[124:125], v149 offset:36960
    ds_read_b64_tr_b16 v[126:127], v149 offset:39264
    s_waitcnt lgkmcnt(10)
    v_mfma_f32_16x16x32_bf16 v[60:63], v[128:131], v[108:111], v[60:63]
    v_mfma_f32_16x16x32_bf16 v[64:67], v[128:131], v[112:115], v[64:67]
    ds_read_b64_tr_b16 v[128:129], v149 offset:36992
    ds_read_b64_tr_b16 v[130:131], v149 offset:39296
    s_waitcnt lgkmcnt(10)
    v_mfma_f32_16x16x32_bf16 v[68:71], v[132:135], v[108:111], v[68:71]
    v_mfma_f32_16x16x32_bf16 v[72:75], v[132:135], v[112:115], v[72:75]
    s_waitcnt vmcnt(14)
    s_barrier
    ds_read_b64_tr_b16 v[132:133], v149 offset:37024
    ds_read_b64_tr_b16 v[134:135], v149 offset:39328
    s_waitcnt lgkmcnt(10)
    v_mfma_f32_16x16x32_bf16 v[4:7], v[136:139], v[116:119], v[4:7]
    v_mfma_f32_16x16x32_bf16 v[8:11], v[136:139], v[120:123], v[8:11]
    s_add_u32 s52, s32, 368640
    s_cmp_ge_u32 s28, 2
    s_cbranch_scc1 L_k4_kernel_sk10
    s_add_u32 m0, s38, 73728
    s_nop 0
    buffer_load_dwordx4 v152, s[12:15], s52 offen lds
L_k4_kernel_sk10:
    s_add_u32 m0, s36, 73728
    s_nop 0
    buffer_load_dwordx4 v150, s[12:15], s52 offen lds
    ds_read_b64_tr_b16 v[136:137], v149 offset:37056
    ds_read_b64_tr_b16 v[138:139], v149 offset:39360
    s_waitcnt lgkmcnt(10)
    v_mfma_f32_16x16x32_bf16 v[12:15], v[140:143], v[116:119], v[12:15]
    v_mfma_f32_16x16x32_bf16 v[16:19], v[140:143], v[120:123], v[16:19]
    ds_read_b64_tr_b16 v[140:141], v149 offset:37088
    ds_read_b64_tr_b16 v[142:143], v149 offset:39392
    s_waitcnt lgkmcnt(10)
    v_mfma_f32_16x16x32_bf16 v[20:23], v[144:147], v[116:119], v[20:23]
    v_mfma_f32_16x16x32_bf16 v[24:27], v[144:147], v[120:123], v[24:27]
    s_add_u32 m0, s37, 73728
    s_nop 0
    buffer_load_dwordx4 v151, s[12:15], s52 offen lds
    ds_read_b64_tr_b16 v[144:145], v149 offset:37120
    ds_read_b64_tr_b16 v[146:147], v149 offset:39424
    s_waitcnt lgkmcnt(10)
    v_mfma_f32_16x16x32_bf16 v[28:31], v[124:127], v[116:119], v[28:31]
    v_mfma_f32_16x16x32_bf16 v[32:35], v[124:127], v[120:123], v[32:35]
    ds_read_b64_tr_b16 v[124:125], v148 offset:0
    ds_read_b64_tr_b16 v[126:127], v148 offset:2304
    s_waitcnt lgkmcnt(10)
    v_mfma_f32_16x16x32_bf16 v[36:39], v[128:131], v[116:119], v[36:39]
    v_mfma_f32_16x16x32_bf16 v[40:43], v[128:131], v[120:123], v[40:43]
    s_mov_b32 s53, 10240
    buffer_load_dwordx4 v[108:111], v156, s[16:19], s53 offen
    ds_read_b64_tr_b16 v[128:129], v148 offset:32
    ds_read_b64_tr_b16 v[130:131], v148 offset:2336
    s_waitcnt lgkmcnt(10)
    v_mfma_f32_16x16x32_bf16 v[44:47], v[132:135], v[116:119], v[44:47]
    v_mfma_f32_16x16x32_bf16 v[48:51], v[132:135], v[120:123], v[48:51]
    ds_read_b64_tr_b16 v[132:133], v148 offset:64
    ds_read_b64_tr_b16 v[134:135], v148 offset:2368
    s_waitcnt lgkmcnt(10)
    v_mfma_f32_16x16x32_bf16 v[52:55], v[136:139], v[116:119], v[52:55]
    v_mfma_f32_16x16x32_bf16 v[56:59], v[136:139], v[120:123], v[56:59]
    buffer_load_dwordx4 v[112:115], v157, s[16:19], s53 offen
    ds_read_b64_tr_b16 v[136:137], v148 offset:96
    ds_read_b64_tr_b16 v[138:139], v148 offset:2400
    s_waitcnt lgkmcnt(10)
    v_mfma_f32_16x16x32_bf16 v[60:63], v[140:143], v[116:119], v[60:63]
    v_mfma_f32_16x16x32_bf16 v[64:67], v[140:143], v[120:123], v[64:67]
    ds_read_b64_tr_b16 v[140:141], v148 offset:128
    ds_read_b64_tr_b16 v[142:143], v148 offset:2432
    s_waitcnt lgkmcnt(10)
    v_mfma_f32_16x16x32_bf16 v[68:71], v[144:147], v[116:119], v[68:71]
    v_mfma_f32_16x16x32_bf16 v[72:75], v[144:147], v[120:123], v[72:75]
    s_waitcnt vmcnt(14)
    s_barrier
    ds_read_b64_tr_b16 v[144:145], v148 offset:160
    ds_read_b64_tr_b16 v[146:147], v148 offset:2464
    s_waitcnt lgkmcnt(10)
    v_mfma_f32_16x16x32_bf16 v[4:7], v[124:127], v[76:79], v[4:7]
    v_mfma_f32_16x16x32_bf16 v[8:11], v[124:127], v[80:83], v[8:11]
    s_add_u32 s52, s32, 405504
    s_cmp_ge_u32 s28, 2
    s_cbranch_scc1 L_k4_kernel_sk11
    s_add_u32 m0, s38, 92160
    s_nop 0
    buffer_load_dwordx4 v152, s[12:15], s52 offen lds
L_k4_kernel_sk11:
    s_add_u32 m0, s36, 92160
    s_nop 0
    buffer_load_dwordx4 v150, s[12:15], s52 offen lds
    ds_read_b64_tr_b16 v[124:125], v148 offset:192
    ds_read_b64_tr_b16 v[126:127], v148 offset:2496
    s_waitcnt lgkmcnt(10)
    v_mfma_f32_16x16x32_bf16 v[12:15], v[128:131], v[76:79], v[12:15]
    v_mfma_f32_16x16x32_bf16 v[16:19], v[128:131], v[80:83], v[16:19]
    ds_read_b64_tr_b16 v[128:129], v148 offset:224
    ds_read_b64_tr_b16 v[130:131], v148 offset:2528
    s_waitcnt lgkmcnt(10)
    v_mfma_f32_16x16x32_bf16 v[20:23], v[132:135], v[76:79], v[20:23]
    v_mfma_f32_16x16x32_bf16 v[24:27], v[132:135], v[80:83], v[24:27]
    s_add_u32 m0, s37, 92160
    s_nop 0
    buffer_load_dwordx4 v151, s[12:15], s52 offen lds
    ds_read_b64_tr_b16 v[132:133], v148 offset:256
    ds_read_b64_tr_b16 v[134:135], v148 offset:2560
    s_waitcnt lgkmcnt(10)
    v_mfma_f32_16x16x32_bf16 v[28:31], v[136:139], v[76:79], v[28:31]
    v_mfma_f32_16x16x32_bf16 v[32:35], v[136:139], v[80:83], v[32:35]
    ds_read_b64_tr_b16 v[136:137], v148 offset:18432
    ds_read_b64_tr_b16 v[138:139], v148 offset:20736
    s_waitcnt lgkmcnt(10)
    v_mfma_f32_16x16x32_bf16 v[36:39], v[140:143], v[76:79], v[36:39]
    v_mfma_f32_16x16x32_bf16 v[40:43], v[140:143], v[80:83], v[40:43]
    s_mov_b32 s53, 11264
    buffer_load_dwordx4 v[116:119], v156, s[16:19], s53 offen
    ds_read_b64_tr_b16 v[140:141], v148 offset:18464
    ds_read_b64_tr_b16 v[142:143], v148 offset:20768
    s_waitcnt lgkmcnt(10)
    v_mfma_f32_16x16x32_bf16 v[44:47], v[144:147], v[76:79], v[44:47]
    v_mfma_f32_16x16x32_bf16 v[48:51], v[144:147], v[80:83], v[48:51]
    ds_read_b64_tr_b16 v[144:145], v148 offset:18496
    ds_read_b64_tr_b16 v[146:147], v148 offset:20800
    s_waitcnt lgkmcnt(10)
    v_mfma_f32_16x16x32_bf16 v[52:55], v[124:127], v[76:79], v[52:55]
    v_mfma_f32_16x16x32_bf16 v[56:59], v[124:127], v[80:83], v[56:59]
    buffer_load_dwordx4 v[120:123], v157, s[16:19], s53 offen
    ds_read_b64_tr_b16 v[124:125], v148 offset:18528
    ds_read_b64_tr_b16 v[126:127], v148 offset:20832
    s_waitcnt lgkmcnt(10)
    v_mfma_f32_16x16x32_bf16 v[60:63], v[128:131], v[76:79], v[60:63]
    v_mfma_f32_16x16x32_bf16 v[64:67], v[128:131], v[80:83], v[64:67]
    ds_read_b64_tr_b16 v[128:129], v148 offset:18560
    ds_read_b64_tr_b16 v[130:131], v148 offset:20864
    s_waitcnt lgkmcnt(10)
    v_mfma_f32_16x16x32_bf16 v[68:71], v[132:135], v[76:79], v[68:71]
    v_mfma_f32_16x16x32_bf16 v[72:75], v[132:135], v[80:83], v[72:75]
    s_waitcnt vmcnt(14)
    s_barrier
    ds_read_b64_tr_b16 v[132:133], v148 offset:18592
    ds_read_b64_tr_b16 v[134:135], v148 offset:20896
    s_waitcnt lgkmcnt(10)
    v_mfma_f32_16x16x32_bf16 v[4:7], v[136:139], v[84:87], v[4:7]
    v_mfma_f32_16x16x32_bf16 v[8:11], v[136:139], v[88:91], v[8:11]
    s_add_u32 s52, s32, 442368
    s_cmp_ge_u32 s28, 2
    s_cbranch_scc1 L_k4_kernel_sk12
    s_add_u32 m0, s38, 0
    s_nop 0
    buffer_load_dwordx4 v152, s[12:15], s52 offen lds
L_k4_kernel_sk12:
    s_add_u32 m0, s36, 0
    s_nop 0
    buffer_load_dwordx4 v150, s[12:15], s52 offen lds
    ds_read_b64_tr_b16 v[136:137], v148 offset:18624
    ds_read_b64_tr_b16 v[138:139], v148 offset:20928
    s_waitcnt lgkmcnt(10)
    v_mfma_f32_16x16x32_bf16 v[12:15], v[140:143], v[84:87], v[12:15]
    v_mfma_f32_16x16x32_bf16 v[16:19], v[140:143], v[88:91], v[16:19]
    ds_read_b64_tr_b16 v[140:141], v148 offset:18656
    ds_read_b64_tr_b16 v[142:143], v148 offset:20960
    s_waitcnt lgkmcnt(10)
    v_mfma_f32_16x16x32_bf16 v[20:23], v[144:147], v[84:87], v[20:23]
    v_mfma_f32_16x16x32_bf16 v[24:27], v[144:147], v[88:91], v[24:27]
    s_add_u32 m0, s37, 0
    s_nop 0
    buffer_load_dwordx4 v151, s[12:15], s52 offen lds
    ds_read_b64_tr_b16 v[144:145], v148 offset:18688
    ds_read_b64_tr_b16 v[146:147], v148 offset:20992
    s_waitcnt lgkmcnt(10)
    v_mfma_f32_16x16x32_bf16 v[28:31], v[124:127], v[84:87], v[28:31]
    v_mfma_f32_16x16x32_bf16 v[32:35], v[124:127], v[88:91], v[32:35]
    ds_read_b64_tr_b16 v[124:125], v148 offset:36864
    ds_read_b64_tr_b16 v[126:127], v148 offset:39168
    s_waitcnt lgkmcnt(10)
    v_mfma_f32_16x16x32_bf16 v[36:39], v[128:131], v[84:87], v[36:39]
    v_mfma_f32_16x16x32_bf16 v[40:43], v[128:131], v[88:91], v[40:43]
    s_mov_b32 s53, 12288
    buffer_load_dwordx4 v[76:79], v156, s[16:19], s53 offen
    ds_read_b64_tr_b16 v[128:129], v148 offset:36896
    ds_read_b64_tr_b16 v[130:131], v148 offset:39200
    s_waitcnt lgkmcnt(10)
    v_mfma_f32_16x16x32_bf16 v[44:47], v[132:135], v[84:87], v[44:47]
    v_mfma_f32_16x16x32_bf16 v[48:51], v[132:135], v[88:91], v[48:51]
    ds_read_b64_tr_b16 v[132:133], v148 offset:36928
    ds_read_b64_tr_b16 v[134:135], v148 offset:39232
    s_waitcnt lgkmcnt(10)
    v_mfma_f32_16x16x32_bf16 v[52:55], v[136:139], v[84:87], v[52:55]
    v_mfma_f32_16x16x32_bf16 v[56:59], v[136:139], v[88:91], v[56:59]
    buffer_load_dwordx4 v[80:83], v157, s[16:19], s53 offen
    ds_read_b64_tr_b16 v[136:137], v148 offset:36960
    ds_read_b64_tr_b16 v[138:139], v148 offset:39264
    s_waitcnt lgkmcnt(10)
    v_mfma_f32_16x16x32_bf16 v[60:63], v[140:143], v[84:87], v[60:63]
    v_mfma_f32_16x16x32_bf16 v[64:67], v[140:143], v[88:91], v[64:67]
    ds_read_b64_tr_b16 v[140:141], v148 offset:36992
    ds_read_b64_tr_b16 v[142:143], v148 offset:39296
    s_waitcnt lgkmcnt(10)
    v_mfma_f32_16x16x32_bf16 v[68:71], v[144:147], v[84:87], v[68:71]
    v_mfma_f32_16x16x32_bf16 v[72:75], v[144:147], v[88:91], v[72:75]
    s_waitcnt vmcnt(14)
    s_barrier
    ds_read_b64_tr_b16 v[144:145], v148 offset:37024
    ds_read_b64_tr_b16 v[146:147], v148 offset:39328
    s_waitcnt lgkmcnt(10)
    v_mfma_f32_16x16x32_bf16 v[4:7], v[124:127], v[92:95], v[4:7]
    v_mfma_f32_16x16x32_bf16 v[8:11], v[124:127], v[96:99], v[8:11]
    s_add_u32 s52, s32, 497664
    s_cmp_ge_u32 s28, 2
    s_cbranch_scc1 L_k4_kernel_sk13
    s_add_u32 m0, s38, 18432
    s_nop 0
    buffer_load_dwordx4 v152, s[12:15], s52 offen lds
L_k4_kernel_sk13:
    s_add_u32 m0, s36, 18432
    s_nop 0
    buffer_load_dwordx4 v150, s[12:15], s52 offen lds
    ds_read_b64_tr_b16 v[124:125], v148 offset:37056
    ds_read_b64_tr_b16 v[126:127], v148 offset:39360
    s_waitcnt lgkmcnt(10)
    v_mfma_f32_16x16x32_bf16 v[12:15], v[128:131], v[92:95], v[12:15]
    v_mfma_f32_16x16x32_bf16 v[16:19], v[128:131], v[96:99], v[16:19]
    ds_read_b64_tr_b16 v[128:129], v148 offset:37088
    ds_read_b64_tr_b16 v[130:131], v148 offset:39392
    s_waitcnt lgkmcnt(10)
    v_mfma_f32_16x16x32_bf16 v[20:23], v[132:135], v[92:95], v[20:23]
    v_mfma_f32_16x16x32_bf16 v[24:27], v[132:135], v[96:99], v[24:27]
    s_add_u32 m0, s37, 18432
    s_nop 0
    buffer_load_dwordx4 v151, s[12:15], s52 offen lds
    ds_read_b64_tr_b16 v[132:133], v148 offset:37120
    ds_read_b64_tr_b16 v[134:135], v148 offset:39424
    s_waitcnt lgkmcnt(10)
    v_mfma_f32_16x16x32_bf16 v[28:31], v[136:139], v[92:95], v[28:31]
    v_mfma_f32_16x16x32_bf16 v[32:35], v[136:139], v[96:99], v[32:35]
    ds_read_b64_tr_b16 v[136:137], v149 offset:0
    ds_read_b64_tr_b16 v[138:139], v149 offset:2304
    s_waitcnt lgkmcnt(10)
    v_mfma_f32_16x16x32_bf16 v[36:39], v[140:143], v[92:95], v[36:39]
    v_mfma_f32_16x16x32_bf16 v[40:43], v[140:143], v[96:99], v[40:43]
    s_mov_b32 s53, 13312
    buffer_load_dwordx4 v[84:87], v156, s[16:19], s53 offen
    ds_read_b64_tr_b16 v[140:141], v149 offset:32
    ds_read_b64_tr_b16 v[142:143], v149 offset:2336
    s_waitcnt lgkmcnt(10)
    v_mfma_f32_16x16x32_bf16 v[44:47], v[144:147], v[92:95], v[44:47]
    v_mfma_f32_16x16x32_bf16 v[48:51], v[144:147], v[96:99], v[48:51]
    ds_read_b64_tr_b16 v[144:145], v149 offset:64
    ds_read_b64_tr_b16 v[146:147], v149 offset:2368
    s_waitcnt lgkmcnt(10)
    v_mfma_f32_16x16x32_bf16 v[52:55], v[124:127], v[92:95], v[52:55]
    v_mfma_f32_16x16x32_bf16 v[56:59], v[124:127], v[96:99], v[56:59]
    buffer_load_dwordx4 v[88:91], v157, s[16:19], s53 offen
    ds_read_b64_tr_b16 v[124:125], v149 offset:96
    ds_read_b64_tr_b16 v[126:127], v149 offset:2400
    s_waitcnt lgkmcnt(10)
    v_mfma_f32_16x16x32_bf16 v[60:63], v[128:131], v[92:95], v[60:63]
    v_mfma_f32_16x16x32_bf16 v[64:67], v[128:131], v[96:99], v[64:67]
    ds_read_b64_tr_b16 v[128:129], v149 offset:128
    ds_read_b64_tr_b16 v[130:131], v149 offset:2432
    s_waitcnt lgkmcnt(10)
    v_mfma_f32_16x16x32_bf16 v[68:71], v[132:135], v[92:95], v[68:71]
    v_mfma_f32_16x16x32_bf16 v[72:75], v[132:135], v[96:99], v[72:75]
    s_waitcnt vmcnt(14)
    s_barrier
    ds_read_b64_tr_b16 v[132:133], v149 offset:160
    ds_read_b64_tr_b16 v[134:135], v149 offset:2464
    s_waitcnt lgkmcnt(10)
    v_mfma_f32_16x16x32_bf16 v[4:7], v[136:139], v[100:103], v[4:7]
    v_mfma_f32_16x16x32_bf16 v[8:11], v[136:139], v[104:107], v[8:11]
    s_add_u32 s52, s32, 534528
    s_cmp_ge_u32 s28, 2
    s_cbranch_scc1 L_k4_kernel_sk14
    s_add_u32 m0, s38, 36864
    s_nop 0
    buffer_load_dwordx4 v152, s[12:15], s52 offen lds
L_k4_kernel_sk14:
    s_add_u32 m0, s36, 36864
    s_nop 0
    buffer_load_dwordx4 v150, s[12:15], s52 offen lds
    ds_read_b64_tr_b16 v[136:137], v149 offset:192
    ds_read_b64_tr_b16 v[138:139], v149 offset:2496
    s_waitcnt lgkmcnt(10)
    v_mfma_f32_16x16x32_bf16 v[12:15], v[140:143], v[100:103], v[12:15]
    v_mfma_f32_16x16x32_bf16 v[16:19], v[140:143], v[104:107], v[16:19]
    ds_read_b64_tr_b16 v[140:141], v149 offset:224
    ds_read_b64_tr_b16 v[142:143], v149 offset:2528
    s_waitcnt lgkmcnt(10)
    v_mfma_f32_16x16x32_bf16 v[20:23], v[144:147], v[100:103], v[20:23]
    v_mfma_f32_16x16x32_bf16 v[24:27], v[144:147], v[104:107], v[24:27]
    s_add_u32 m0, s37, 36864
    s_nop 0
    buffer_load_dwordx4 v151, s[12:15], s52 offen lds
    ds_read_b64_tr_b16 v[144:145], v149 offset:256
    ds_read_b64_tr_b16 v[146:147], v149 offset:2560
    s_waitcnt lgkmcnt(10)
    v_mfma_f32_16x16x32_bf16 v[28:31], v[124:127], v[100:103], v[28:31]
    v_mfma_f32_16x16x32_bf16 v[32:35], v[124:127], v[104:107], v[32:35]
    ds_read_b64_tr_b16 v[124:125], v149 offset:18432
    ds_read_b64_tr_b16 v[126:127], v149 offset:20736
    s_waitcnt lgkmcnt(10)
    v_mfma_f32_16x16x32_bf16 v[36:39], v[128:131], v[100:103], v[36:39]
    v_mfma_f32_16x16x32_bf16 v[40:43], v[128:131], v[104:107], v[40:43]
    s_mov_b32 s53, 14336
    buffer_load_dwordx4 v[92:95], v156, s[16:19], s53 offen
    ds_read_b64_tr_b16 v[128:129], v149 offset:18464
    ds_read_b64_tr_b16 v[130:131], v149 offset:20768
    s_waitcnt lgkmcnt(10)
    v_mfma_f32_16x16x32_bf16 v[44:47], v[132:135], v[100:103], v[44:47]
    v_mfma_f32_16x16x32_bf16 v[48:51], v[132:135], v[104:107], v[48:51]
    ds_read_b64_tr_b16 v[132:133], v149 offset:18496
    ds_read_b64_tr_b16 v[134:135], v149 offset:20800
    s_waitcnt lgkmcnt(10)
    v_mfma_f32_16x16x32_bf16 v[52:55], v[136:139], v[100:103], v[52:55]
    v_mfma_f32_16x16x32_bf16 v[56:59], v[136:139], v[104:107], v[56:59]
    buffer_load_dwordx4 v[96:99], v157, s[16:19], s53 offen
    ds_read_b64_tr_b16 v[136:137], v149 offset:18528
    ds_read_b64_tr_b16 v[138:139], v149 offset:20832
    s_waitcnt lgkmcnt(10)
    v_mfma_f32_16x16x32_bf16 v[60:63], v[140:143], v[100:103], v[60:63]
    v_mfma_f32_16x16x32_bf16 v[64:67], v[140:143], v[104:107], v[64:67]
    ds_read_b64_tr_b16 v[140:141], v149 offset:18560
    ds_read_b64_tr_b16 v[142:143], v149 offset:20864
    s_waitcnt lgkmcnt(10)
    v_mfma_f32_16x16x32_bf16 v[68:71], v[144:147], v[100:103], v[68:71]
    v_mfma_f32_16x16x32_bf16 v[72:75], v[144:147], v[104:107], v[72:75]
    s_waitcnt vmcnt(14)
    s_barrier
    ds_read_b64_tr_b16 v[144:145], v149 offset:18592
    ds_read_b64_tr_b16 v[146:147], v149 offset:20896
    s_waitcnt lgkmcnt(10)
    v_mfma_f32_16x16x32_bf16 v[4:7], v[124:127], v[108:111], v[4:7]
    v_mfma_f32_16x16x32_bf16 v[8:11], v[124:127], v[112:115], v[8:11]
    s_add_u32 s52, s32, 571392
    s_cmp_ge_u32 s28, 2
    s_cbranch_scc1 L_k4_kernel_sk15
    s_add_u32 m0, s38, 55296
    s_nop 0
    buffer_load_dwordx4 v152, s[12:15], s52 offen lds
L_k4_kernel_sk15:
    s_add_u32 m0, s36, 55296
    s_nop 0
    buffer_load_dwordx4 v150, s[12:15], s52 offen lds
    ds_read_b64_tr_b16 v[124:125], v149 offset:18624
    ds_read_b64_tr_b16 v[126:127], v149 offset:20928
    s_waitcnt lgkmcnt(10)
    v_mfma_f32_16x16x32_bf16 v[12:15], v[128:131], v[108:111], v[12:15]
    v_mfma_f32_16x16x32_bf16 v[16:19], v[128:131], v[112:115], v[16:19]
    ds_read_b64_tr_b16 v[128:129], v149 offset:18656
    ds_read_b64_tr_b16 v[130:131], v149 offset:20960
    s_waitcnt lgkmcnt(10)
    v_mfma_f32_16x16x32_bf16 v[20:23], v[132:135], v[108:111], v[20:23]
    v_mfma_f32_16x16x32_bf16 v[24:27], v[132:135], v[112:115], v[24:27]
    s_add_u32 m0, s37, 55296
    s_nop 0
    buffer_load_dwordx4 v151, s[12:15], s52 offen lds
    ds_read_b64_tr_b16 v[132:133], v149 offset:18688
    ds_read_b64_tr_b16 v[134:135], v149 offset:20992
    s_waitcnt lgkmcnt(10)
    v_mfma_f32_16x16x32_bf16 v[28:31], v[136:139], v[108:111], v[28:31]
    v_mfma_f32_16x16x32_bf16 v[32:35], v[136:139], v[112:115], v[32:35]
    ds_read_b64_tr_b16 v[136:137], v149 offset:36864
    ds_read_b64_tr_b16 v[138:139], v149 offset:39168
    s_waitcnt lgkmcnt(10)
    v_mfma_f32_16x16x32_bf16 v[36:39], v[140:143], v[108:111], v[36:39]
    v_mfma_f32_16x16x32_bf16 v[40:43], v[140:143], v[112:115], v[40:43]
    s_mov_b32 s53, 15360
    buffer_load_dwordx4 v[100:103], v156, s[16:19], s53 offen
    ds_read_b64_tr_b16 v[140:141], v149 offset:36896
    ds_read_b64_tr_b16 v[142:143], v149 offset:39200
    s_waitcnt lgkmcnt(10)
    v_mfma_f32_16x16x32_bf16 v[44:47], v[144:147], v[108:111], v[44:47]
    v_mfma_f32_16x16x32_bf16 v[48:51], v[144:147], v[112:115], v[48:51]
    ds_read_b64_tr_b16 v[144:145], v149 offset:36928
    ds_read_b64_tr_b16 v[146:147], v149 offset:39232
    s_waitcnt lgkmcnt(10)
    v_mfma_f32_16x16x32_bf16 v[52:55], v[124:127], v[108:111], v[52:55]
    v_mfma_f32_16x16x32_bf16 v[56:59], v[124:127], v[112:115], v[56:59]
    buffer_load_dwordx4 v[104:107], v157, s[16:19], s53 offen
    ds_read_b64_tr_b16 v[124:125], v149 offset:36960
    ds_read_b64_tr_b16 v[126:127], v149 offset:39264
    s_waitcnt lgkmcnt(10)
    v_mfma_f32_16x16x32_bf16 v[60:63], v[128:131], v[108:111], v[60:63]
    v_mfma_f32_16x16x32_bf16 v[64:67], v[128:131], v[112:115], v[64:67]
    ds_read_b64_tr_b16 v[128:129], v149 offset:36992
    ds_read_b64_tr_b16 v[130:131], v149 offset:39296
    s_waitcnt lgkmcnt(10)
    v_mfma_f32_16x16x32_bf16 v[68:71], v[132:135], v[108:111], v[68:71]
    v_mfma_f32_16x16x32_bf16 v[72:75], v[132:135], v[112:115], v[72:75]
    s_waitcnt vmcnt(14)
    s_barrier
    ds_read_b64_tr_b16 v[132:133], v149 offset:37024
    ds_read_b64_tr_b16 v[134:135], v149 offset:39328
    s_waitcnt lgkmcnt(10)
    v_mfma_f32_16x16x32_bf16 v[4:7], v[136:139], v[116:119], v[4:7]
    v_mfma_f32_16x16x32_bf16 v[8:11], v[136:139], v[120:123], v[8:11]
    s_add_u32 s52, s32, 608256
    s_cmp_ge_u32 s28, 2
    s_cbranch_scc1 L_k4_kernel_sk16
    s_add_u32 m0, s38, 73728
    s_nop 0
    buffer_load_dwordx4 v152, s[12:15], s52 offen lds
L_k4_kernel_sk16:
    s_add_u32 m0, s36, 73728
    s_nop 0
    buffer_load_dwordx4 v150, s[12:15], s52 offen lds
    ds_read_b64_tr_b16 v[136:137], v149 offset:37056
    ds_read_b64_tr_b16 v[138:139], v149 offset:39360
    s_waitcnt lgkmcnt(10)
    v_mfma_f32_16x16x32_bf16 v[12:15], v[140:143], v[116:119], v[12:15]
    v_mfma_f32_16x16x32_bf16 v[16:19], v[140:143], v[120:123], v[16:19]
    ds_read_b64_tr_b16 v[140:141], v149 offset:37088
    ds_read_b64_tr_b16 v[142:143], v149 offset:39392
    s_waitcnt lgkmcnt(10)
    v_mfma_f32_16x16x32_bf16 v[20:23], v[144:147], v[116:119], v[20:23]
    v_mfma_f32_16x16x32_bf16 v[24:27], v[144:147], v[120:123], v[24:27]
    s_add_u32 m0, s37, 73728
    s_nop 0
    buffer_load_dwordx4 v151, s[12:15], s52 offen lds
    ds_read_b64_tr_b16 v[144:145], v149 offset:37120
    ds_read_b64_tr_b16 v[146:147], v149 offset:39424
    s_waitcnt lgkmcnt(10)
    v_mfma_f32_16x16x32_bf16 v[28:31], v[124:127], v[116:119], v[28:31]
    v_mfma_f32_16x16x32_bf16 v[32:35], v[124:127], v[120:123], v[32:35]
    ds_read_b64_tr_b16 v[124:125], v148 offset:0
    ds_read_b64_tr_b16 v[126:127], v148 offset:2304
    s_waitcnt lgkmcnt(10)
    v_mfma_f32_16x16x32_bf16 v[36:39], v[128:131], v[116:119], v[36:39]
    v_mfma_f32_16x16x32_bf16 v[40:43], v[128:131], v[120:123], v[40:43]
    s_mov_b32 s53, 16384
    buffer_load_dwordx4 v[108:111], v156, s[16:19], s53 offen
    ds_read_b64_tr_b16 v[128:129], v148 offset:32
    ds_read_b64_tr_b16 v[130:131], v148 offset:2336
    s_waitcnt lgkmcnt(10)
    v_mfma_f32_16x16x32_bf16 v[44:47], v[132:135], v[116:119], v[44:47]
    v_mfma_f32_16x16x32_bf16 v[48:51], v[132:135], v[120:123], v[48:51]
    ds_read_b64_tr_b16 v[132:133], v148 offset:64
    ds_read_b64_tr_b16 v[134:135], v148 offset:2368
    s_waitcnt lgkmcnt(10)
    v_mfma_f32_16x16x32_bf16 v[52:55], v[136:139], v[116:119], v[52:55]
    v_mfma_f32_16x16x32_bf16 v[56:59], v[136:139], v[120:123], v[56:59]
    buffer_load_dwordx4 v[112:115], v157, s[16:19], s53 offen
    ds_read_b64_tr_b16 v[136:137], v148 offset:96
    ds_read_b64_tr_b16 v[138:139], v148 offset:2400
    s_waitcnt lgkmcnt(10)
    v_mfma_f32_16x16x32_bf16 v[60:63], v[140:143], v[116:119], v[60:63]
    v_mfma_f32_16x16x32_bf16 v[64:67], v[140:143], v[120:123], v[64:67]
    ds_read_b64_tr_b16 v[140:141], v148 offset:128
    ds_read_b64_tr_b16 v[142:143], v148 offset:2432
    s_waitcnt lgkmcnt(10)
    v_mfma_f32_16x16x32_bf16 v[68:71], v[144:147], v[116:119], v[68:71]
    v_mfma_f32_16x16x32_bf16 v[72:75], v[144:147], v[120:123], v[72:75]
    s_waitcnt vmcnt(14)
    s_barrier
    ds_read_b64_tr_b16 v[144:145], v148 offset:160
    ds_read_b64_tr_b16 v[146:147], v148 offset:2464
    s_waitcnt lgkmcnt(10)
    v_mfma_f32_16x16x32_bf16 v[4:7], v[124:127], v[76:79], v[4:7]
    v_mfma_f32_16x16x32_bf16 v[8:11], v[124:127], v[80:83], v[8:11]
    s_add_u32 s52, s32, 479232
    s_cmp_ge_u32 s28, 2
    s_cbranch_scc1 L_k4_kernel_sk17
    s_add_u32 m0, s38, 92160
    s_nop 0
    buffer_load_dwordx4 v155, s[12:15], s52 offen lds
L_k4_kernel_sk17:
    s_add_u32 m0, s36, 92160
    s_nop 0
    buffer_load_dwordx4 v153, s[12:15], s52 offen lds
    ds_read_b64_tr_b16 v[124:125], v148 offset:192
    ds_read_b64_tr_b16 v[126:127], v148 offset:2496
    s_waitcnt lgkmcnt(10)
    v_mfma_f32_16x16x32_bf16 v[12:15], v[128:131], v[76:79], v[12:15]
    v_mfma_f32_16x16x32_bf16 v[16:19], v[128:131], v[80:83], v[16:19]
    ds_read_b64_tr_b16 v[128:129], v148 offset:224
    ds_read_b64_tr_b16 v[130:131], v148 offset:2528
    s_waitcnt lgkmcnt(10)
    v_mfma_f32_16x16x32_bf16 v[20:23], v[132:135], v[76:79], v[20:23]
    v_mfma_f32_16x16x32_bf16 v[24:27], v[132:135], v[80:83], v[24:27]
    s_add_u32 m0, s37, 92160
    s_nop 0
    buffer_load_dwordx4 v154, s[12:15], s52 offen lds
    ds_read_b64_tr_b16 v[132:133], v148 offset:256
    ds_read_b64_tr_b16 v[134:135], v148 offset:2560
    s_waitcnt lgkmcnt(10)
    v_mfma_f32_16x16x32_bf16 v[28:31], v[136:139], v[76:79], v[28:31]
    v_mfma_f32_16x16x32_bf16 v[32:35], v[136:139], v[80:83], v[32:35]
    ds_read_b64_tr_b16 v[136:137], v148 offset:18432
    ds_read_b64_tr_b16 v[138:139], v148 offset:20736
    s_waitcnt lgkmcnt(10)
    v_mfma_f32_16x16x32_bf16 v[36:39], v[140:143], v[76:79], v[36:39]
    v_mfma_f32_16x16x32_bf16 v[40:43], v[140:143], v[80:83], v[40:43]
    s_mov_b32 s53, 17408
    buffer_load_dwordx4 v[116:119], v156, s[16:19], s53 offen
    ds_read_b64_tr_b16 v[140:141], v148 offset:18464
    ds_read_b64_tr_b16 v[142:143], v148 offset:20768
    s_waitcnt lgkmcnt(10)
    v_mfma_f32_16x16x32_bf16 v[44:47], v[144:147], v[76:79], v[44:47]
    v_mfma_f32_16x16x32_bf16 v[48:51], v[144:147], v[80:83], v[48:51]
    ds_read_b64_tr_b16 v[144:145], v148 offset:18496
    ds_read_b64_tr_b16 v[146:147], v148 offset:20800
    s_waitcnt lgkmcnt(10)
    v_mfma_f32_16x16x32_bf16 v[52:55], v[124:127], v[76:79], v[52:55]
    v_mfma_f32_16x16x32_bf16 v[56:59], v[124:127], v[80:83], v[56:59]
    buffer_load_dwordx4 v[120:123], v157, s[16:19], s53 offen
    ds_read_b64_tr_b16 v[124:125], v148 offset:18528
    ds_read_b64_tr_b16 v[126:127], v148 offset:20832
    s_waitcnt lgkmcnt(10)
    v_mfma_f32_16x16x32_bf16 v[60:63], v[128:131], v[76:79], v[60:63]
    v_mfma_f32_16x16x32_bf16 v[64:67], v[128:131], v[80:83], v[64:67]
    ds_read_b64_tr_b16 v[128:129], v148 offset:18560
    ds_read_b64_tr_b16 v[130:131], v148 offset:20864
    s_waitcnt lgkmcnt(10)
    v_mfma_f32_16x16x32_bf16 v[68:71], v[132:135], v[76:79], v[68:71]
    v_mfma_f32_16x16x32_bf16 v[72:75], v[132:135], v[80:83], v[72:75]
    s_waitcnt vmcnt(14)
    s_barrier
    ds_read_b64_tr_b16 v[132:133], v148 offset:18592
    ds_read_b64_tr_b16 v[134:135], v148 offset:20896
    s_waitcnt lgkmcnt(10)
    v_mfma_f32_16x16x32_bf16 v[4:7], v[136:139], v[84:87], v[4:7]
    v_mfma_f32_16x16x32_bf16 v[8:11], v[136:139], v[88:91], v[8:11]
    ds_read_b64_tr_b16 v[136:137], v148 offset:18624
    ds_read_b64_tr_b16 v[138:139], v148 offset:20928
    s_waitcnt lgkmcnt(10)
    v_mfma_f32_16x16x32_bf16 v[12:15], v[140:143], v[84:87], v[12:15]
    v_mfma_f32_16x16x32_bf16 v[16:19], v[140:143], v[88:91], v[16:19]
    ds_read_b64_tr_b16 v[140:141], v148 offset:18656
    ds_read_b64_tr_b16 v[142:143], v148 offset:20960
    s_waitcnt lgkmcnt(10)
    v_mfma_f32_16x16x32_bf16 v[20:23], v[144:147], v[84:87], v[20:23]
    v_mfma_f32_16x16x32_bf16 v[24:27], v[144:147], v[88:91], v[24:27]
    ds_read_b64_tr_b16 v[144:145], v148 offset:18688
    ds_read_b64_tr_b16 v[146:147], v148 offset:20992
    s_waitcnt lgkmcnt(10)
    v_mfma_f32_16x16x32_bf16 v[28:31], v[124:127], v[84:87], v[28:31]
    v_mfma_f32_16x16x32_bf16 v[32:35], v[124:127], v[88:91], v[32:35]
    ds_read_b64_tr_b16 v[124:125], v148 offset:36864
    ds_read_b64_tr_b16 v[126:127], v148 offset:39168
    s_waitcnt lgkmcnt(10)
    v_mfma_f32_16x16x32_bf16 v[36:39], v[128:131], v[84:87], v[36:39]
    v_mfma_f32_16x16x32_bf16 v[40:43], v[128:131], v[88:91], v[40:43]
    ds_read_b64_tr_b16 v[128:129], v148 offset:36896
    ds_read_b64_tr_b16 v[130:131], v148 offset:39200
    s_waitcnt lgkmcnt(10)
    v_mfma_f32_16x16x32_bf16 v[44:47], v[132:135], v[84:87], v[44:47]
    v_mfma_f32_16x16x32_bf16 v[48:51], v[132:135], v[88:91], v[48:51]
    ds_read_b64_tr_b16 v[132:133], v148 offset:36928
    ds_read_b64_tr_b16 v[134:135], v148 offset:39232
    s_waitcnt lgkmcnt(10)
    v_mfma_f32_16x16x32_bf16 v[52:55], v[136:139], v[84:87], v[52:55]
    v_mfma_f32_16x16x32_bf16 v[56:59], v[136:139], v[88:91], v[56:59]
    ds_read_b64_tr_b16 v[136:137], v148 offset:36960
    ds_read_b64_tr_b16 v[138:139], v148 offset:39264
    s_waitcnt lgkmcnt(10)
    v_mfma_f32_16x16x32_bf16 v[60:63], v[140:143], v[84:87], v[60:63]
    v_mfma_f32_16x16x32_bf16 v[64:67], v[140:143], v[88:91], v[64:67]
    ds_read_b64_tr_b16 v[140:141], v148 offset:36992
    ds_read_b64_tr_b16 v[142:143], v148 offset:39296
    s_waitcnt lgkmcnt(10)
    v_mfma_f32_16x16x32_bf16 v[68:71], v[144:147], v[84:87], v[68:71]
    v_mfma_f32_16x16x32_bf16 v[72:75], v[144:147], v[88:91], v[72:75]
    s_waitcnt vmcnt(10)
    s_barrier
    ds_read_b64_tr_b16 v[144:145], v148 offset:37024
    ds_read_b64_tr_b16 v[146:147], v148 offset:39328
    s_waitcnt lgkmcnt(10)
    v_mfma_f32_16x16x32_bf16 v[4:7], v[124:127], v[92:95], v[4:7]
    v_mfma_f32_16x16x32_bf16 v[8:11], v[124:127], v[96:99], v[8:11]
    ds_read_b64_tr_b16 v[124:125], v148 offset:37056
    ds_read_b64_tr_b16 v[126:127], v148 offset:39360
    s_waitcnt lgkmcnt(10)
    v_mfma_f32_16x16x32_bf16 v[12:15], v[128:131], v[92:95], v[12:15]
    v_mfma_f32_16x16x32_bf16 v[16:19], v[128:131], v[96:99], v[16:19]
    ds_read_b64_tr_b16 v[128:129], v148 offset:37088
    ds_read_b64_tr_b16 v[130:131], v148 offset:39392
    s_waitcnt lgkmcnt(10)
    v_mfma_f32_16x16x32_bf16 v[20:23], v[132:135], v[92:95], v[20:23]
    v_mfma_f32_16x16x32_bf16 v[24:27], v[132:135], v[96:99], v[24:27]
    ds_read_b64_tr_b16 v[132:133], v148 offset:37120
    ds_read_b64_tr_b16 v[134:135], v148 offset:39424
    s_waitcnt lgkmcnt(10)
    v_mfma_f32_16x16x32_bf16 v[28:31], v[136:139], v[92:95], v[28:31]
    v_mfma_f32_16x16x32_bf16 v[32:35], v[136:139], v[96:99], v[32:35]
    ds_read_b64_tr_b16 v[136:137], v149 offset:0
    ds_read_b64_tr_b16 v[138:139], v149 offset:2304
    s_waitcnt lgkmcnt(10)
    v_mfma_f32_16x16x32_bf16 v[36:39], v[140:143], v[92:95], v[36:39]
    v_mfma_f32_16x16x32_bf16 v[40:43], v[140:143], v[96:99], v[40:43]
    ds_read_b64_tr_b16 v[140:141], v149 offset:32
    ds_read_b64_tr_b16 v[142:143], v149 offset:2336
    s_waitcnt lgkmcnt(10)
    v_mfma_f32_16x16x32_bf16 v[44:47], v[144:147], v[92:95], v[44:47]
    v_mfma_f32_16x16x32_bf16 v[48:51], v[144:147], v[96:99], v[48:51]
    ds_read_b64_tr_b16 v[144:145], v149 offset:64
    ds_read_b64_tr_b16 v[146:147], v149 offset:2368
    s_waitcnt lgkmcnt(10)
    v_mfma_f32_16x16x32_bf16 v[52:55], v[124:127], v[92:95], v[52:55]
    v_mfma_f32_16x16x32_bf16 v[56:59], v[124:127], v[96:99], v[56:59]
    ds_read_b64_tr_b16 v[124:125], v149 offset:96
    ds_read_b64_tr_b16 v[126:127], v149 offset:2400
    s_waitcnt lgkmcnt(10)
    v_mfma_f32_16x16x32_bf16 v[60:63], v[128:131], v[92:95], v[60:63]
    v_mfma_f32_16x16x32_bf16 v[64:67], v[128:131], v[96:99], v[64:67]
    ds_read_b64_tr_b16 v[128:129], v149 offset:128
    ds_read_b64_tr_b16 v[130:131], v149 offset:2432
    s_waitcnt lgkmcnt(10)
    v_mfma_f32_16x16x32_bf16 v[68:71], v[132:135], v[92:95], v[68:71]
    v_mfma_f32_16x16x32_bf16 v[72:75], v[132:135], v[96:99], v[72:75]
    s_waitcnt vmcnt(6)
    s_barrier
    ds_read_b64_tr_b16 v[132:133], v149 offset:160
    ds_read_b64_tr_b16 v[134:135], v149 offset:2464
    s_waitcnt lgkmcnt(10)
    v_mfma_f32_16x16x32_bf16 v[4:7], v[136:139], v[100:103], v[4:7]
    v_mfma_f32_16x16x32_bf16 v[8:11], v[136:139], v[104:107], v[8:11]
    ds_read_b64_tr_b16 v[136:137], v149 offset:192
    ds_read_b64_tr_b16 v[138:139], v149 offset:2496
    s_waitcnt lgkmcnt(10)
    v_mfma_f32_16x16x32_bf16 v[12:15], v[140:143], v[100:103], v[12:15]
    v_mfma_f32_16x16x32_bf16 v[16:19], v[140:143], v[104:107], v[16:19]
    ds_read_b64_tr_b16 v[140:141], v149 offset:224
    ds_read_b64_tr_b16 v[142:143], v149 offset:2528
    s_waitcnt lgkmcnt(10)
    v_mfma_f32_16x16x32_bf16 v[20:23], v[144:147], v[100:103], v[20:23]
    v_mfma_f32_16x16x32_bf16 v[24:27], v[144:147], v[104:107], v[24:27]
    ds_read_b64_tr_b16 v[144:145], v149 offset:256
    ds_read_b64_tr_b16 v[146:147], v149 offset:2560
    s_waitcnt lgkmcnt(10)
    v_mfma_f32_16x16x32_bf16 v[28:31], v[124:127], v[100:103], v[28:31]
    v_mfma_f32_16x16x32_bf16 v[32:35], v[124:127], v[104:107], v[32:35]
    ds_read_b64_tr_b16 v[124:125], v149 offset:18432
    ds_read_b64_tr_b16 v[126:127], v149 offset:20736
    s_waitcnt lgkmcnt(10)
    v_mfma_f32_16x16x32_bf16 v[36:39], v[128:131], v[100:103], v[36:39]
    v_mfma_f32_16x16x32_bf16 v[40:43], v[128:131], v[104:107], v[40:43]
    ds_read_b64_tr_b16 v[128:129], v149 offset:18464
    ds_read_b64_tr_b16 v[130:131], v149 offset:20768
    s_waitcnt lgkmcnt(10)
    v_mfma_f32_16x16x32_bf16 v[44:47], v[132:135], v[100:103], v[44:47]
    v_mfma_f32_16x16x32_bf16 v[48:51], v[132:135], v[104:107], v[48:51]
    ds_read_b64_tr_b16 v[132:133], v149 offset:18496
    ds_read_b64_tr_b16 v[134:135], v149 offset:20800
    s_waitcnt lgkmcnt(10)
    v_mfma_f32_16x16x32_bf16 v[52:55], v[136:139], v[100:103], v[52:55]
    v_mfma_f32_16x16x32_bf16 v[56:59], v[136:139], v[104:107], v[56:59]
    ds_read_b64_tr_b16 v[136:137], v149 offset:18528
    ds_read_b64_tr_b16 v[138:139], v149 offset:20832
    s_waitcnt lgkmcnt(10)
    v_mfma_f32_16x16x32_bf16 v[60:63], v[140:143], v[100:103], v[60:63]
    v_mfma_f32_16x16x32_bf16 v[64:67], v[140:143], v[104:107], v[64:67]
    ds_read_b64_tr_b16 v[140:141], v149 offset:18560
    ds_read_b64_tr_b16 v[142:143], v149 offset:20864
    s_waitcnt lgkmcnt(10)
    v_mfma_f32_16x16x32_bf16 v[68:71], v[144:147], v[100:103], v[68:71]
    v_mfma_f32_16x16x32_bf16 v[72:75], v[144:147], v[104:107], v[72:75]
    s_waitcnt vmcnt(2)
    s_barrier
    ds_read_b64_tr_b16 v[144:145], v149 offset:18592
    ds_read_b64_tr_b16 v[146:147], v149 offset:20896
    s_waitcnt lgkmcnt(10)
    v_mfma_f32_16x16x32_bf16 v[4:7], v[124:127], v[108:111], v[4:7]
    v_mfma_f32_16x16x32_bf16 v[8:11], v[124:127], v[112:115], v[8:11]
    ds_read_b64_tr_b16 v[124:125], v149 offset:18624
    ds_read_b64_tr_b16 v[126:127], v149 offset:20928
    s_waitcnt lgkmcnt(10)
    v_mfma_f32_16x16x32_bf16 v[12:15], v[128:131], v[108:111], v[12:15]
    v_mfma_f32_16x16x32_bf16 v[16:19], v[128:131], v[112:115], v[16:19]
    ds_read_b64_tr_b16 v[128:129], v149 offset:18656
    ds_read_b64_tr_b16 v[130:131], v149 offset:20960
    s_waitcnt lgkmcnt(10)
    v_mfma_f32_16x16x32_bf16 v[20:23], v[132:135], v[108:111], v[20:23]
    v_mfma_f32_16x16x32_bf16 v[24:27], v[132:135], v[112:115], v[24:27]
    ds_read_b64_tr_b16 v[132:133], v149 offset:18688
    ds_read_b64_tr_b16 v[134:135], v149 offset:20992
    s_waitcnt lgkmcnt(10)
    v_mfma_f32_16x16x32_bf16 v[28:31], v[136:139], v[108:111], v[28:31]
    v_mfma_f32_16x16x32_bf16 v[32:35], v[136:139], v[112:115], v[32:35]
    ds_read_b64_tr_b16 v[136:137], v149 offset:36864
    ds_read_b64_tr_b16 v[138:139], v149 offset:39168
    s_waitcnt lgkmcnt(10)
    v_mfma_f32_16x16x32_bf16 v[36:39], v[140:143], v[108:111], v[36:39]
    v_mfma_f32_16x16x32_bf16 v[40:43], v[140:143], v[112:115], v[40:43]
    ds_read_b64_tr_b16 v[140:141], v149 offset:36896
    ds_read_b64_tr_b16 v[142:143], v149 offset:39200
    s_waitcnt lgkmcnt(10)
    v_mfma_f32_16x16x32_bf16 v[44:47], v[144:147], v[108:111], v[44:47]
    v_mfma_f32_16x16x32_bf16 v[48:51], v[144:147], v[112:115], v[48:51]
    ds_read_b64_tr_b16 v[144:145], v149 offset:36928
    ds_read_b64_tr_b16 v[146:147], v149 offset:39232
    s_waitcnt lgkmcnt(10)
    v_mfma_f32_16x16x32_bf16 v[52:55], v[124:127], v[108:111], v[52:55]
    v_mfma_f32_16x16x32_bf16 v[56:59], v[124:127], v[112:115], v[56:59]
    ds_read_b64_tr_b16 v[124:125], v149 offset:36960
    ds_read_b64_tr_b16 v[126:127], v149 offset:39264
    s_waitcnt lgkmcnt(10)
    v_mfma_f32_16x16x32_bf16 v[60:63], v[128:131], v[108:111], v[60:63]
    v_mfma_f32_16x16x32_bf16 v[64:67], v[128:131], v[112:115], v[64:67]
    ds_read_b64_tr_b16 v[128:129], v149 offset:36992
    ds_read_b64_tr_b16 v[130:131], v149 offset:39296
    s_waitcnt lgkmcnt(10)
    v_mfma_f32_16x16x32_bf16 v[68:71], v[132:135], v[108:111], v[68:71]
    v_mfma_f32_16x16x32_bf16 v[72:75], v[132:135], v[112:115], v[72:75]
    s_barrier
    s_waitcnt vmcnt(0)
    ds_read_b64_tr_b16 v[132:133], v149 offset:37024
    ds_read_b64_tr_b16 v[134:135], v149 offset:39328
    s_waitcnt lgkmcnt(10)
    v_mfma_f32_16x16x32_bf16 v[4:7], v[136:139], v[116:119], v[4:7]
    v_mfma_f32_16x16x32_bf16 v[8:11], v[136:139], v[120:123], v[8:11]
    ds_read_b64_tr_b16 v[136:137], v149 offset:37056
    ds_read_b64_tr_b16 v[138:139], v149 offset:39360
    s_waitcnt lgkmcnt(10)
    v_mfma_f32_16x16x32_bf16 v[12:15], v[140:143], v[116:119], v[12:15]
    v_mfma_f32_16x16x32_bf16 v[16:19], v[140:143], v[120:123], v[16:19]
    ds_read_b64_tr_b16 v[140:141], v149 offset:37088
    ds_read_b64_tr_b16 v[142:143], v149 offset:39392
    s_waitcnt lgkmcnt(10)
    v_mfma_f32_16x16x32_bf16 v[20:23], v[144:147], v[116:119], v[20:23]
    v_mfma_f32_16x16x32_bf16 v[24:27], v[144:147], v[120:123], v[24:27]
    ds_read_b64_tr_b16 v[144:145], v149 offset:37120
    ds_read_b64_tr_b16 v[146:147], v149 offset:39424
    s_waitcnt lgkmcnt(10)
    v_mfma_f32_16x16x32_bf16 v[28:31], v[124:127], v[116:119], v[28:31]
    v_mfma_f32_16x16x32_bf16 v[32:35], v[124:127], v[120:123], v[32:35]
    s_waitcnt lgkmcnt(8)
    v_mfma_f32_16x16x32_bf16 v[36:39], v[128:131], v[116:119], v[36:39]
    v_mfma_f32_16x16x32_bf16 v[40:43], v[128:131], v[120:123], v[40:43]
    s_waitcnt lgkmcnt(6)
    v_mfma_f32_16x16x32_bf16 v[44:47], v[132:135], v[116:119], v[44:47]
    v_mfma_f32_16x16x32_bf16 v[48:51], v[132:135], v[120:123], v[48:51]
    s_waitcnt lgkmcnt(4)
    v_mfma_f32_16x16x32_bf16 v[52:55], v[136:139], v[116:119], v[52:55]
    v_mfma_f32_16x16x32_bf16 v[56:59], v[136:139], v[120:123], v[56:59]
    s_waitcnt lgkmcnt(2)
    v_mfma_f32_16x16x32_bf16 v[60:63], v[140:143], v[116:119], v[60:63]
    v_mfma_f32_16x16x32_bf16 v[64:67], v[140:143], v[120:123], v[64:67]
    s_waitcnt lgkmcnt(0)
    v_mfma_f32_16x16x32_bf16 v[68:71], v[144:147], v[116:119], v[68:71]
    v_mfma_f32_16x16x32_bf16 v[72:75], v[144:147], v[120:123], v[72:75]
    s_barrier
L_k4_kernel_epi:
    s_lshr_b32 s40, s28, 2
    v_lshlrev_b32 v160, 4, v0
    v_lshlrev_b32 v163, 3, v0
    s_mul_i32 s41, s28, 9216
    v_add_u32 v161, s41, v160
    s_xor_b32 s42, s28, 4
    s_mul_i32 s42, s42, 9216
    v_add_u32 v162, s42, v160
    s_cmp_eq_u32 s40, 0
    s_nop 4
    s_cbranch_scc0 L_k4_kernel_kh1
    ds_write_b128 v161, v[8:11] offset:0
    ds_write_b128 v161, v[16:19] offset:1024
    ds_write_b128 v161, v[24:27] offset:2048
    ds_write_b128 v161, v[32:35] offset:3072
    ds_write_b128 v161, v[40:43] offset:4096
    ds_write_b128 v161, v[48:51] offset:5120
    ds_write_b128 v161, v[56:59] offset:6144
    ds_write_b128 v161, v[64:67] offset:7168
    ds_write_b128 v161, v[72:75] offset:8192
    s_waitcnt lgkmcnt(0)
    s_barrier
    ds_read_b128 v[76:79], v162 offset:0
    ds_read_b128 v[80:83], v162 offset:1024
    ds_read_b128 v[84:87], v162 offset:2048
    ds_read_b128 v[88:91], v162 offset:3072
    ds_read_b128 v[92:95], v162 offset:4096
    ds_read_b128 v[96:99], v162 offset:5120
    ds_read_b128 v[100:103], v162 offset:6144
    ds_read_b128 v[104:107], v162 offset:7168
    ds_read_b128 v[108:111], v162 offset:8192
    s_waitcnt lgkmcnt(8)
    v_add_f32 v76, v76, v4
    v_add_f32 v77, v77, v5
    v_add_f32 v78, v78, v6
    v_add_f32 v79, v79, v7
    v_cvt_pk_bf16_f32 v76, v76, v77
    v_cvt_pk_bf16_f32 v77, v78, v79
    buffer_store_dwordx2 v[76:77], v163, s[20:23], s34 offen offset:0 sc1
    s_waitcnt lgkmcnt(7)
    v_add_f32 v80, v80, v12
    v_add_f32 v81, v81, v13
    v_add_f32 v82, v82, v14
    v_add_f32 v83, v83, v15
    v_cvt_pk_bf16_f32 v80, v80, v81
    v_cvt_pk_bf16_f32 v81, v82, v83
    buffer_store_dwordx2 v[80:81], v163, s[20:23], s34 offen offset:512 sc1
    s_waitcnt lgkmcnt(6)
    v_add_f32 v84, v84, v20
    v_add_f32 v85, v85, v21
    v_add_f32 v86, v86, v22
    v_add_f32 v87, v87, v23
    v_cvt_pk_bf16_f32 v84, v84, v85
    v_cvt_pk_bf16_f32 v85, v86, v87
    buffer_store_dwordx2 v[84:85], v163, s[20:23], s34 offen offset:1024 sc1
    s_waitcnt lgkmcnt(5)
    v_add_f32 v88, v88, v28
    v_add_f32 v89, v89, v29
    v_add_f32 v90, v90, v30
    v_add_f32 v91, v91, v31
    v_cvt_pk_bf16_f32 v88, v88, v89
    v_cvt_pk_bf16_f32 v89, v90, v91
    buffer_store_dwordx2 v[88:89], v163, s[20:23], s34 offen offset:1536 sc1
    s_waitcnt lgkmcnt(4)
    v_add_f32 v92, v92, v36
    v_add_f32 v93, v93, v37
    v_add_f32 v94, v94, v38
    v_add_f32 v95, v95, v39
    v_cvt_pk_bf16_f32 v92, v92, v93
    v_cvt_pk_bf16_f32 v93, v94, v95
    buffer_store_dwordx2 v[92:93], v163, s[20:23], s34 offen offset:2048 sc1
    s_waitcnt lgkmcnt(3)
    v_add_f32 v96, v96, v44
    v_add_f32 v97, v97, v45
    v_add_f32 v98, v98, v46
    v_add_f32 v99, v99, v47
    v_cvt_pk_bf16_f32 v96, v96, v97
    v_cvt_pk_bf16_f32 v97, v98, v99
    buffer_store_dwordx2 v[96:97], v163, s[20:23], s34 offen offset:2560 sc1
    s_waitcnt lgkmcnt(2)
    v_add_f32 v100, v100, v52
    v_add_f32 v101, v101, v53
    v_add_f32 v102, v102, v54
    v_add_f32 v103, v103, v55
    v_cvt_pk_bf16_f32 v100, v100, v101
    v_cvt_pk_bf16_f32 v101, v102, v103
    buffer_store_dwordx2 v[100:101], v163, s[20:23], s34 offen offset:3072 sc1
    s_waitcnt lgkmcnt(1)
    v_add_f32 v104, v104, v60
    v_add_f32 v105, v105, v61
    v_add_f32 v106, v106, v62
    v_add_f32 v107, v107, v63
    v_cvt_pk_bf16_f32 v104, v104, v105
    v_cvt_pk_bf16_f32 v105, v106, v107
    buffer_store_dwordx2 v[104:105], v163, s[20:23], s34 offen offset:3584 sc1
    s_waitcnt lgkmcnt(0)
    v_add_f32 v108, v108, v68
    v_add_f32 v109, v109, v69
    v_add_f32 v110, v110, v70
    v_add_f32 v111, v111, v71
    v_cvt_pk_bf16_f32 v108, v108, v109
    v_cvt_pk_bf16_f32 v109, v110, v111
    s_add_u32 s34, s34, 4096
    buffer_store_dwordx2 v[108:109], v163, s[20:23], s34 offen offset:0 sc1
    s_endpgm
L_k4_kernel_kh1:
    ds_write_b128 v161, v[4:7] offset:0
    ds_write_b128 v161, v[12:15] offset:1024
    ds_write_b128 v161, v[20:23] offset:2048
    ds_write_b128 v161, v[28:31] offset:3072
    ds_write_b128 v161, v[36:39] offset:4096
    ds_write_b128 v161, v[44:47] offset:5120
    ds_write_b128 v161, v[52:55] offset:6144
    ds_write_b128 v161, v[60:63] offset:7168
    ds_write_b128 v161, v[68:71] offset:8192
    s_waitcnt lgkmcnt(0)
    s_barrier
    ds_read_b128 v[76:79], v162 offset:0
    ds_read_b128 v[80:83], v162 offset:1024
    ds_read_b128 v[84:87], v162 offset:2048
    ds_read_b128 v[88:91], v162 offset:3072
    ds_read_b128 v[92:95], v162 offset:4096
    ds_read_b128 v[96:99], v162 offset:5120
    ds_read_b128 v[100:103], v162 offset:6144
    ds_read_b128 v[104:107], v162 offset:7168
    ds_read_b128 v[108:111], v162 offset:8192
    s_waitcnt lgkmcnt(8)
    v_add_f32 v76, v76, v8
    v_add_f32 v77, v77, v9
    v_add_f32 v78, v78, v10
    v_add_f32 v79, v79, v11
    v_cvt_pk_bf16_f32 v76, v76, v77
    v_cvt_pk_bf16_f32 v77, v78, v79
    buffer_store_dwordx2 v[76:77], v163, s[20:23], s34 offen offset:0 sc1
    s_waitcnt lgkmcnt(7)
    v_add_f32 v80, v80, v16
    v_add_f32 v81, v81, v17
    v_add_f32 v82, v82, v18
    v_add_f32 v83, v83, v19
    v_cvt_pk_bf16_f32 v80, v80, v81
    v_cvt_pk_bf16_f32 v81, v82, v83
    buffer_store_dwordx2 v[80:81], v163, s[20:23], s34 offen offset:512 sc1
    s_waitcnt lgkmcnt(6)
    v_add_f32 v84, v84, v24
    v_add_f32 v85, v85, v25
    v_add_f32 v86, v86, v26
    v_add_f32 v87, v87, v27
    v_cvt_pk_bf16_f32 v84, v84, v85
    v_cvt_pk_bf16_f32 v85, v86, v87
    buffer_store_dwordx2 v[84:85], v163, s[20:23], s34 offen offset:1024 sc1
    s_waitcnt lgkmcnt(5)
    v_add_f32 v88, v88, v32
    v_add_f32 v89, v89, v33
    v_add_f32 v90, v90, v34
    v_add_f32 v91, v91, v35
    v_cvt_pk_bf16_f32 v88, v88, v89
    v_cvt_pk_bf16_f32 v89, v90, v91
    buffer_store_dwordx2 v[88:89], v163, s[20:23], s34 offen offset:1536 sc1
    s_waitcnt lgkmcnt(4)
    v_add_f32 v92, v92, v40
    v_add_f32 v93, v93, v41
    v_add_f32 v94, v94, v42
    v_add_f32 v95, v95, v43
    v_cvt_pk_bf16_f32 v92, v92, v93
    v_cvt_pk_bf16_f32 v93, v94, v95
    buffer_store_dwordx2 v[92:93], v163, s[20:23], s34 offen offset:2048 sc1
    s_waitcnt lgkmcnt(3)
    v_add_f32 v96, v96, v48
    v_add_f32 v97, v97, v49
    v_add_f32 v98, v98, v50
    v_add_f32 v99, v99, v51
    v_cvt_pk_bf16_f32 v96, v96, v97
    v_cvt_pk_bf16_f32 v97, v98, v99
    buffer_store_dwordx2 v[96:97], v163, s[20:23], s34 offen offset:2560 sc1
    s_waitcnt lgkmcnt(2)
    v_add_f32 v100, v100, v56
    v_add_f32 v101, v101, v57
    v_add_f32 v102, v102, v58
    v_add_f32 v103, v103, v59
    v_cvt_pk_bf16_f32 v100, v100, v101
    v_cvt_pk_bf16_f32 v101, v102, v103
    buffer_store_dwordx2 v[100:101], v163, s[20:23], s34 offen offset:3072 sc1
    s_waitcnt lgkmcnt(1)
    v_add_f32 v104, v104, v64
    v_add_f32 v105, v105, v65
    v_add_f32 v106, v106, v66
    v_add_f32 v107, v107, v67
    v_cvt_pk_bf16_f32 v104, v104, v105
    v_cvt_pk_bf16_f32 v105, v106, v107
    buffer_store_dwordx2 v[104:105], v163, s[20:23], s34 offen offset:3584 sc1
    s_waitcnt lgkmcnt(0)
    v_add_f32 v108, v108, v72
    v_add_f32 v109, v109, v73
    v_add_f32 v110, v110, v74
    v_add_f32 v111, v111, v75
    v_cvt_pk_bf16_f32 v108, v108, v109
    v_cvt_pk_bf16_f32 v109, v110, v111
    s_add_u32 s34, s34, 4096
    buffer_store_dwordx2 v[108:109], v163, s[20:23], s34 offen offset:0 sc1
    s_endpgm
L_k4_kernel_done:
    s_endpgm

.globl k5_kernel
.p2align 8
.type k5_kernel,@function
k5_kernel:
    s_cmp_ge_u32 s2, 576
    s_cbranch_scc1 L_k5_kernel_done
    s_load_dwordx2 s[4:5], s[0:1], 56
    s_load_dwordx2 s[8:9], s[0:1], 72
    v_lshrrev_b32 v1, 6, v0
    v_and_b32 v0, 63, v0
    s_nop 0
    v_readfirstlane_b32 s28, v1
    s_lshl_b32 s29, s2, 2
    s_add_u32 s29, s29, s28
    s_mul_i32 s30, s29, 3641
    s_lshr_b32 s30, s30, 16
    s_mul_i32 s31, s30, 18
    s_sub_u32 s31, s29, s31
    s_waitcnt lgkmcnt(0)
    s_add_u32 s12, s8, 2359296
    s_addc_u32 s13, s9, 0
    s_and_b32 s13, s13, 0xffff
    s_mov_b32 s14, 2359296
    s_mov_b32 s15, 0x00020000
    s_add_u32 s16, s8, 23691264
    s_addc_u32 s17, s9, 0
    s_and_b32 s17, s17, 0xffff
    s_mov_b32 s18, 18874368
    s_mov_b32 s19, 0x00020000
    s_mov_b32 s20, s4
    s_mov_b32 s21, s5
    s_and_b32 s21, s21, 0xffff
    s_mov_b32 s22, 2359296
    s_mov_b32 s23, 0x00020000
    v_lshlrev_b32 v1, 4, v0
    s_lshl_b32 s32, s29, 10
    s_lshl_b32 s33, s29, 10
    v_lshlrev_b32 v3, 3, v0
    buffer_load_dwordx4 v[4:7], v1, s[12:15], s32 offen
    buffer_load_dwordx2 v[40:41], v3, s[16:19], s33 offen
    buffer_load_dwordx2 v[42:43], v3, s[16:19], s33 offen offset:512
    s_add_u32 s33, s33, 2359296
    buffer_load_dwordx2 v[44:45], v3, s[16:19], s33 offen
    buffer_load_dwordx2 v[46:47], v3, s[16:19], s33 offen offset:512
    s_add_u32 s33, s33, 2359296
    buffer_load_dwordx2 v[48:49], v3, s[16:19], s33 offen
    buffer_load_dwordx2 v[50:51], v3, s[16:19], s33 offen offset:512
    s_add_u32 s33, s33, 2359296
    buffer_load_dwordx2 v[52:53], v3, s[16:19], s33 offen
    buffer_load_dwordx2 v[54:55], v3, s[16:19], s33 offen offset:512
    v_and_b32 v2, 15, v0
    s_lshl_b32 s34, s30, 4
    v_add_u32 v2, s34, v2
    v_mul_u32_u24 v2, 1152, v2
    v_lshrrev_b32 v3, 4, v0
    v_lshl_add_u32 v2, v3, 3, v2
    s_lshl_b32 s34, s31, 6
    s_waitcnt vmcnt(0)
    v_lshlrev_b32 v8, 16, v40
    v_and_b32 v9, 0xffff0000, v40
    v_lshlrev_b32 v10, 16, v41
    v_and_b32 v11, 0xffff0000, v41
    v_lshlrev_b32 v12, 16, v42
    v_and_b32 v13, 0xffff0000, v42
    v_lshlrev_b32 v14, 16, v43
    v_and_b32 v15, 0xffff0000, v43
    v_lshlrev_b32 v16, 16, v44
    v_and_b32 v17, 0xffff0000, v44
    v_lshlrev_b32 v18, 16, v45
    v_and_b32 v19, 0xffff0000, v45
    v_lshlrev_b32 v20, 16, v46
    v_and_b32 v21, 0xffff0000, v46
    v_lshlrev_b32 v22, 16, v47
    v_and_b32 v23, 0xffff0000, v47
    v_lshlrev_b32 v24, 16, v48
    v_and_b32 v25, 0xffff0000, v48
    v_lshlrev_b32 v26, 16, v49
    v_and_b32 v27, 0xffff0000, v49
    v_lshlrev_b32 v28, 16, v50
    v_and_b32 v29, 0xffff0000, v50
    v_lshlrev_b32 v30, 16, v51
    v_and_b32 v31, 0xffff0000, v51
    v_lshlrev_b32 v32, 16, v52
    v_and_b32 v33, 0xffff0000, v52
    v_lshlrev_b32 v34, 16, v53
    v_and_b32 v35, 0xffff0000, v53
    v_lshlrev_b32 v36, 16, v54
    v_and_b32 v37, 0xffff0000, v54
    v_lshlrev_b32 v38, 16, v55
    v_and_b32 v39, 0xffff0000, v55
    v_add_f32 v8, v8, v16
    v_add_f32 v24, v24, v32
    v_add_f32 v9, v9, v17
    v_add_f32 v25, v25, v33
    v_add_f32 v10, v10, v18
    v_add_f32 v26, v26, v34
    v_add_f32 v11, v11, v19
    v_add_f32 v27, v27, v35
    v_add_f32 v12, v12, v20
    v_add_f32 v28, v28, v36
    v_add_f32 v13, v13, v21
    v_add_f32 v29, v29, v37
    v_add_f32 v14, v14, v22
    v_add_f32 v30, v30, v38
    v_add_f32 v15, v15, v23
    v_add_f32 v31, v31, v39
    v_add_f32 v8, v8, v24
    v_add_f32 v9, v9, v25
    v_add_f32 v10, v10, v26
    v_add_f32 v11, v11, v27
    v_add_f32 v12, v12, v28
    v_add_f32 v13, v13, v29
    v_add_f32 v14, v14, v30
    v_add_f32 v15, v15, v31
    v_cvt_pk_bf16_f32 v16, v8, v9
    v_cvt_pk_bf16_f32 v17, v10, v11
    v_cvt_pk_bf16_f32 v18, v12, v13
    v_cvt_pk_bf16_f32 v19, v14, v15
    v_lshlrev_b32 v24, 16, v16
    v_and_b32 v25, 0xffff0000, v16
    v_lshlrev_b32 v32, 16, v4
    v_and_b32 v33, 0xffff0000, v4
    v_lshlrev_b32 v26, 16, v17
    v_and_b32 v27, 0xffff0000, v17
    v_lshlrev_b32 v34, 16, v5
    v_and_b32 v35, 0xffff0000, v5
    v_lshlrev_b32 v28, 16, v18
    v_and_b32 v29, 0xffff0000, v18
    v_lshlrev_b32 v36, 16, v6
    v_and_b32 v37, 0xffff0000, v6
    v_lshlrev_b32 v30, 16, v19
    v_and_b32 v31, 0xffff0000, v19
    v_lshlrev_b32 v38, 16, v7
    v_and_b32 v39, 0xffff0000, v7
    v_add_f32 v24, v24, v32
    v_add_f32 v25, v25, v33
    v_add_f32 v26, v26, v34
    v_add_f32 v27, v27, v35
    v_add_f32 v28, v28, v36
    v_add_f32 v29, v29, v37
    v_add_f32 v30, v30, v38
    v_add_f32 v31, v31, v39
    v_cvt_pk_bf16_f32 v16, v24, v25
    v_cvt_pk_bf16_f32 v17, v26, v27
    v_cvt_pk_bf16_f32 v18, v28, v29
    v_cvt_pk_bf16_f32 v19, v30, v31
    buffer_store_dwordx2 v[16:17], v2, s[20:23], s34 offen
    buffer_store_dwordx2 v[18:19], v2, s[20:23], s34 offen offset:32
L_k5_kernel_done:
    s_endpgm
.section .rodata,"a"
.p2align 6
.amdhsa_kernel k1_kernel
  .amdhsa_next_free_vgpr 184
  .amdhsa_next_free_sgpr 96
  .amdhsa_accum_offset 184
  .amdhsa_group_segment_fixed_size 0
  .amdhsa_kernarg_size 80
  .amdhsa_user_sgpr_count 2
  .amdhsa_user_sgpr_kernarg_segment_ptr 1
  .amdhsa_system_sgpr_workgroup_id_x 1
.end_amdhsa_kernel
.p2align 6
.amdhsa_kernel k2_kernel
  .amdhsa_next_free_vgpr 188
  .amdhsa_next_free_sgpr 96
  .amdhsa_accum_offset 188
  .amdhsa_group_segment_fixed_size 0
  .amdhsa_kernarg_size 80
  .amdhsa_user_sgpr_count 2
  .amdhsa_user_sgpr_kernarg_segment_ptr 1
  .amdhsa_system_sgpr_workgroup_id_x 1
.end_amdhsa_kernel
.p2align 6
.amdhsa_kernel k3_kernel
  .amdhsa_next_free_vgpr 254
  .amdhsa_next_free_sgpr 96
  .amdhsa_accum_offset 256
  .amdhsa_group_segment_fixed_size 0
  .amdhsa_kernarg_size 80
  .amdhsa_user_sgpr_count 2
  .amdhsa_user_sgpr_kernarg_segment_ptr 1
  .amdhsa_system_sgpr_workgroup_id_x 1
.end_amdhsa_kernel
.p2align 6
.amdhsa_kernel k4_kernel
  .amdhsa_next_free_vgpr 176
  .amdhsa_next_free_sgpr 96
  .amdhsa_accum_offset 176
  .amdhsa_group_segment_fixed_size 0
  .amdhsa_kernarg_size 80
  .amdhsa_user_sgpr_count 2
  .amdhsa_user_sgpr_kernarg_segment_ptr 1
  .amdhsa_system_sgpr_workgroup_id_x 1
.end_amdhsa_kernel
.p2align 6
.amdhsa_kernel k5_kernel
  .amdhsa_next_free_vgpr 56
  .amdhsa_next_free_sgpr 48
  .amdhsa_accum_offset 56
  .amdhsa_group_segment_fixed_size 0
  .amdhsa_kernarg_size 80
  .amdhsa_user_sgpr_count 2
  .amdhsa_user_sgpr_kernarg_segment_ptr 1
  .amdhsa_system_sgpr_workgroup_id_x 1
.end_amdhsa_kernel
```
